```python
import torch

def _softmax(x, axis=-1):
    return torch.softmax(x, dim=axis)
def _gelu(x):
    return torch.nn.functional.gelu(x, approximate="tanh")
def _silu(x):
    return torch.nn.functional.silu(x)
def _sigmoid(x):
    return torch.sigmoid(x)
def _layernorm(x, axis=-1, eps=1e-5):
    m = x.mean(dim=axis, keepdim=True)
    v = x.var(dim=axis, keepdim=True, unbiased=False)
    return (x - m) / torch.sqrt(v + eps)
def _scatter_add(tgt, idx, src, axis=0):
    return tgt.clone().index_add_(axis, idx, src)
def _segment_sum(src, seg, n):
    out = torch.zeros((n,) + src.shape[1:], dtype=src.dtype)
    return out.index_add_(0, seg, src)
def _pad(x, pw):
    flat = tuple(v for pair in reversed(pw) for v in pair)
    return torch.nn.functional.pad(x, flat)

kernel_name = 'recurrent_scan__spectral_gfnet__glu_gated_geglu__prompt'

def setup_inputs():

    _w = (lambda a: (lambda t: t.to(torch.bfloat16) if t.is_floating_point() else t)(torch.as_tensor(a)))
    def _A_setup():
        B, S, D = 1, 2048, 512
        Df = D // 2 + 1
        return {
            "x": _w((lambda *s: torch.randn(*s, dtype=torch.bfloat16) * 0.1)(B, S, D)),
            "w_r": _w((lambda *s: torch.randn(*s, dtype=torch.bfloat16) * 3.2)(S, Df) * 0.02),
            "w_i": _w((lambda *s: torch.randn(*s, dtype=torch.bfloat16) * 3.2)(S, Df) * 0.02),
        }
    _A_in = _A_setup()

    def _B_setup():
        B, S, Dm, Df = 1, 2048, 512, 1376
        return {
            "x": _w((lambda *s: torch.randn(*s, dtype=torch.bfloat16) * 0.1)(B, S, Dm)),
            "w_gate": _w((lambda *s: torch.randn(*s, dtype=torch.bfloat16) * 0.8)(Dm, Df) * (Dm ** -0.5)),
            "w_up": _w((lambda *s: torch.randn(*s, dtype=torch.bfloat16) * 0.8)(Dm, Df) * (Dm ** -0.5)),
            "w_down": _w((lambda *s: torch.randn(*s, dtype=torch.bfloat16) * 0.8)(Df, Dm) * (Df ** -0.5)),
        }
    _B_in = _B_setup()

    return {
        "A_x": _A_in["x"],
        "A_w_r": _A_in["w_r"],
        "A_w_i": _A_in["w_i"],
        "B_x": _B_in["x"],
        "B_w_gate": _B_in["w_gate"],
        "B_w_up": _B_in["w_up"],
        "B_w_down": _B_in["w_down"],
    }

def reference(A_x, A_w_r, A_w_i, B_x, B_w_gate, B_w_up, B_w_down):
    def _A_ref(x, w_r, w_i):
        B, S, D = x.shape
        X = (lambda x, axes=(-2,-1): torch.fft.rfft2(x.float(), dim=axes))(x, axes=(-2, -1))
        W = w_r + 1j * w_i
        X = X * W
        y = (lambda x, s, axes=(-2,-1): torch.fft.irfft2(x, s=s, dim=axes).to(torch.bfloat16))(X, (S, D), axes=(-2, -1))
        return y

    def _B_ref(x, w_gate, w_up, w_down):
        g = torch.einsum("bsd,df->bsf", x, w_gate)
        u = torch.einsum("bsd,df->bsf", x, w_up)
        h = _gelu(g) * u
        return torch.einsum("bsf,fd->bsd", h, w_down)

    x = A_x
    xn = _layernorm(x, axis=-1)
    s = _A_ref(xn, A_w_r, A_w_i)
    g = _silu(_B_ref(xn, B_w_gate, B_w_up, B_w_down))
    return x + s * g
```

```asm
; @launch kernel=k0_kernel grid=(256,1,1) block=(512,1,1) lds=37248
; @launch kernel=k1_kernel grid=(512,1,1) block=(256,1,1) lds=74112
.amdgcn_target "amdgcn-amd-amdhsa--gfx950"
.text
.globl k0_kernel
.p2align 8
.type k0_kernel,@function
k0_kernel:
    s_cmp_ge_u32 s2, 256
    s_cbranch_scc1 L_k0_exit
    s_load_dwordx4 s[4:7], s[0:1], 0
    s_load_dwordx2 s[8:9], s[0:1], 16
    s_load_dwordx2 s[10:11], s[0:1], 32
    s_load_dwordx2 s[12:13], s[0:1], 40
    s_load_dwordx2 s[14:15], s[0:1], 48
    s_load_dwordx2 s[16:17], s[0:1], 72
    s_getpc_b64 s[24:25]
L_k0_pc:
    s_add_u32 s24, s24, TWTAB-L_k0_pc
    s_addc_u32 s25, s25, 0
    s_and_b32 s25, s25, 0xffff
    s_mov_b32 s26, 23296
    s_mov_b32 s27, 0x00020000
    s_mov_b32 s64, 0x3f3504f3
    s_mov_b32 s65, 0x3f3504f3
    v_and_b32 v1, 63, v0
    v_lshrrev_b32 v2, 6, v0
    s_nop 0
    v_readfirstlane_b32 s50, v2
    v_lshlrev_b32 v3, 4, v1
    s_and_b32 s49, s2, 3
    s_lshl_b32 s49, s49, 6
    s_and_b32 s3, s2, 4
    s_lshl_b32 s3, s3, 3
    s_or_b32 s49, s49, s3
    s_lshr_b32 s3, s2, 3
    s_and_b32 s3, s3, 31
    s_or_b32 s49, s49, s3
    s_and_b32 s51, s50, 3
    s_cmp_ge_u32 s50, 4
    s_cbranch_scc1 L_k0_aux
    s_lshl_b32 s62, s49, 3
    s_lshl_b32 s3, s50, 1
    s_add_u32 s62, s62, s3
    s_lshl_b32 s62, s62, 10
    v_lshlrev_b32 v5, 1, v1
    v_and_b32 v4, 7, v1
    v_lshlrev_b32 v4, 4, v4
    s_waitcnt lgkmcnt(0)
    s_mov_b32 s20, s4
    s_and_b32 s21, s5, 0xffff
    s_mov_b32 s22, 0x200000
    s_mov_b32 s23, 0x00020000
    buffer_load_ushort v8, v5, s[20:23], s62 offen offset:0
    buffer_load_ushort v9, v5, s[20:23], s62 offen offset:1024
    buffer_load_ushort v10, v5, s[20:23], s62 offen offset:128
    buffer_load_ushort v11, v5, s[20:23], s62 offen offset:1152
    buffer_load_ushort v12, v5, s[20:23], s62 offen offset:256
    buffer_load_ushort v13, v5, s[20:23], s62 offen offset:1280
    buffer_load_ushort v14, v5, s[20:23], s62 offen offset:384
    buffer_load_ushort v15, v5, s[20:23], s62 offen offset:1408
    buffer_load_ushort v16, v5, s[20:23], s62 offen offset:512
    buffer_load_ushort v17, v5, s[20:23], s62 offen offset:1536
    buffer_load_ushort v18, v5, s[20:23], s62 offen offset:640
    buffer_load_ushort v19, v5, s[20:23], s62 offen offset:1664
    buffer_load_ushort v20, v5, s[20:23], s62 offen offset:768
    buffer_load_ushort v21, v5, s[20:23], s62 offen offset:1792
    buffer_load_ushort v22, v5, s[20:23], s62 offen offset:896
    buffer_load_ushort v23, v5, s[20:23], s62 offen offset:1920
    buffer_load_dwordx4 v[40:43], v3, s[24:27], 0 offen offset:0
    buffer_load_dwordx4 v[44:47], v3, s[24:27], 0 offen offset:1024
    buffer_load_dwordx4 v[48:51], v3, s[24:27], 0 offen offset:2048
    buffer_load_dwordx4 v[52:55], v3, s[24:27], 0 offen offset:3072
    s_mov_b32 s3, 4096
    buffer_load_dwordx4 v[56:59], v4, s[24:27], s3 offen
    s_mov_b32 s3, 4224
    buffer_load_dwordx4 v[60:63], v4, s[24:27], s3 offen
    s_mov_b32 s3, 4352
    buffer_load_dwordx4 v[64:67], v4, s[24:27], s3 offen
    s_mov_b32 s3, 4480
    buffer_load_dwordx4 v[68:71], v4, s[24:27], s3 offen
    s_mov_b32 s28, s16
    s_and_b32 s29, s17, 0xffff
    s_mov_b32 s30, 0x410000
    s_mov_b32 s31, 0x00020000
    s_mul_i32 s61, s50, 4928
    s_add_u32 s61, s61, 0
    s_mul_i32 s3, s50, 2080
    s_add_u32 s3, s3, 28928
    v_add_u32 v89, s3, v5
    v_lshlrev_b32 v84, 3, v1
    v_add_u32 v84, s61, v84
    v_lshrrev_b32 v5, 3, v1
    v_and_b32 v6, 7, v1
    v_mul_u32_u24 v85, 72, v5
    v_add_u32 v86, v85, v6
    v_lshlrev_b32 v86, 3, v86
    v_add_u32 v86, s61, v86
    v_mul_u32_u24 v87, 9, v6
    v_add_u32 v87, v87, v85
    v_lshlrev_b32 v87, 3, v87
    v_add_u32 v87, s61, v87
    v_lshlrev_b32 v88, 3, v6
    v_add_u32 v88, v88, v5
    v_lshlrev_b32 v88, 3, v88
    v_add_u32 v88, s61, v88
    s_waitcnt vmcnt(8)
    v_lshlrev_b32 v8, 16, v8
    v_lshlrev_b32 v9, 16, v9
    v_lshlrev_b32 v10, 16, v10
    v_lshlrev_b32 v11, 16, v11
    v_lshlrev_b32 v12, 16, v12
    v_lshlrev_b32 v13, 16, v13
    v_lshlrev_b32 v14, 16, v14
    v_lshlrev_b32 v15, 16, v15
    v_lshlrev_b32 v16, 16, v16
    v_lshlrev_b32 v17, 16, v17
    v_lshlrev_b32 v18, 16, v18
    v_lshlrev_b32 v19, 16, v19
    v_lshlrev_b32 v20, 16, v20
    v_lshlrev_b32 v21, 16, v21
    v_lshlrev_b32 v22, 16, v22
    v_lshlrev_b32 v23, 16, v23
    v_pk_add_f32 v[72:73], v[8:9], v[10:11]
    v_pk_mul_f32 v[74:75], v[8:9], v[8:9]
    v_pk_add_f32 v[80:81], v[12:13], v[14:15]
    v_pk_mul_f32 v[82:83], v[10:11], v[10:11]
    v_pk_add_f32 v[72:73], v[72:73], v[16:17]
    v_pk_fma_f32 v[74:75], v[12:13], v[12:13], v[74:75]
    v_pk_add_f32 v[80:81], v[80:81], v[18:19]
    v_pk_fma_f32 v[82:83], v[14:15], v[14:15], v[82:83]
    v_pk_add_f32 v[72:73], v[72:73], v[20:21]
    v_pk_fma_f32 v[74:75], v[16:17], v[16:17], v[74:75]
    v_pk_add_f32 v[80:81], v[80:81], v[22:23]
    v_pk_fma_f32 v[82:83], v[18:19], v[18:19], v[82:83]
    v_pk_fma_f32 v[74:75], v[20:21], v[20:21], v[74:75]
    v_pk_fma_f32 v[82:83], v[22:23], v[22:23], v[82:83]
    v_pk_add_f32 v[72:73], v[72:73], v[80:81]
    v_pk_add_f32 v[74:75], v[74:75], v[82:83]
    s_nop 0
    v_add_f32_dpp v72, v72, v72 row_shr:1 row_mask:0xf bank_mask:0xf bound_ctrl:0
    v_add_f32_dpp v73, v73, v73 row_shr:1 row_mask:0xf bank_mask:0xf bound_ctrl:0
    v_add_f32_dpp v74, v74, v74 row_shr:1 row_mask:0xf bank_mask:0xf bound_ctrl:0
    v_add_f32_dpp v75, v75, v75 row_shr:1 row_mask:0xf bank_mask:0xf bound_ctrl:0
    v_add_f32_dpp v72, v72, v72 row_shr:2 row_mask:0xf bank_mask:0xf bound_ctrl:0
    v_add_f32_dpp v73, v73, v73 row_shr:2 row_mask:0xf bank_mask:0xf bound_ctrl:0
    v_add_f32_dpp v74, v74, v74 row_shr:2 row_mask:0xf bank_mask:0xf bound_ctrl:0
    v_add_f32_dpp v75, v75, v75 row_shr:2 row_mask:0xf bank_mask:0xf bound_ctrl:0
    v_add_f32_dpp v72, v72, v72 row_shr:4 row_mask:0xf bank_mask:0xf bound_ctrl:0
    v_add_f32_dpp v73, v73, v73 row_shr:4 row_mask:0xf bank_mask:0xf bound_ctrl:0
    v_add_f32_dpp v74, v74, v74 row_shr:4 row_mask:0xf bank_mask:0xf bound_ctrl:0
    v_add_f32_dpp v75, v75, v75 row_shr:4 row_mask:0xf bank_mask:0xf bound_ctrl:0
    v_add_f32_dpp v72, v72, v72 row_shr:8 row_mask:0xf bank_mask:0xf bound_ctrl:0
    v_add_f32_dpp v73, v73, v73 row_shr:8 row_mask:0xf bank_mask:0xf bound_ctrl:0
    v_add_f32_dpp v74, v74, v74 row_shr:8 row_mask:0xf bank_mask:0xf bound_ctrl:0
    v_add_f32_dpp v75, v75, v75 row_shr:8 row_mask:0xf bank_mask:0xf bound_ctrl:0
    v_add_f32_dpp v72, v72, v72 row_bcast:15 row_mask:0xa bank_mask:0xf
    v_add_f32_dpp v73, v73, v73 row_bcast:15 row_mask:0xa bank_mask:0xf
    v_add_f32_dpp v74, v74, v74 row_bcast:15 row_mask:0xa bank_mask:0xf
    v_add_f32_dpp v75, v75, v75 row_bcast:15 row_mask:0xa bank_mask:0xf
    v_add_f32_dpp v72, v72, v72 row_bcast:31 row_mask:0xc bank_mask:0xf
    v_add_f32_dpp v73, v73, v73 row_bcast:31 row_mask:0xc bank_mask:0xf
    v_add_f32_dpp v74, v74, v74 row_bcast:31 row_mask:0xc bank_mask:0xf
    v_add_f32_dpp v75, v75, v75 row_bcast:31 row_mask:0xc bank_mask:0xf
    v_readlane_b32 s66, v72, 63
    v_readlane_b32 s67, v73, 63
    v_readlane_b32 s68, v74, 63
    v_readlane_b32 s69, v75, 63
    v_mov_b32 v76, s66
    v_mov_b32 v77, s67
    v_mov_b32 v78, s68
    v_mov_b32 v79, s69
    v_mul_f32 v76, 0x3b000000, v76
    v_mul_f32 v77, 0x3b000000, v77
    v_mul_f32 v78, 0x3b000000, v78
    v_mul_f32 v79, 0x3b000000, v79
    v_fma_f32 v78, -v76, v76, v78
    v_fma_f32 v79, -v77, v77, v79
    v_max_f32 v78, 0, v78
    v_max_f32 v79, 0, v79
    v_cvt_pk_bf16_f32 v72, v76, v77
    v_lshlrev_b32 v76, 16, v72
    v_and_b32 v77, 0xffff0000, v72
    v_cvt_pk_bf16_f32 v74, v78, v79
    v_lshlrev_b32 v78, 16, v74
    v_and_b32 v79, 0xffff0000, v74
    v_add_f32 v78, 0x3727c5ac, v78
    v_add_f32 v79, 0x3727c5ac, v79
    v_pk_add_f32 v[8:9], v[8:9], v[76:77] neg_lo:[0,1] neg_hi:[0,1]
    v_pk_add_f32 v[10:11], v[10:11], v[76:77] neg_lo:[0,1] neg_hi:[0,1]
    v_pk_add_f32 v[12:13], v[12:13], v[76:77] neg_lo:[0,1] neg_hi:[0,1]
    v_pk_add_f32 v[14:15], v[14:15], v[76:77] neg_lo:[0,1] neg_hi:[0,1]
    v_cvt_pk_bf16_f32 v74, v78, v79
    v_lshlrev_b32 v78, 16, v74
    v_and_b32 v79, 0xffff0000, v74
    v_sqrt_f32 v78, v78
    v_sqrt_f32 v79, v79
    v_pk_add_f32 v[16:17], v[16:17], v[76:77] neg_lo:[0,1] neg_hi:[0,1]
    v_pk_add_f32 v[18:19], v[18:19], v[76:77] neg_lo:[0,1] neg_hi:[0,1]
    v_pk_add_f32 v[20:21], v[20:21], v[76:77] neg_lo:[0,1] neg_hi:[0,1]
    v_pk_add_f32 v[22:23], v[22:23], v[76:77] neg_lo:[0,1] neg_hi:[0,1]
    v_cvt_pk_bf16_f32 v74, v78, v79
    v_lshlrev_b32 v78, 16, v74
    v_and_b32 v79, 0xffff0000, v74
    v_rcp_f32 v78, v78
    v_rcp_f32 v79, v79
    v_cvt_pk_bf16_f32 v72, v8, v9
    v_cvt_pk_bf16_f32 v73, v10, v11
    v_cvt_pk_bf16_f32 v80, v12, v13
    v_cvt_pk_bf16_f32 v81, v14, v15
    v_cvt_pk_bf16_f32 v82, v16, v17
    v_cvt_pk_bf16_f32 v83, v18, v19
    v_cvt_pk_bf16_f32 v76, v20, v21
    v_cvt_pk_bf16_f32 v77, v22, v23
    v_lshlrev_b32 v8, 16, v72
    v_and_b32 v9, 0xffff0000, v72
    v_lshlrev_b32 v10, 16, v73
    v_and_b32 v11, 0xffff0000, v73
    v_lshlrev_b32 v12, 16, v80
    v_and_b32 v13, 0xffff0000, v80
    v_lshlrev_b32 v14, 16, v81
    v_and_b32 v15, 0xffff0000, v81
    v_lshlrev_b32 v16, 16, v82
    v_and_b32 v17, 0xffff0000, v82
    v_lshlrev_b32 v18, 16, v83
    v_and_b32 v19, 0xffff0000, v83
    v_lshlrev_b32 v20, 16, v76
    v_and_b32 v21, 0xffff0000, v76
    v_lshlrev_b32 v22, 16, v77
    v_and_b32 v23, 0xffff0000, v77
    v_pk_mul_f32 v[8:9], v[8:9], v[78:79]
    v_pk_mul_f32 v[10:11], v[10:11], v[78:79]
    v_pk_mul_f32 v[12:13], v[12:13], v[78:79]
    v_pk_mul_f32 v[14:15], v[14:15], v[78:79]
    v_pk_mul_f32 v[16:17], v[16:17], v[78:79]
    v_pk_mul_f32 v[18:19], v[18:19], v[78:79]
    v_pk_mul_f32 v[20:21], v[20:21], v[78:79]
    v_pk_mul_f32 v[22:23], v[22:23], v[78:79]
    v_cvt_pk_bf16_f32 v72, v8, v9
    v_cvt_pk_bf16_f32 v73, v10, v11
    v_cvt_pk_bf16_f32 v80, v12, v13
    v_cvt_pk_bf16_f32 v81, v14, v15
    v_cvt_pk_bf16_f32 v82, v16, v17
    v_cvt_pk_bf16_f32 v83, v18, v19
    v_cvt_pk_bf16_f32 v76, v20, v21
    v_cvt_pk_bf16_f32 v77, v22, v23
    v_lshlrev_b32 v8, 16, v72
    v_and_b32 v9, 0xffff0000, v72
    ds_write_b16 v89, v72 offset:0
    ds_write_b16_d16_hi v89, v72 offset:1040
    v_lshlrev_b32 v10, 16, v73
    v_and_b32 v11, 0xffff0000, v73
    ds_write_b16 v89, v73 offset:128
    ds_write_b16_d16_hi v89, v73 offset:1168
    v_lshlrev_b32 v12, 16, v80
    v_and_b32 v13, 0xffff0000, v80
    ds_write_b16 v89, v80 offset:256
    ds_write_b16_d16_hi v89, v80 offset:1296
    v_lshlrev_b32 v14, 16, v81
    v_and_b32 v15, 0xffff0000, v81
    ds_write_b16 v89, v81 offset:384
    ds_write_b16_d16_hi v89, v81 offset:1424
    v_lshlrev_b32 v16, 16, v82
    v_and_b32 v17, 0xffff0000, v82
    ds_write_b16 v89, v82 offset:512
    ds_write_b16_d16_hi v89, v82 offset:1552
    v_lshlrev_b32 v18, 16, v83
    v_and_b32 v19, 0xffff0000, v83
    ds_write_b16 v89, v83 offset:640
    ds_write_b16_d16_hi v89, v83 offset:1680
    v_lshlrev_b32 v20, 16, v76
    v_and_b32 v21, 0xffff0000, v76
    ds_write_b16 v89, v76 offset:768
    ds_write_b16_d16_hi v89, v76 offset:1808
    v_lshlrev_b32 v22, 16, v77
    v_and_b32 v23, 0xffff0000, v77
    ds_write_b16 v89, v77 offset:896
    ds_write_b16_d16_hi v89, v77 offset:1936
    v_pk_add_f32 v[24:25], v[8:9], v[16:17]
    v_pk_add_f32 v[32:33], v[8:9], v[16:17] neg_lo:[0,1] neg_hi:[0,1]
    v_pk_add_f32 v[26:27], v[10:11], v[18:19]
    v_pk_add_f32 v[34:35], v[10:11], v[18:19] neg_lo:[0,1] neg_hi:[0,1]
    v_pk_add_f32 v[28:29], v[12:13], v[20:21]
    v_pk_add_f32 v[36:37], v[12:13], v[20:21] neg_lo:[0,1] neg_hi:[0,1]
    v_pk_add_f32 v[30:31], v[14:15], v[22:23]
    v_pk_add_f32 v[38:39], v[14:15], v[22:23] neg_lo:[0,1] neg_hi:[0,1]
    v_pk_add_f32 v[8:9], v[34:35], v[34:35] op_sel:[0,1] op_sel_hi:[1,0] neg_hi:[0,1]
    v_pk_mul_f32 v[34:35], v[8:9], s[64:65]
    v_pk_add_f32 v[10:11], v[38:39], v[38:39] op_sel:[0,1] op_sel_hi:[1,0] neg_lo:[0,1]
    v_pk_mul_f32 v[38:39], v[10:11], s[64:65] neg_lo:[1,0] neg_hi:[1,0]
    v_pk_add_f32 v[8:9], v[24:25], v[28:29]
    v_pk_add_f32 v[10:11], v[24:25], v[28:29] neg_lo:[0,1] neg_hi:[0,1]
    v_pk_add_f32 v[12:13], v[26:27], v[30:31]
    v_pk_add_f32 v[14:15], v[26:27], v[30:31] neg_lo:[0,1] neg_hi:[0,1]
    v_pk_add_f32 v[16:17], v[32:33], v[36:37] op_sel:[0,1] op_sel_hi:[1,0] neg_hi:[0,1]
    v_pk_add_f32 v[18:19], v[32:33], v[36:37] op_sel:[0,1] op_sel_hi:[1,0] neg_lo:[0,1]
    v_pk_add_f32 v[20:21], v[34:35], v[38:39]
    v_pk_add_f32 v[22:23], v[34:35], v[38:39] neg_lo:[0,1] neg_hi:[0,1]
    v_pk_add_f32 v[24:25], v[8:9], v[12:13]
    v_pk_add_f32 v[32:33], v[8:9], v[12:13] neg_lo:[0,1] neg_hi:[0,1]
    v_pk_add_f32 v[28:29], v[10:11], v[14:15] op_sel:[0,1] op_sel_hi:[1,0] neg_hi:[0,1]
    v_pk_add_f32 v[36:37], v[10:11], v[14:15] op_sel:[0,1] op_sel_hi:[1,0] neg_lo:[0,1]
    v_pk_add_f32 v[26:27], v[16:17], v[20:21]
    v_pk_add_f32 v[34:35], v[16:17], v[20:21] neg_lo:[0,1] neg_hi:[0,1]
    v_pk_add_f32 v[30:31], v[18:19], v[22:23] op_sel:[0,1] op_sel_hi:[1,0] neg_hi:[0,1]
    v_pk_add_f32 v[38:39], v[18:19], v[22:23] op_sel:[0,1] op_sel_hi:[1,0] neg_lo:[0,1]
    s_waitcnt vmcnt(4)
    v_pk_mul_f32 v[10:11], v[26:27], v[42:43] op_sel:[0,0] op_sel_hi:[1,0]
    v_pk_fma_f32 v[10:11], v[26:27], v[42:43], v[10:11] op_sel:[1,1,0] op_sel_hi:[0,1,1] neg_lo:[1,0,0]
    v_pk_mul_f32 v[12:13], v[28:29], v[44:45] op_sel:[0,0] op_sel_hi:[1,0]
    v_pk_fma_f32 v[12:13], v[28:29], v[44:45], v[12:13] op_sel:[1,1,0] op_sel_hi:[0,1,1] neg_lo:[1,0,0]
    v_pk_mul_f32 v[14:15], v[30:31], v[46:47] op_sel:[0,0] op_sel_hi:[1,0]
    v_pk_fma_f32 v[14:15], v[30:31], v[46:47], v[14:15] op_sel:[1,1,0] op_sel_hi:[0,1,1] neg_lo:[1,0,0]
    v_pk_mul_f32 v[16:17], v[32:33], v[48:49] op_sel:[0,0] op_sel_hi:[1,0]
    v_pk_fma_f32 v[16:17], v[32:33], v[48:49], v[16:17] op_sel:[1,1,0] op_sel_hi:[0,1,1] neg_lo:[1,0,0]
    v_pk_mul_f32 v[18:19], v[34:35], v[50:51] op_sel:[0,0] op_sel_hi:[1,0]
    v_pk_fma_f32 v[18:19], v[34:35], v[50:51], v[18:19] op_sel:[1,1,0] op_sel_hi:[0,1,1] neg_lo:[1,0,0]
    v_pk_mul_f32 v[20:21], v[36:37], v[52:53] op_sel:[0,0] op_sel_hi:[1,0]
    v_pk_fma_f32 v[20:21], v[36:37], v[52:53], v[20:21] op_sel:[1,1,0] op_sel_hi:[0,1,1] neg_lo:[1,0,0]
    v_pk_mul_f32 v[22:23], v[38:39], v[54:55] op_sel:[0,0] op_sel_hi:[1,0]
    v_pk_fma_f32 v[22:23], v[38:39], v[54:55], v[22:23] op_sel:[1,1,0] op_sel_hi:[0,1,1] neg_lo:[1,0,0]
    ds_write_b64 v84, v[24:25]
    ds_write_b64 v84, v[10:11] offset:576
    ds_write_b64 v84, v[12:13] offset:1152
    ds_write_b64 v84, v[14:15] offset:1728
    ds_write_b64 v84, v[16:17] offset:2304
    ds_write_b64 v84, v[18:19] offset:2880
    ds_write_b64 v84, v[20:21] offset:3456
    ds_write_b64 v84, v[22:23] offset:4032
    ds_read_b64 v[8:9], v86 offset:0
    ds_read_b64 v[10:11], v86 offset:64
    ds_read_b64 v[12:13], v86 offset:128
    ds_read_b64 v[14:15], v86 offset:192
    ds_read_b64 v[16:17], v86 offset:256
    ds_read_b64 v[18:19], v86 offset:320
    ds_read_b64 v[20:21], v86 offset:384
    ds_read_b64 v[22:23], v86 offset:448
    s_waitcnt vmcnt(0) lgkmcnt(0)
    v_pk_add_f32 v[24:25], v[8:9], v[16:17]
    v_pk_add_f32 v[32:33], v[8:9], v[16:17] neg_lo:[0,1] neg_hi:[0,1]
    v_pk_add_f32 v[26:27], v[10:11], v[18:19]
    v_pk_add_f32 v[34:35], v[10:11], v[18:19] neg_lo:[0,1] neg_hi:[0,1]
    v_pk_add_f32 v[28:29], v[12:13], v[20:21]
    v_pk_add_f32 v[36:37], v[12:13], v[20:21] neg_lo:[0,1] neg_hi:[0,1]
    v_pk_add_f32 v[30:31], v[14:15], v[22:23]
    v_pk_add_f32 v[38:39], v[14:15], v[22:23] neg_lo:[0,1] neg_hi:[0,1]
    v_pk_add_f32 v[8:9], v[34:35], v[34:35] op_sel:[0,1] op_sel_hi:[1,0] neg_hi:[0,1]
    v_pk_mul_f32 v[34:35], v[8:9], s[64:65]
    v_pk_add_f32 v[10:11], v[38:39], v[38:39] op_sel:[0,1] op_sel_hi:[1,0] neg_lo:[0,1]
    v_pk_mul_f32 v[38:39], v[10:11], s[64:65] neg_lo:[1,0] neg_hi:[1,0]
    v_pk_add_f32 v[8:9], v[24:25], v[28:29]
    v_pk_add_f32 v[10:11], v[24:25], v[28:29] neg_lo:[0,1] neg_hi:[0,1]
    v_pk_add_f32 v[12:13], v[26:27], v[30:31]
    v_pk_add_f32 v[14:15], v[26:27], v[30:31] neg_lo:[0,1] neg_hi:[0,1]
    v_pk_add_f32 v[16:17], v[32:33], v[36:37] op_sel:[0,1] op_sel_hi:[1,0] neg_hi:[0,1]
    v_pk_add_f32 v[18:19], v[32:33], v[36:37] op_sel:[0,1] op_sel_hi:[1,0] neg_lo:[0,1]
    v_pk_add_f32 v[20:21], v[34:35], v[38:39]
    v_pk_add_f32 v[22:23], v[34:35], v[38:39] neg_lo:[0,1] neg_hi:[0,1]
    v_pk_add_f32 v[24:25], v[8:9], v[12:13]
    v_pk_add_f32 v[32:33], v[8:9], v[12:13] neg_lo:[0,1] neg_hi:[0,1]
    v_pk_add_f32 v[28:29], v[10:11], v[14:15] op_sel:[0,1] op_sel_hi:[1,0] neg_hi:[0,1]
    v_pk_add_f32 v[36:37], v[10:11], v[14:15] op_sel:[0,1] op_sel_hi:[1,0] neg_lo:[0,1]
    v_pk_add_f32 v[26:27], v[16:17], v[20:21]
    v_pk_add_f32 v[34:35], v[16:17], v[20:21] neg_lo:[0,1] neg_hi:[0,1]
    v_pk_add_f32 v[30:31], v[18:19], v[22:23] op_sel:[0,1] op_sel_hi:[1,0] neg_hi:[0,1]
    v_pk_add_f32 v[38:39], v[18:19], v[22:23] op_sel:[0,1] op_sel_hi:[1,0] neg_lo:[0,1]
    v_pk_mul_f32 v[10:11], v[26:27], v[58:59] op_sel:[0,0] op_sel_hi:[1,0]
    v_pk_fma_f32 v[10:11], v[26:27], v[58:59], v[10:11] op_sel:[1,1,0] op_sel_hi:[0,1,1] neg_lo:[1,0,0]
    v_pk_mul_f32 v[12:13], v[28:29], v[60:61] op_sel:[0,0] op_sel_hi:[1,0]
    v_pk_fma_f32 v[12:13], v[28:29], v[60:61], v[12:13] op_sel:[1,1,0] op_sel_hi:[0,1,1] neg_lo:[1,0,0]
    v_pk_mul_f32 v[14:15], v[30:31], v[62:63] op_sel:[0,0] op_sel_hi:[1,0]
    v_pk_fma_f32 v[14:15], v[30:31], v[62:63], v[14:15] op_sel:[1,1,0] op_sel_hi:[0,1,1] neg_lo:[1,0,0]
    v_pk_mul_f32 v[16:17], v[32:33], v[64:65] op_sel:[0,0] op_sel_hi:[1,0]
    v_pk_fma_f32 v[16:17], v[32:33], v[64:65], v[16:17] op_sel:[1,1,0] op_sel_hi:[0,1,1] neg_lo:[1,0,0]
    v_pk_mul_f32 v[18:19], v[34:35], v[66:67] op_sel:[0,0] op_sel_hi:[1,0]
    v_pk_fma_f32 v[18:19], v[34:35], v[66:67], v[18:19] op_sel:[1,1,0] op_sel_hi:[0,1,1] neg_lo:[1,0,0]
    v_pk_mul_f32 v[20:21], v[36:37], v[68:69] op_sel:[0,0] op_sel_hi:[1,0]
    v_pk_fma_f32 v[20:21], v[36:37], v[68:69], v[20:21] op_sel:[1,1,0] op_sel_hi:[0,1,1] neg_lo:[1,0,0]
    v_pk_mul_f32 v[22:23], v[38:39], v[70:71] op_sel:[0,0] op_sel_hi:[1,0]
    v_pk_fma_f32 v[22:23], v[38:39], v[70:71], v[22:23] op_sel:[1,1,0] op_sel_hi:[0,1,1] neg_lo:[1,0,0]
    ds_write_b64 v86, v[24:25]
    ds_write_b64 v86, v[10:11] offset:72
    ds_write_b64 v86, v[12:13] offset:144
    ds_write_b64 v86, v[14:15] offset:216
    ds_write_b64 v86, v[16:17] offset:288
    ds_write_b64 v86, v[18:19] offset:360
    ds_write_b64 v86, v[20:21] offset:432
    ds_write_b64 v86, v[22:23] offset:504
    ds_read_b64 v[8:9], v87 offset:0
    ds_read_b64 v[10:11], v87 offset:8
    ds_read_b64 v[12:13], v87 offset:16
    ds_read_b64 v[14:15], v87 offset:24
    ds_read_b64 v[16:17], v87 offset:32
    ds_read_b64 v[18:19], v87 offset:40
    ds_read_b64 v[20:21], v87 offset:48
    ds_read_b64 v[22:23], v87 offset:56
    s_waitcnt lgkmcnt(0)
    v_pk_add_f32 v[24:25], v[8:9], v[16:17]
    v_pk_add_f32 v[32:33], v[8:9], v[16:17] neg_lo:[0,1] neg_hi:[0,1]
    v_pk_add_f32 v[26:27], v[10:11], v[18:19]
    v_pk_add_f32 v[34:35], v[10:11], v[18:19] neg_lo:[0,1] neg_hi:[0,1]
    v_pk_add_f32 v[28:29], v[12:13], v[20:21]
    v_pk_add_f32 v[36:37], v[12:13], v[20:21] neg_lo:[0,1] neg_hi:[0,1]
    v_pk_add_f32 v[30:31], v[14:15], v[22:23]
    v_pk_add_f32 v[38:39], v[14:15], v[22:23] neg_lo:[0,1] neg_hi:[0,1]
    v_pk_add_f32 v[8:9], v[34:35], v[34:35] op_sel:[0,1] op_sel_hi:[1,0] neg_hi:[0,1]
    v_pk_mul_f32 v[34:35], v[8:9], s[64:65]
    v_pk_add_f32 v[10:11], v[38:39], v[38:39] op_sel:[0,1] op_sel_hi:[1,0] neg_lo:[0,1]
    v_pk_mul_f32 v[38:39], v[10:11], s[64:65] neg_lo:[1,0] neg_hi:[1,0]
    v_pk_add_f32 v[8:9], v[24:25], v[28:29]
    v_pk_add_f32 v[10:11], v[24:25], v[28:29] neg_lo:[0,1] neg_hi:[0,1]
    v_pk_add_f32 v[12:13], v[26:27], v[30:31]
    v_pk_add_f32 v[14:15], v[26:27], v[30:31] neg_lo:[0,1] neg_hi:[0,1]
    v_pk_add_f32 v[16:17], v[32:33], v[36:37] op_sel:[0,1] op_sel_hi:[1,0] neg_hi:[0,1]
    v_pk_add_f32 v[18:19], v[32:33], v[36:37] op_sel:[0,1] op_sel_hi:[1,0] neg_lo:[0,1]
    v_pk_add_f32 v[20:21], v[34:35], v[38:39]
    v_pk_add_f32 v[22:23], v[34:35], v[38:39] neg_lo:[0,1] neg_hi:[0,1]
    v_pk_add_f32 v[24:25], v[8:9], v[12:13]
    v_pk_add_f32 v[32:33], v[8:9], v[12:13] neg_lo:[0,1] neg_hi:[0,1]
    v_pk_add_f32 v[28:29], v[10:11], v[14:15] op_sel:[0,1] op_sel_hi:[1,0] neg_hi:[0,1]
    v_pk_add_f32 v[36:37], v[10:11], v[14:15] op_sel:[0,1] op_sel_hi:[1,0] neg_lo:[0,1]
    v_pk_add_f32 v[26:27], v[16:17], v[20:21]
    v_pk_add_f32 v[34:35], v[16:17], v[20:21] neg_lo:[0,1] neg_hi:[0,1]
    v_pk_add_f32 v[30:31], v[18:19], v[22:23] op_sel:[0,1] op_sel_hi:[1,0] neg_hi:[0,1]
    v_pk_add_f32 v[38:39], v[18:19], v[22:23] op_sel:[0,1] op_sel_hi:[1,0] neg_lo:[0,1]
    ds_write_b64 v88, v[24:25] offset:0
    ds_write_b64 v88, v[26:27] offset:512
    ds_write_b64 v88, v[28:29] offset:1024
    ds_write_b64 v88, v[30:31] offset:1536
    ds_write_b64 v88, v[32:33] offset:2048
    ds_write_b64 v88, v[34:35] offset:2560
    ds_write_b64 v88, v[36:37] offset:3072
    ds_write_b64 v88, v[38:39] offset:3584
    ds_write_b64 v88, v[32:33] offset:4096
    v_lshrrev_b32 v5, 2, v0
    v_and_b32 v6, 3, v0
    v_mul_u32_u24 v7, 4928, v6
    v_add_u32 v7, 0, v7
    v_lshlrev_b32 v84, 3, v5
    v_add_u32 v84, v84, v7
    v_sub_u32 v85, 320, v5
    v_lshlrev_b32 v85, 3, v85
    v_add_u32 v85, v85, v7
    s_waitcnt lgkmcnt(0)
    s_barrier
    ds_read_b64 v[8:9], v84 offset:0
    ds_read_b64 v[16:17], v85 offset:1536
    ds_read_b64 v[10:11], v84 offset:512
    ds_read_b64 v[18:19], v85 offset:1024
    ds_read_b64 v[12:13], v84 offset:1024
    ds_read_b64 v[20:21], v85 offset:512
    ds_read_b64 v[14:15], v84 offset:1536
    ds_read_b64 v[22:23], v85 offset:0
    v_cmp_eq_u32 vcc, 0, v5
    v_lshlrev_b32 v5, 4, v0
    s_mul_i32 s3, s49, 16640
    s_waitcnt lgkmcnt(0)
    v_pk_add_f32 v[24:25], v[8:9], v[16:17] neg_hi:[0,1]
    v_pk_add_f32 v[26:27], v[8:9], v[16:17] op_sel:[1,1] op_sel_hi:[0,0] neg_hi:[1,0]
    v_pk_add_f32 v[28:29], v[10:11], v[18:19] neg_hi:[0,1]
    v_pk_add_f32 v[30:31], v[10:11], v[18:19] op_sel:[1,1] op_sel_hi:[0,0] neg_hi:[1,0]
    v_pk_add_f32 v[32:33], v[12:13], v[20:21] neg_hi:[0,1]
    v_pk_add_f32 v[34:35], v[12:13], v[20:21] op_sel:[1,1] op_sel_hi:[0,0] neg_hi:[1,0]
    v_pk_add_f32 v[36:37], v[14:15], v[22:23] neg_hi:[0,1]
    v_pk_add_f32 v[38:39], v[14:15], v[22:23] op_sel:[1,1] op_sel_hi:[0,0] neg_hi:[1,0]
    v_add_f32 v72, v8, v8
    v_add_f32 v73, v16, v16
    v_add_f32 v74, v9, v9
    v_add_f32 v75, v17, v17
    v_cndmask_b32 v24, v24, v72, vcc
    v_cndmask_b32 v25, v25, v73, vcc
    v_cndmask_b32 v26, v26, v74, vcc
    v_cndmask_b32 v27, v27, v75, vcc
    s_add_u32 s62, s3, 4096
    buffer_store_dwordx4 v[28:31], v5, s[28:31], s62 offen sc0 sc1
    s_add_u32 s62, s3, 8192
    buffer_store_dwordx4 v[32:35], v5, s[28:31], s62 offen sc0 sc1
    s_add_u32 s62, s3, 12288
    buffer_store_dwordx4 v[36:39], v5, s[28:31], s62 offen sc0 sc1
    s_add_u32 s62, s3, 0
    buffer_store_dwordx4 v[24:27], v5, s[28:31], s62 offen sc0 sc1
    s_endpgm
    s_nop 0
L_k0_aux:
    v_lshlrev_b32 v6, 1, v1
    s_mov_b32 s48, s2
    s_and_b32 s62, s48, 0xfc
    s_add_u32 s62, s62, s51
    s_lshr_b32 s63, s62, 5
    s_lshr_b32 s3, s62, 2
    s_and_b32 s3, s3, 7
    s_lshl_b32 s3, s3, 3
    s_add_u32 s63, s63, s3
    s_and_b32 s3, s62, 3
    s_lshl_b32 s3, s3, 7
    s_add_u32 s63, s63, s3
    s_mov_b32 s61, s63
    s_mul_i32 s63, s63, 514
    s_and_b32 s66, s48, 3
    s_lshl_b32 s66, s66, 7
    s_add_u32 s66, s66, s63
    v_and_b32 v24, 1, v1
    s_and_b32 s3, s48, 3
    s_lshl_b32 s3, s3, 1
    v_add_u32 v24, s3, v24
    v_lshrrev_b32 v25, 2, v24
    v_lshlrev_b32 v25, 6, v25
    v_and_b32 v26, 3, v24
    v_lshl_add_u32 v25, v26, 9, v25
    v_add_u32 v25, s61, v25
    v_sub_u32 v26, 2048, v25
    v_and_b32 v26, 2047, v26
    v_mul_u32_u24 v25, 514, v25
    v_mul_u32_u24 v26, 514, v26
    s_lshl_b32 s67, s2, 2
    s_add_u32 s67, s67, s51
    v_and_b32 v7, 31, v1
    v_lshlrev_b32 v7, 1, v7
    v_lshrrev_b32 v2, 5, v1
    v_lshlrev_b32 v2, 12, v2
    v_add_u32 v7, v7, v2
    v_add_u32 v2, 0x2000, v7
    v_and_b32 v4, 31, v1
    v_min_u32 v4, 23, v4
    v_lshlrev_b32 v4, 6, v4
    v_lshrrev_b32 v5, 5, v1
    v_mul_u32_u24 v5, 2752, v5
    v_add_u32 v4, v4, v5
    s_lshr_b32 s70, s2, 3
    s_and_b32 s70, s70, 31
    s_lshl_b32 s70, s70, 2
    s_add_u32 s70, s70, s51
    s_mul_i32 s70, s70, 11008
    s_and_b32 s3, s2, 4
    s_mul_i32 s3, s3, 384
    s_add_u32 s70, s70, s3
    s_add_u32 s71, s70, 5504
    s_waitcnt lgkmcnt(0)
    s_mov_b32 s32, s6
    s_and_b32 s33, s7, 0xffff
    s_mov_b32 s34, 0x101000
    s_mov_b32 s35, 0x00020000
    s_mov_b32 s36, s8
    s_and_b32 s37, s9, 0xffff
    s_mov_b32 s38, 0x101000
    s_mov_b32 s39, 0x00020000
    s_add_u32 s3, s66, 0
    buffer_load_ushort v8, v6, s[32:35], s3 offen
    buffer_load_ushort v9, v6, s[36:39], s3 offen
    s_add_u32 s3, s66, 263168
    buffer_load_ushort v10, v6, s[32:35], s3 offen
    buffer_load_ushort v11, v6, s[36:39], s3 offen
    s_add_u32 s3, s66, 526336
    buffer_load_ushort v12, v6, s[32:35], s3 offen
    buffer_load_ushort v13, v6, s[36:39], s3 offen
    s_add_u32 s3, s66, 789504
    buffer_load_ushort v14, v6, s[32:35], s3 offen
    buffer_load_ushort v15, v6, s[36:39], s3 offen
    s_add_u32 s3, s66, 32896
    buffer_load_ushort v16, v6, s[32:35], s3 offen
    buffer_load_ushort v17, v6, s[36:39], s3 offen
    s_add_u32 s3, s66, 296064
    buffer_load_ushort v18, v6, s[32:35], s3 offen
    buffer_load_ushort v19, v6, s[36:39], s3 offen
    s_add_u32 s3, s66, 559232
    buffer_load_ushort v20, v6, s[32:35], s3 offen
    buffer_load_ushort v21, v6, s[36:39], s3 offen
    s_add_u32 s3, s66, 822400
    buffer_load_ushort v22, v6, s[32:35], s3 offen
    buffer_load_ushort v23, v6, s[36:39], s3 offen
    buffer_load_ushort v30, v25, s[32:35], 0 offen offset:0
    buffer_load_ushort v31, v25, s[36:39], 0 offen offset:0
    buffer_load_ushort v32, v25, s[32:35], 0 offen offset:512
    buffer_load_ushort v33, v25, s[36:39], 0 offen offset:512
    buffer_load_ushort v34, v26, s[32:35], 0 offen offset:0
    buffer_load_ushort v35, v26, s[36:39], 0 offen offset:0
    buffer_load_ushort v36, v26, s[32:35], 0 offen offset:512
    buffer_load_ushort v37, v26, s[36:39], 0 offen offset:512
    s_mov_b32 s44, s14
    s_and_b32 s45, s15, 0xffff
    s_mov_b32 s46, 0x158000
    s_mov_b32 s47, 0x00020000
    s_cmp_eq_u32 s51, 1
    s_cselect_b32 s64, s2, 255
    s_lshr_b32 s3, s14, 7
    s_sub_u32 s3, 3, s3
    s_and_b32 s3, s3, 7
    s_lshl_b32 s3, s3, 7
    s_lshl_b32 s65, s64, 13
    s_add_u32 s65, s65, s3
    s_lshl_b32 s64, s64, 11
    v_lshrrev_b32 v76, 3, v1
    v_and_b32 v77, 7, v1
    v_lshlrev_b32 v77, 4, v77
    v_lshl_add_u32 v78, v76, 10, v77
    v_lshl_add_u32 v77, v76, 8, v77
    buffer_load_dwordx4 v[72:75], v78, s[44:47], s65 offen
    s_cmp_lt_u32 s67, 512
    s_cselect_b32 s72, s10, s12
    s_cselect_b32 s73, s11, s13
    s_and_b32 s73, s73, 0xffff
    s_mov_b32 s74, 1409024
    s_mov_b32 s75, 0x00020000
    v_min_u32 v4, 42, v1
    v_lshlrev_b32 v4, 6, v4
    s_and_b32 s70, s67, 511
    s_mul_i32 s70, s70, 2752
    buffer_load_dword v62, v4, s[72:75], s70 offen
    s_getpc_b64 s[72:73]
L_k0_pc2:
    s_add_u32 s72, s72, k1_kernel-L_k0_pc2
    s_addc_u32 s73, s73, 0
    s_and_b32 s73, s73, 0xffff
    s_mov_b32 s74, TWTAB+23296-k1_kernel
    s_mov_b32 s75, 0x00020000
    v_and_b32 v5, 15, v1
    v_lshlrev_b32 v5, 6, v5
    s_lshr_b32 s70, s2, 3
    s_and_b32 s70, s70, 31
    s_lshl_b32 s70, s70, 2
    s_add_u32 s70, s70, s51
    s_lshl_b32 s70, s70, 10
    buffer_load_dword v66, v5, s[72:75], s70 offen
    v_min_u32 v5, 10, v1
    v_lshlrev_b32 v5, 7, v5
    s_mul_i32 s70, s67, 1408
    buffer_load_dword v67, v5, s[44:47], s70 offen
    s_add_u32 s40, s16, 0x1580000
    s_addc_u32 s41, s17, 0
    s_and_b32 s41, s41, 0xffff
    s_mov_b32 s42, 0x208000
    s_mov_b32 s43, 0x00020000
    s_add_u32 s24, s16, 0x1500000
    s_addc_u32 s25, s17, 0
    s_and_b32 s25, s25, 0xffff
    s_mov_b32 s26, 0x56000
    s_mov_b32 s27, 0x00020000
    s_add_u32 s28, s16, 0x1c00000
    s_addc_u32 s29, s17, 0
    s_and_b32 s29, s29, 0xffff
    s_mov_b32 s30, 0x200000
    s_mov_b32 s31, 0x00020000
    v_mul_u32_u24 v6, 144, v1
    s_lshl_b32 s3, s51, 5
    s_add_u32 s3, s3, 19712
    v_add_u32 v6, s3, v6
    s_waitcnt vmcnt(4)
    v_lshl_or_b32 v46, v9, 16, v8
    v_lshl_or_b32 v47, v11, 16, v10
    v_lshl_or_b32 v48, v13, 16, v12
    v_lshl_or_b32 v49, v15, 16, v14
    v_lshl_or_b32 v50, v17, 16, v16
    v_lshl_or_b32 v51, v19, 16, v18
    v_lshl_or_b32 v52, v21, 16, v20
    v_lshl_or_b32 v53, v23, 16, v22
    ds_write_b128 v6, v[46:49]
    ds_write_b128 v6, v[50:53] offset:16
    v_lshlrev_b32 v30, 16, v30
    v_lshlrev_b32 v31, 16, v31
    v_lshlrev_b32 v32, 16, v32
    v_lshlrev_b32 v33, 16, v33
    v_lshlrev_b32 v34, 16, v34
    v_lshlrev_b32 v35, 16, v35
    v_lshlrev_b32 v36, 16, v36
    v_lshlrev_b32 v37, 16, v37
    v_add_f32 v30, v30, v34
    v_sub_f32 v31, v31, v35
    v_add_f32 v32, v32, v36
    v_sub_f32 v33, v33, v37
    v_add_f32 v38, v30, v32
    v_add_f32 v39, v31, v33
    v_sub_f32 v40, v30, v32
    v_sub_f32 v41, v31, v33
    v_mul_f32 v38, 0.25, v38
    v_mul_f32 v39, 0.25, v39
    v_mul_f32 v40, 0.25, v40
    v_mul_f32 v41, 0.25, v41
    v_lshlrev_b32 v24, 4, v24
    s_lshl_b32 s69, s62, 7
    s_add_u32 s69, s69, 2097152
    s_mov_b64 exec, 3
    buffer_store_dwordx4 v[38:41], v24, s[40:43], s69 offen sc0 sc1
    s_mov_b64 exec, -1
    v_lshrrev_b32 v5, 3, v1
    v_and_b32 v6, 7, v1
    s_lshl_b32 s3, s51, 4
    v_add_u32 v5, s3, v5
    v_mul_u32_u24 v7, 144, v5
    v_lshlrev_b32 v8, 4, v6
    v_add_u32 v7, v7, v8
    v_add_u32 v7, 19712, v7
    v_lshlrev_b32 v5, 13, v5
    v_add_u32 v5, v5, v8
    s_and_b32 s62, s48, 3
    s_lshl_b32 s62, s62, 19
    s_lshr_b32 s63, s48, 2
    s_lshl_b32 s63, s63, 7
    s_add_u32 s62, s62, s63
    s_add_u32 s63, s62, 0x10000
    v_lshrrev_b32 v9, 3, v1
    s_lshl_b32 s3, s51, 3
    v_add_u32 v9, s3, v9
    v_mul_u32_u24 v10, 1040, v6
    v_lshl_add_u32 v10, v9, 4, v10
    v_add_u32 v10, 28928, v10
    v_lshrrev_b32 v11, 1, v9
    v_lshlrev_b32 v11, 10, v11
    v_and_b32 v9, 1, v9
    v_lshl_add_u32 v11, v9, 9, v11
    v_add_u32 v11, v11, v8
    s_lshr_b32 s66, s49, 2
    s_lshl_b32 s66, s66, 15
    s_and_b32 s3, s49, 3
    s_lshl_b32 s3, s3, 7
    s_add_u32 s66, s66, s3
    s_add_u32 s68, s66, 0x4000
    s_lshl_b32 s3, s51, 8
    s_add_u32 s3, s3, s2
    s_cmp_lt_u32 s3, 32
    s_cbranch_scc0 L_k0_nf
    s_add_u32 s20, s16, 0x1e00000
    s_addc_u32 s21, s17, 0
    s_and_b32 s21, s21, 0xffff
    s_mov_b32 s22, 0x100000
    s_mov_b32 s23, 0x00020000
    v_mov_b32 v68, 0
    v_mov_b32 v69, 0
    v_mov_b32 v70, 0
    v_mov_b32 v71, 0
    s_mul_i32 s3, s2, 4352
    s_mov_b64 exec, 0xffff
    s_add_u32 s70, s3, 263168
    buffer_store_dwordx4 v[68:71], v3, s[20:23], s70 offen sc0 sc1
    s_add_u32 s70, s3, 526336
    buffer_store_dwordx4 v[68:71], v3, s[20:23], s70 offen sc0 sc1
    s_add_u32 s70, s3, 789504
    buffer_store_dwordx4 v[68:71], v3, s[20:23], s70 offen sc0 sc1
    s_mov_b64 exec, -1
    s_lshl_b32 s70, s2, 10
    s_add_u32 s70, s70, 0
    buffer_store_dwordx4 v[68:71], v3, s[20:23], s70 offen sc0 sc1
    s_nop 1
L_k0_nf:
    s_waitcnt lgkmcnt(0)
    s_barrier
    ds_read_b128 v[12:15], v10
    ds_read_b128 v[16:19], v10 offset:512
    ds_read_b128 v[20:23], v7
    ds_read_b128 v[24:27], v7 offset:1152
    s_waitcnt lgkmcnt(2)
    buffer_store_dwordx4 v[12:15], v11, s[28:31], s66 offen sc0 sc1
    buffer_store_dwordx4 v[16:19], v11, s[28:31], s68 offen sc0 sc1
    s_waitcnt lgkmcnt(0)
    buffer_store_dwordx4 v[20:23], v5, s[40:43], s62 offen sc0 sc1
    buffer_store_dwordx4 v[24:27], v5, s[40:43], s63 offen sc0 sc1
    s_waitcnt vmcnt(4)
    buffer_store_dwordx4 v[72:75], v77, s[24:27], s64 offen sc0 sc1
    s_endpgm
    s_nop 0
L_k0_exit:
    s_endpgm
.globl k1_kernel
.p2align 8
.type k1_kernel,@function
k1_kernel:
    s_cmp_ge_u32 s2, 512
    s_cbranch_scc1 L_k1_exit
    s_cmp_ge_u32 s2, 256
    s_cbranch_scc1 L_k1_col
    s_setprio 1
    s_load_dwordx2 s[10:11], s[0:1], 32
    s_load_dwordx2 s[12:13], s[0:1], 40
    s_load_dwordx2 s[16:17], s[0:1], 72
    s_load_dwordx2 s[14:15], s[0:1], 48
    s_load_dwordx2 s[4:5], s[0:1], 0
    s_load_dwordx2 s[6:7], s[0:1], 56
    s_and_b32 s70, s2, 3
    s_lshl_b32 s70, s70, 2
    s_lshr_b32 s3, s2, 3
    s_and_b32 s3, s3, 3
    s_add_u32 s70, s70, s3
    s_and_b32 s71, s2, 4
    s_lshl_b32 s71, s71, 1
    s_lshr_b32 s3, s2, 5
    s_add_u32 s71, s71, s3
    v_and_b32 v1, 63, v0
    v_lshrrev_b32 v2, 6, v0
    s_nop 0
    v_readfirstlane_b32 s50, v2
    v_lshlrev_b32 v3, 4, v1
    v_add_u32 v5, 640, v3
    v_lshrrev_b32 v5, 10, v5
    v_lshl_add_u32 v2, v5, 7, v3
    v_add_u32 v8, 0, v1
    v_mul_u32_u24 v5, 0x5556, v8
    v_lshrrev_b32 v5, 18, v5
    v_mul_u32_u24 v6, 12, v5
    v_sub_u32 v6, v8, v6
    v_mul_u32_u24 v5, 2752, v5
    v_lshl_add_u32 v8, v6, 4, v5
    v_add_u32 v9, 64, v1
    v_mul_u32_u24 v5, 0x5556, v9
    v_lshrrev_b32 v5, 18, v5
    v_mul_u32_u24 v6, 12, v5
    v_sub_u32 v6, v9, v6
    v_mul_u32_u24 v5, 2752, v5
    v_lshl_add_u32 v9, v6, 4, v5
    v_add_u32 v10, 128, v1
    v_mul_u32_u24 v5, 0x5556, v10
    v_lshrrev_b32 v5, 18, v5
    v_mul_u32_u24 v6, 12, v5
    v_sub_u32 v6, v10, v6
    v_mul_u32_u24 v5, 2752, v5
    v_lshl_add_u32 v10, v6, 4, v5
    s_lshr_b32 s55, s50, 1
    s_and_b32 s56, s50, 1
    s_mul_i32 s57, s56, 44032
    s_mul_i32 s59, s71, 6
    s_min_u32 s59, s59, 80
    s_lshl_b32 s60, s59, 5
    s_add_u32 s57, s57, s60
    s_mul_i32 s58, s55, 6176
    s_mul_i32 s60, s56, 3072
    s_add_u32 s58, s58, s60
    s_lshl_b32 s54, s70, 2
    s_add_u32 s54, s54, s50
    s_lshl_b32 s53, s54, 15
    v_lshrrev_b32 v5, 4, v1
    v_and_b32 v6, 1, v5
    v_lshrrev_b32 v5, 1, v5
    v_and_b32 v7, 15, v1
    v_lshrrev_b32 v13, 2, v7
    v_and_b32 v7, 3, v7
    v_lshlrev_b32 v16, 9, v5
    v_lshl_add_u32 v16, v13, 6, v16
    v_lshl_add_u32 v16, v6, 5, v16
    v_lshl_add_u32 v16, v7, 3, v16
    s_mul_i32 s62, s50, 18432
    v_add_u32 v16, s62, v16
    v_lshl_add_u32 v5, v5, 3, v13
    v_mul_u32_u24 v5, 192, v5
    v_mul_u32_u24 v6, 6176, v6
    v_add_u32 v5, v5, v6
    v_lshl_add_u32 v11, v7, 3, v5
    v_add_u32 v12, 37056, v11
    v_lshrrev_b32 v5, 5, v1
    v_bfe_u32 v18, v1, 2, 2
    v_lshl_add_u32 v18, v5, 2, v18
    v_bfe_u32 v5, v1, 4, 1
    v_lshlrev_b32 v17, 6, v5
    v_and_b32 v5, 3, v1
    v_lshl_add_u32 v17, v5, 4, v17
    s_and_b32 s51, s2, 3
    s_lshl_b32 s51, s51, 3
    s_and_b32 s3, s2, 4
    s_add_u32 s51, s51, s3
    s_lshr_b32 s3, s2, 3
    s_and_b32 s3, s3, 3
    s_add_u32 s51, s51, s3
    s_lshr_b32 s52, s2, 5
    s_mul_i32 s63, s50, 22
    s_lshl_b32 s64, s63, 14
    s_lshl_b32 s3, s52, 7
    s_add_u32 s64, s64, s3
    s_lshl_b32 s65, s63, 17
    s_lshl_b32 s3, s51, 12
    s_add_u32 s65, s65, s3
    s_cmp_eq_u32 s55, 0
    s_waitcnt lgkmcnt(0)
    s_cselect_b32 s72, s10, s12
    s_cselect_b32 s73, s11, s13
    s_and_b32 s73, s73, 0xffff
    s_mov_b32 s74, 1409024
    s_mov_b32 s75, 0x00020000
    s_add_u32 s20, s16, 0x1c00000
    s_addc_u32 s21, s17, 0
    s_and_b32 s21, s21, 0xffff
    s_mov_b32 s22, 0x200000
    s_mov_b32 s23, 0x00020000
    s_add_u32 s76, s16, 0xa00000
    s_addc_u32 s77, s17, 0
    s_and_b32 s77, s77, 0xffff
    s_mov_b32 s78, 0xac0000
    s_mov_b32 s79, 0x00020000
    s_mov_b32 s24, s14
    s_and_b32 s25, s15, 0xffff
    s_mov_b32 s26, 0x158000
    s_mov_b32 s27, 0x00020000
    s_movk_i32 s44, 0x2000
    s_lshl_b32 s45, s52, 7
    s_add_u32 s45, s45, 1400832
    s_mov_b32 s46, 10
    s_lshr_b32 s3, s14, 7
    s_sub_u32 s3, 3, s3
    s_and_b32 s3, s3, 7
    s_cmp_lg_u32 s3, s52
    s_cbranch_scc1 L_g_wdn
    s_add_u32 s24, s16, 0x1500000
    s_addc_u32 s25, s17, 0
    s_and_b32 s25, s25, 0xffff
    s_mov_b32 s26, 0x56000
    s_mov_b32 s27, 0x00020000
    s_movk_i32 s44, 0x800
    s_mov_b32 s45, 350208
    s_mov_b32 s46, 8
    s_lshl_b32 s64, s63, 12
L_g_wdn:
    v_lshlrev_b32 v18, s46, v18
    v_add_u32 v17, v17, v18
    s_add_u32 s32, s16, 0x1e00000
    s_addc_u32 s33, s17, 0
    s_and_b32 s33, s33, 0xffff
    s_mov_b32 s34, 0x100000
    s_mov_b32 s35, 0x00020000
    s_cmp_ge_u32 s71, 15
    s_cbranch_scc1 L_g_b
    s_add_u32 m0, s58, 0
    s_nop 0
    buffer_load_dwordx4 v8, s[72:75], s57 offen lds
    s_add_u32 m0, s58, 1024
    s_nop 0
    buffer_load_dwordx4 v9, s[72:75], s57 offen lds
    s_add_u32 m0, s58, 2048
    s_nop 0
    buffer_load_dwordx4 v10, s[72:75], s57 offen lds
    s_add_u32 s57, s57, 88064
    buffer_load_dwordx4 v[176:179], v3, s[20:23], s53 offen offset:0
    buffer_load_dwordx4 v[180:183], v3, s[20:23], s53 offen offset:1024
    s_add_u32 m0, s58, 12352
    s_nop 0
    buffer_load_dwordx4 v8, s[72:75], s57 offen lds
    s_add_u32 m0, s58, 13376
    s_nop 0
    buffer_load_dwordx4 v9, s[72:75], s57 offen lds
    s_add_u32 m0, s58, 14400
    s_nop 0
    buffer_load_dwordx4 v10, s[72:75], s57 offen lds
    s_add_u32 s57, s57, 88064
    buffer_load_dwordx4 v[184:187], v3, s[20:23], s53 offen offset:2048
    buffer_load_dwordx4 v[188:191], v3, s[20:23], s53 offen offset:3072
    s_add_u32 s53, s53, 4096
    s_lshl_b32 s59, s59, 17
    s_lshl_b32 s60, s54, 11
    s_add_u32 s59, s59, s60
    v_mov_b32 v14, 0xc0135761
    v_mov_b32 v15, 0xc0135761
    s_mov_b32 s60, 0xbdd2d3e8
    s_mov_b32 s61, 0xbdd2d3e8
    s_add_u32 m0, s58, 24704
    s_nop 0
    buffer_load_dwordx4 v8, s[72:75], s57 offen lds
    s_add_u32 m0, s58, 25728
    s_nop 0
    buffer_load_dwordx4 v9, s[72:75], s57 offen lds
    s_add_u32 m0, s58, 26752
    s_nop 0
    buffer_load_dwordx4 v10, s[72:75], s57 offen lds
    s_add_u32 s57, s57, 88064
    buffer_load_dwordx4 v[192:195], v3, s[20:23], s53 offen offset:0
    buffer_load_dwordx4 v[196:199], v3, s[20:23], s53 offen offset:1024
    s_waitcnt vmcnt(12)
    s_barrier
    ds_read_b64_tr_b16 v[128:129], v11 offset:0
    ds_read_b64_tr_b16 v[130:131], v11 offset:768
    ds_read_b64_tr_b16 v[132:133], v11 offset:32
    ds_read_b64_tr_b16 v[134:135], v11 offset:800
    ds_read_b64_tr_b16 v[136:137], v11 offset:64
    ds_read_b64_tr_b16 v[138:139], v11 offset:832
    ds_read_b64_tr_b16 v[140:141], v11 offset:96
    ds_read_b64_tr_b16 v[142:143], v11 offset:864
    ds_read_b64_tr_b16 v[144:145], v11 offset:128
    ds_read_b64_tr_b16 v[146:147], v11 offset:896
    ds_read_b64_tr_b16 v[148:149], v11 offset:160
    ds_read_b64_tr_b16 v[150:151], v11 offset:928
    s_waitcnt vmcnt(11)
    s_waitcnt lgkmcnt(10)
    v_mfma_f32_32x32x16_bf16 v[32:47], v[128:131], v[176:179], 0
    ds_read_b64_tr_b16 v[152:153], v11 offset:3072
    ds_read_b64_tr_b16 v[154:155], v11 offset:3840
    s_waitcnt lgkmcnt(10)
    v_mfma_f32_32x32x16_bf16 v[48:63], v[132:135], v[176:179], 0
    ds_read_b64_tr_b16 v[156:157], v11 offset:3104
    ds_read_b64_tr_b16 v[158:159], v11 offset:3872
    s_add_u32 m0, s58, 37056
    s_nop 0
    buffer_load_dwordx4 v8, s[72:75], s57 offen lds
    s_waitcnt lgkmcnt(10)
    v_mfma_f32_32x32x16_bf16 v[64:79], v[136:139], v[176:179], 0
    ds_read_b64_tr_b16 v[160:161], v11 offset:3136
    ds_read_b64_tr_b16 v[162:163], v11 offset:3904
    s_waitcnt lgkmcnt(10)
    v_mfma_f32_32x32x16_bf16 v[80:95], v[140:143], v[176:179], 0
    ds_read_b64_tr_b16 v[164:165], v11 offset:3168
    ds_read_b64_tr_b16 v[166:167], v11 offset:3936
    s_add_u32 m0, s58, 38080
    s_nop 0
    buffer_load_dwordx4 v9, s[72:75], s57 offen lds
    s_waitcnt lgkmcnt(10)
    v_mfma_f32_32x32x16_bf16 v[96:111], v[144:147], v[176:179], 0
    ds_read_b64_tr_b16 v[168:169], v11 offset:3200
    ds_read_b64_tr_b16 v[170:171], v11 offset:3968
    s_waitcnt lgkmcnt(10)
    v_mfma_f32_32x32x16_bf16 v[112:127], v[148:151], v[176:179], 0
    ds_read_b64_tr_b16 v[172:173], v11 offset:3232
    ds_read_b64_tr_b16 v[174:175], v11 offset:4000
    s_add_u32 m0, s58, 39104
    s_nop 0
    buffer_load_dwordx4 v10, s[72:75], s57 offen lds
    s_add_u32 s57, s57, 88064
    s_waitcnt vmcnt(10)
    s_barrier
    s_waitcnt lgkmcnt(10)
    v_mfma_f32_32x32x16_bf16 v[32:47], v[152:155], v[180:183], v[32:47]
    ds_read_b64_tr_b16 v[128:129], v11 offset:12352
    ds_read_b64_tr_b16 v[130:131], v11 offset:13120
    s_waitcnt lgkmcnt(10)
    v_mfma_f32_32x32x16_bf16 v[48:63], v[156:159], v[180:183], v[48:63]
    ds_read_b64_tr_b16 v[132:133], v11 offset:12384
    ds_read_b64_tr_b16 v[134:135], v11 offset:13152
    buffer_load_dwordx4 v[200:203], v3, s[20:23], s53 offen offset:2048
    s_waitcnt lgkmcnt(10)
    v_mfma_f32_32x32x16_bf16 v[64:79], v[160:163], v[180:183], v[64:79]
    ds_read_b64_tr_b16 v[136:137], v11 offset:12416
    ds_read_b64_tr_b16 v[138:139], v11 offset:13184
    s_waitcnt lgkmcnt(10)
    v_mfma_f32_32x32x16_bf16 v[80:95], v[164:167], v[180:183], v[80:95]
    ds_read_b64_tr_b16 v[140:141], v11 offset:12448
    ds_read_b64_tr_b16 v[142:143], v11 offset:13216
    buffer_load_dwordx4 v[204:207], v3, s[20:23], s53 offen offset:3072
    s_add_u32 s53, s53, 4096
    s_waitcnt lgkmcnt(10)
    v_mfma_f32_32x32x16_bf16 v[96:111], v[168:171], v[180:183], v[96:111]
    ds_read_b64_tr_b16 v[144:145], v11 offset:12480
    ds_read_b64_tr_b16 v[146:147], v11 offset:13248
    s_waitcnt lgkmcnt(10)
    v_mfma_f32_32x32x16_bf16 v[112:127], v[172:175], v[180:183], v[112:127]
    ds_read_b64_tr_b16 v[148:149], v11 offset:12512
    ds_read_b64_tr_b16 v[150:151], v11 offset:13280
    s_add_u32 m0, s58, 49408
    s_nop 0
    buffer_load_dwordx4 v8, s[72:75], s57 offen lds
    s_waitcnt vmcnt(12)
    s_waitcnt lgkmcnt(10)
    v_mfma_f32_32x32x16_bf16 v[32:47], v[128:131], v[184:187], v[32:47]
    ds_read_b64_tr_b16 v[152:153], v11 offset:15424
    ds_read_b64_tr_b16 v[154:155], v11 offset:16192
    s_waitcnt lgkmcnt(10)
    v_mfma_f32_32x32x16_bf16 v[48:63], v[132:135], v[184:187], v[48:63]
    ds_read_b64_tr_b16 v[156:157], v11 offset:15456
    ds_read_b64_tr_b16 v[158:159], v11 offset:16224
    s_add_u32 m0, s58, 50432
    s_nop 0
    buffer_load_dwordx4 v9, s[72:75], s57 offen lds
    s_waitcnt lgkmcnt(10)
    v_mfma_f32_32x32x16_bf16 v[64:79], v[136:139], v[184:187], v[64:79]
    ds_read_b64_tr_b16 v[160:161], v11 offset:15488
    ds_read_b64_tr_b16 v[162:163], v11 offset:16256
    s_waitcnt lgkmcnt(10)
    v_mfma_f32_32x32x16_bf16 v[80:95], v[140:143], v[184:187], v[80:95]
    ds_read_b64_tr_b16 v[164:165], v11 offset:15520
    ds_read_b64_tr_b16 v[166:167], v11 offset:16288
    s_add_u32 m0, s58, 51456
    s_nop 0
    buffer_load_dwordx4 v10, s[72:75], s57 offen lds
    s_add_u32 s57, s57, 88064
    s_waitcnt lgkmcnt(10)
    v_mfma_f32_32x32x16_bf16 v[96:111], v[144:147], v[184:187], v[96:111]
    ds_read_b64_tr_b16 v[168:169], v11 offset:15552
    ds_read_b64_tr_b16 v[170:171], v11 offset:16320
    s_waitcnt lgkmcnt(10)
    v_mfma_f32_32x32x16_bf16 v[112:127], v[148:151], v[184:187], v[112:127]
    ds_read_b64_tr_b16 v[172:173], v11 offset:15584
    ds_read_b64_tr_b16 v[174:175], v11 offset:16352
    s_add_u32 m0, s58, 61760
    s_nop 0
    buffer_load_dwordx4 v8, s[72:75], s57 offen lds
    s_waitcnt vmcnt(11)
    s_barrier
    s_waitcnt lgkmcnt(10)
    v_mfma_f32_32x32x16_bf16 v[32:47], v[152:155], v[188:191], v[32:47]
    ds_read_b64_tr_b16 v[128:129], v11 offset:24704
    ds_read_b64_tr_b16 v[130:131], v11 offset:25472
    s_waitcnt lgkmcnt(10)
    v_mfma_f32_32x32x16_bf16 v[48:63], v[156:159], v[188:191], v[48:63]
    ds_read_b64_tr_b16 v[132:133], v11 offset:24736
    ds_read_b64_tr_b16 v[134:135], v11 offset:25504
    s_add_u32 m0, s58, 62784
    s_nop 0
    buffer_load_dwordx4 v9, s[72:75], s57 offen lds
    s_waitcnt lgkmcnt(10)
    v_mfma_f32_32x32x16_bf16 v[64:79], v[160:163], v[188:191], v[64:79]
    ds_read_b64_tr_b16 v[136:137], v11 offset:24768
    ds_read_b64_tr_b16 v[138:139], v11 offset:25536
    s_waitcnt lgkmcnt(10)
    v_mfma_f32_32x32x16_bf16 v[80:95], v[164:167], v[188:191], v[80:95]
    ds_read_b64_tr_b16 v[140:141], v11 offset:24800
    ds_read_b64_tr_b16 v[142:143], v11 offset:25568
    s_add_u32 m0, s58, 63808
    s_nop 0
    buffer_load_dwordx4 v10, s[72:75], s57 offen lds
    s_add_u32 s57, s57, 88064
    s_waitcnt lgkmcnt(10)
    v_mfma_f32_32x32x16_bf16 v[96:111], v[168:171], v[188:191], v[96:111]
    ds_read_b64_tr_b16 v[144:145], v11 offset:24832
    ds_read_b64_tr_b16 v[146:147], v11 offset:25600
    s_waitcnt lgkmcnt(10)
    v_mfma_f32_32x32x16_bf16 v[112:127], v[172:175], v[188:191], v[112:127]
    ds_read_b64_tr_b16 v[148:149], v11 offset:24864
    ds_read_b64_tr_b16 v[150:151], v11 offset:25632
    buffer_load_dwordx4 v[176:179], v3, s[20:23], s53 offen offset:0
    s_waitcnt vmcnt(13)
    s_waitcnt lgkmcnt(10)
    v_mfma_f32_32x32x16_bf16 v[32:47], v[128:131], v[192:195], v[32:47]
    ds_read_b64_tr_b16 v[152:153], v11 offset:27776
    ds_read_b64_tr_b16 v[154:155], v11 offset:28544
    s_waitcnt lgkmcnt(10)
    v_mfma_f32_32x32x16_bf16 v[48:63], v[132:135], v[192:195], v[48:63]
    ds_read_b64_tr_b16 v[156:157], v11 offset:27808
    ds_read_b64_tr_b16 v[158:159], v11 offset:28576
    buffer_load_dwordx4 v[180:183], v3, s[20:23], s53 offen offset:1024
    s_waitcnt lgkmcnt(10)
    v_mfma_f32_32x32x16_bf16 v[64:79], v[136:139], v[192:195], v[64:79]
    ds_read_b64_tr_b16 v[160:161], v11 offset:27840
    ds_read_b64_tr_b16 v[162:163], v11 offset:28608
    s_waitcnt lgkmcnt(10)
    v_mfma_f32_32x32x16_bf16 v[80:95], v[140:143], v[192:195], v[80:95]
    ds_read_b64_tr_b16 v[164:165], v11 offset:27872
    ds_read_b64_tr_b16 v[166:167], v11 offset:28640
    buffer_load_dwordx4 v[184:187], v3, s[20:23], s53 offen offset:2048
    s_waitcnt lgkmcnt(10)
    v_mfma_f32_32x32x16_bf16 v[96:111], v[144:147], v[192:195], v[96:111]
    ds_read_b64_tr_b16 v[168:169], v11 offset:27904
    ds_read_b64_tr_b16 v[170:171], v11 offset:28672
    s_waitcnt lgkmcnt(10)
    v_mfma_f32_32x32x16_bf16 v[112:127], v[148:151], v[192:195], v[112:127]
    ds_read_b64_tr_b16 v[172:173], v11 offset:27936
    ds_read_b64_tr_b16 v[174:175], v11 offset:28704
    s_add_u32 m0, s58, 0
    s_nop 0
    buffer_load_dwordx4 v8, s[72:75], s57 offen lds
    s_waitcnt vmcnt(12)
    s_barrier
    s_waitcnt lgkmcnt(10)
    v_mfma_f32_32x32x16_bf16 v[32:47], v[152:155], v[196:199], v[32:47]
    ds_read_b64_tr_b16 v[128:129], v12 offset:0
    ds_read_b64_tr_b16 v[130:131], v12 offset:768
    s_waitcnt lgkmcnt(10)
    v_mfma_f32_32x32x16_bf16 v[48:63], v[156:159], v[196:199], v[48:63]
    ds_read_b64_tr_b16 v[132:133], v12 offset:32
    ds_read_b64_tr_b16 v[134:135], v12 offset:800
    s_add_u32 m0, s58, 1024
    s_nop 0
    buffer_load_dwordx4 v9, s[72:75], s57 offen lds
    s_waitcnt lgkmcnt(10)
    v_mfma_f32_32x32x16_bf16 v[64:79], v[160:163], v[196:199], v[64:79]
    ds_read_b64_tr_b16 v[136:137], v12 offset:64
    ds_read_b64_tr_b16 v[138:139], v12 offset:832
    s_waitcnt lgkmcnt(10)
    v_mfma_f32_32x32x16_bf16 v[80:95], v[164:167], v[196:199], v[80:95]
    ds_read_b64_tr_b16 v[140:141], v12 offset:96
    ds_read_b64_tr_b16 v[142:143], v12 offset:864
    s_add_u32 m0, s58, 2048
    s_nop 0
    buffer_load_dwordx4 v10, s[72:75], s57 offen lds
    s_add_u32 s57, s57, 88064
    s_waitcnt lgkmcnt(10)
    v_mfma_f32_32x32x16_bf16 v[96:111], v[168:171], v[196:199], v[96:111]
    ds_read_b64_tr_b16 v[144:145], v12 offset:128
    ds_read_b64_tr_b16 v[146:147], v12 offset:896
    s_waitcnt lgkmcnt(10)
    v_mfma_f32_32x32x16_bf16 v[112:127], v[172:175], v[196:199], v[112:127]
    ds_read_b64_tr_b16 v[148:149], v12 offset:160
    ds_read_b64_tr_b16 v[150:151], v12 offset:928
    buffer_load_dwordx4 v[188:191], v3, s[20:23], s53 offen offset:3072
    s_add_u32 s53, s53, 4096
    s_waitcnt vmcnt(14)
    s_waitcnt lgkmcnt(10)
    v_mfma_f32_32x32x16_bf16 v[32:47], v[128:131], v[200:203], v[32:47]
    ds_read_b64_tr_b16 v[152:153], v12 offset:3072
    ds_read_b64_tr_b16 v[154:155], v12 offset:3840
    s_waitcnt lgkmcnt(10)
    v_mfma_f32_32x32x16_bf16 v[48:63], v[132:135], v[200:203], v[48:63]
    ds_read_b64_tr_b16 v[156:157], v12 offset:3104
    ds_read_b64_tr_b16 v[158:159], v12 offset:3872
    buffer_load_dwordx4 v[192:195], v3, s[20:23], s53 offen offset:0
    s_waitcnt lgkmcnt(10)
    v_mfma_f32_32x32x16_bf16 v[64:79], v[136:139], v[200:203], v[64:79]
    ds_read_b64_tr_b16 v[160:161], v12 offset:3136
    ds_read_b64_tr_b16 v[162:163], v12 offset:3904
    s_waitcnt lgkmcnt(10)
    v_mfma_f32_32x32x16_bf16 v[80:95], v[140:143], v[200:203], v[80:95]
    ds_read_b64_tr_b16 v[164:165], v12 offset:3168
    ds_read_b64_tr_b16 v[166:167], v12 offset:3936
    s_add_u32 m0, s58, 12352
    s_nop 0
    buffer_load_dwordx4 v8, s[72:75], s57 offen lds
    s_waitcnt lgkmcnt(10)
    v_mfma_f32_32x32x16_bf16 v[96:111], v[144:147], v[200:203], v[96:111]
    ds_read_b64_tr_b16 v[168:169], v12 offset:3200
    ds_read_b64_tr_b16 v[170:171], v12 offset:3968
    s_waitcnt lgkmcnt(10)
    v_mfma_f32_32x32x16_bf16 v[112:127], v[148:151], v[200:203], v[112:127]
    ds_read_b64_tr_b16 v[172:173], v12 offset:3232
    ds_read_b64_tr_b16 v[174:175], v12 offset:4000
    s_add_u32 m0, s58, 13376
    s_nop 0
    buffer_load_dwordx4 v9, s[72:75], s57 offen lds
    s_waitcnt vmcnt(13)
    s_barrier
    s_waitcnt lgkmcnt(10)
    v_mfma_f32_32x32x16_bf16 v[32:47], v[152:155], v[204:207], v[32:47]
    ds_read_b64_tr_b16 v[128:129], v12 offset:12352
    ds_read_b64_tr_b16 v[130:131], v12 offset:13120
    s_waitcnt lgkmcnt(10)
    v_mfma_f32_32x32x16_bf16 v[48:63], v[156:159], v[204:207], v[48:63]
    ds_read_b64_tr_b16 v[132:133], v12 offset:12384
    ds_read_b64_tr_b16 v[134:135], v12 offset:13152
    s_add_u32 m0, s58, 14400
    s_nop 0
    buffer_load_dwordx4 v10, s[72:75], s57 offen lds
    s_add_u32 s57, s57, 88064
    s_waitcnt lgkmcnt(10)
    v_mfma_f32_32x32x16_bf16 v[64:79], v[160:163], v[204:207], v[64:79]
    ds_read_b64_tr_b16 v[136:137], v12 offset:12416
    ds_read_b64_tr_b16 v[138:139], v12 offset:13184
    s_waitcnt lgkmcnt(10)
    v_mfma_f32_32x32x16_bf16 v[80:95], v[164:167], v[204:207], v[80:95]
    ds_read_b64_tr_b16 v[140:141], v12 offset:12448
    ds_read_b64_tr_b16 v[142:143], v12 offset:13216
    buffer_load_dwordx4 v[196:199], v3, s[20:23], s53 offen offset:1024
    s_waitcnt lgkmcnt(10)
    v_mfma_f32_32x32x16_bf16 v[96:111], v[168:171], v[204:207], v[96:111]
    ds_read_b64_tr_b16 v[144:145], v12 offset:12480
    ds_read_b64_tr_b16 v[146:147], v12 offset:13248
    s_waitcnt lgkmcnt(10)
    v_mfma_f32_32x32x16_bf16 v[112:127], v[172:175], v[204:207], v[112:127]
    ds_read_b64_tr_b16 v[148:149], v12 offset:12512
    ds_read_b64_tr_b16 v[150:151], v12 offset:13280
    buffer_load_dwordx4 v[200:203], v3, s[20:23], s53 offen offset:2048
    s_waitcnt vmcnt(12)
    s_waitcnt lgkmcnt(10)
    v_mfma_f32_32x32x16_bf16 v[32:47], v[128:131], v[176:179], v[32:47]
    ds_read_b64_tr_b16 v[152:153], v12 offset:15424
    ds_read_b64_tr_b16 v[154:155], v12 offset:16192
    s_waitcnt lgkmcnt(10)
    v_mfma_f32_32x32x16_bf16 v[48:63], v[132:135], v[176:179], v[48:63]
    ds_read_b64_tr_b16 v[156:157], v12 offset:15456
    ds_read_b64_tr_b16 v[158:159], v12 offset:16224
    s_add_u32 m0, s58, 24704
    s_nop 0
    buffer_load_dwordx4 v8, s[72:75], s57 offen lds
    s_waitcnt lgkmcnt(10)
    v_mfma_f32_32x32x16_bf16 v[64:79], v[136:139], v[176:179], v[64:79]
    ds_read_b64_tr_b16 v[160:161], v12 offset:15488
    ds_read_b64_tr_b16 v[162:163], v12 offset:16256
    s_waitcnt lgkmcnt(10)
    v_mfma_f32_32x32x16_bf16 v[80:95], v[140:143], v[176:179], v[80:95]
    ds_read_b64_tr_b16 v[164:165], v12 offset:15520
    ds_read_b64_tr_b16 v[166:167], v12 offset:16288
    s_add_u32 m0, s58, 25728
    s_nop 0
    buffer_load_dwordx4 v9, s[72:75], s57 offen lds
    s_waitcnt lgkmcnt(10)
    v_mfma_f32_32x32x16_bf16 v[96:111], v[144:147], v[176:179], v[96:111]
    ds_read_b64_tr_b16 v[168:169], v12 offset:15552
    ds_read_b64_tr_b16 v[170:171], v12 offset:16320
    s_waitcnt lgkmcnt(10)
    v_mfma_f32_32x32x16_bf16 v[112:127], v[148:151], v[176:179], v[112:127]
    ds_read_b64_tr_b16 v[172:173], v12 offset:15584
    ds_read_b64_tr_b16 v[174:175], v12 offset:16352
    s_add_u32 m0, s58, 26752
    s_nop 0
    buffer_load_dwordx4 v10, s[72:75], s57 offen lds
    s_add_u32 s57, s57, 88064
    s_waitcnt vmcnt(14)
    s_barrier
    s_waitcnt lgkmcnt(10)
    v_mfma_f32_32x32x16_bf16 v[32:47], v[152:155], v[180:183], v[32:47]
    ds_read_b64_tr_b16 v[128:129], v12 offset:24704
    ds_read_b64_tr_b16 v[130:131], v12 offset:25472
    s_waitcnt lgkmcnt(10)
    v_mfma_f32_32x32x16_bf16 v[48:63], v[156:159], v[180:183], v[48:63]
    ds_read_b64_tr_b16 v[132:133], v12 offset:24736
    ds_read_b64_tr_b16 v[134:135], v12 offset:25504
    buffer_load_dwordx4 v[204:207], v3, s[20:23], s53 offen offset:3072
    s_add_u32 s53, s53, 4096
    s_waitcnt lgkmcnt(10)
    v_mfma_f32_32x32x16_bf16 v[64:79], v[160:163], v[180:183], v[64:79]
    ds_read_b64_tr_b16 v[136:137], v12 offset:24768
    ds_read_b64_tr_b16 v[138:139], v12 offset:25536
    s_waitcnt lgkmcnt(10)
    v_mfma_f32_32x32x16_bf16 v[80:95], v[164:167], v[180:183], v[80:95]
    ds_read_b64_tr_b16 v[140:141], v12 offset:24800
    ds_read_b64_tr_b16 v[142:143], v12 offset:25568
    buffer_load_dwordx4 v[176:179], v3, s[20:23], s53 offen offset:0
    s_waitcnt lgkmcnt(10)
    v_mfma_f32_32x32x16_bf16 v[96:111], v[168:171], v[180:183], v[96:111]
    ds_read_b64_tr_b16 v[144:145], v12 offset:24832
    ds_read_b64_tr_b16 v[146:147], v12 offset:25600
    s_waitcnt lgkmcnt(10)
    v_mfma_f32_32x32x16_bf16 v[112:127], v[172:175], v[180:183], v[112:127]
    ds_read_b64_tr_b16 v[148:149], v12 offset:24864
    ds_read_b64_tr_b16 v[150:151], v12 offset:25632
    s_add_u32 m0, s58, 37056
    s_nop 0
    buffer_load_dwordx4 v8, s[72:75], s57 offen lds
    s_waitcnt vmcnt(16)
    s_waitcnt lgkmcnt(10)
    v_mfma_f32_32x32x16_bf16 v[32:47], v[128:131], v[184:187], v[32:47]
    ds_read_b64_tr_b16 v[152:153], v12 offset:27776
    ds_read_b64_tr_b16 v[154:155], v12 offset:28544
    s_waitcnt lgkmcnt(10)
    v_mfma_f32_32x32x16_bf16 v[48:63], v[132:135], v[184:187], v[48:63]
    ds_read_b64_tr_b16 v[156:157], v12 offset:27808
    ds_read_b64_tr_b16 v[158:159], v12 offset:28576
    s_add_u32 m0, s58, 38080
    s_nop 0
    buffer_load_dwordx4 v9, s[72:75], s57 offen lds
    s_waitcnt lgkmcnt(10)
    v_mfma_f32_32x32x16_bf16 v[64:79], v[136:139], v[184:187], v[64:79]
    ds_read_b64_tr_b16 v[160:161], v12 offset:27840
    ds_read_b64_tr_b16 v[162:163], v12 offset:28608
    s_waitcnt lgkmcnt(10)
    v_mfma_f32_32x32x16_bf16 v[80:95], v[140:143], v[184:187], v[80:95]
    ds_read_b64_tr_b16 v[164:165], v12 offset:27872
    ds_read_b64_tr_b16 v[166:167], v12 offset:28640
    s_add_u32 m0, s58, 39104
    s_nop 0
    buffer_load_dwordx4 v10, s[72:75], s57 offen lds
    s_add_u32 s57, s57, 88064
    s_waitcnt lgkmcnt(10)
    v_mfma_f32_32x32x16_bf16 v[96:111], v[144:147], v[184:187], v[96:111]
    ds_read_b64_tr_b16 v[168:169], v12 offset:27904
    ds_read_b64_tr_b16 v[170:171], v12 offset:28672
    s_waitcnt lgkmcnt(10)
    v_mfma_f32_32x32x16_bf16 v[112:127], v[148:151], v[184:187], v[112:127]
    ds_read_b64_tr_b16 v[172:173], v12 offset:27936
    ds_read_b64_tr_b16 v[174:175], v12 offset:28704
    buffer_load_dwordx4 v[180:183], v3, s[20:23], s53 offen offset:1024
    s_waitcnt vmcnt(15)
    s_barrier
    s_waitcnt lgkmcnt(10)
    v_mfma_f32_32x32x16_bf16 v[32:47], v[152:155], v[188:191], v[32:47]
    ds_read_b64_tr_b16 v[128:129], v11 offset:0
    ds_read_b64_tr_b16 v[130:131], v11 offset:768
    s_waitcnt lgkmcnt(10)
    v_mfma_f32_32x32x16_bf16 v[48:63], v[156:159], v[188:191], v[48:63]
    ds_read_b64_tr_b16 v[132:133], v11 offset:32
    ds_read_b64_tr_b16 v[134:135], v11 offset:800
    buffer_load_dwordx4 v[184:187], v3, s[20:23], s53 offen offset:2048
    s_waitcnt lgkmcnt(10)
    v_mfma_f32_32x32x16_bf16 v[64:79], v[160:163], v[188:191], v[64:79]
    ds_read_b64_tr_b16 v[136:137], v11 offset:64
    ds_read_b64_tr_b16 v[138:139], v11 offset:832
    s_waitcnt lgkmcnt(10)
    v_mfma_f32_32x32x16_bf16 v[80:95], v[164:167], v[188:191], v[80:95]
    ds_read_b64_tr_b16 v[140:141], v11 offset:96
    ds_read_b64_tr_b16 v[142:143], v11 offset:864
    s_add_u32 m0, s58, 49408
    s_nop 0
    buffer_load_dwordx4 v8, s[72:75], s57 offen lds
    s_waitcnt lgkmcnt(10)
    v_mfma_f32_32x32x16_bf16 v[96:111], v[168:171], v[188:191], v[96:111]
    ds_read_b64_tr_b16 v[144:145], v11 offset:128
    ds_read_b64_tr_b16 v[146:147], v11 offset:896
    s_waitcnt lgkmcnt(10)
    v_mfma_f32_32x32x16_bf16 v[112:127], v[172:175], v[188:191], v[112:127]
    ds_read_b64_tr_b16 v[148:149], v11 offset:160
    ds_read_b64_tr_b16 v[150:151], v11 offset:928
    s_add_u32 m0, s58, 50432
    s_nop 0
    buffer_load_dwordx4 v9, s[72:75], s57 offen lds
    s_waitcnt vmcnt(17)
    s_waitcnt lgkmcnt(10)
    v_mfma_f32_32x32x16_bf16 v[32:47], v[128:131], v[192:195], v[32:47]
    ds_read_b64_tr_b16 v[152:153], v11 offset:3072
    ds_read_b64_tr_b16 v[154:155], v11 offset:3840
    s_waitcnt lgkmcnt(10)
    v_mfma_f32_32x32x16_bf16 v[48:63], v[132:135], v[192:195], v[48:63]
    ds_read_b64_tr_b16 v[156:157], v11 offset:3104
    ds_read_b64_tr_b16 v[158:159], v11 offset:3872
    s_add_u32 m0, s58, 51456
    s_nop 0
    buffer_load_dwordx4 v10, s[72:75], s57 offen lds
    s_add_u32 s57, s57, 88064
    s_waitcnt lgkmcnt(10)
    v_mfma_f32_32x32x16_bf16 v[64:79], v[136:139], v[192:195], v[64:79]
    ds_read_b64_tr_b16 v[160:161], v11 offset:3136
    ds_read_b64_tr_b16 v[162:163], v11 offset:3904
    s_waitcnt lgkmcnt(10)
    v_mfma_f32_32x32x16_bf16 v[80:95], v[140:143], v[192:195], v[80:95]
    ds_read_b64_tr_b16 v[164:165], v11 offset:3168
    ds_read_b64_tr_b16 v[166:167], v11 offset:3936
    buffer_load_dwordx4 v[188:191], v3, s[20:23], s53 offen offset:3072
    s_add_u32 s53, s53, 4096
    s_waitcnt lgkmcnt(10)
    v_mfma_f32_32x32x16_bf16 v[96:111], v[144:147], v[192:195], v[96:111]
    ds_read_b64_tr_b16 v[168:169], v11 offset:3200
    ds_read_b64_tr_b16 v[170:171], v11 offset:3968
    s_waitcnt lgkmcnt(10)
    v_mfma_f32_32x32x16_bf16 v[112:127], v[148:151], v[192:195], v[112:127]
    ds_read_b64_tr_b16 v[172:173], v11 offset:3232
    ds_read_b64_tr_b16 v[174:175], v11 offset:4000
    buffer_load_dwordx4 v[192:195], v3, s[20:23], s53 offen offset:0
    s_waitcnt vmcnt(16)
    s_barrier
    s_waitcnt lgkmcnt(10)
    v_mfma_f32_32x32x16_bf16 v[32:47], v[152:155], v[196:199], v[32:47]
    ds_read_b64_tr_b16 v[128:129], v11 offset:12352
    ds_read_b64_tr_b16 v[130:131], v11 offset:13120
    s_waitcnt lgkmcnt(10)
    v_mfma_f32_32x32x16_bf16 v[48:63], v[156:159], v[196:199], v[48:63]
    ds_read_b64_tr_b16 v[132:133], v11 offset:12384
    ds_read_b64_tr_b16 v[134:135], v11 offset:13152
    s_add_u32 m0, s58, 61760
    s_nop 0
    buffer_load_dwordx4 v8, s[72:75], s57 offen lds
    s_waitcnt lgkmcnt(10)
    v_mfma_f32_32x32x16_bf16 v[64:79], v[160:163], v[196:199], v[64:79]
    ds_read_b64_tr_b16 v[136:137], v11 offset:12416
    ds_read_b64_tr_b16 v[138:139], v11 offset:13184
    s_waitcnt lgkmcnt(10)
    v_mfma_f32_32x32x16_bf16 v[80:95], v[164:167], v[196:199], v[80:95]
    ds_read_b64_tr_b16 v[140:141], v11 offset:12448
    ds_read_b64_tr_b16 v[142:143], v11 offset:13216
    s_add_u32 m0, s58, 62784
    s_nop 0
    buffer_load_dwordx4 v9, s[72:75], s57 offen lds
    s_waitcnt lgkmcnt(10)
    v_mfma_f32_32x32x16_bf16 v[96:111], v[168:171], v[196:199], v[96:111]
    ds_read_b64_tr_b16 v[144:145], v11 offset:12480
    ds_read_b64_tr_b16 v[146:147], v11 offset:13248
    s_waitcnt lgkmcnt(10)
    v_mfma_f32_32x32x16_bf16 v[112:127], v[172:175], v[196:199], v[112:127]
    ds_read_b64_tr_b16 v[148:149], v11 offset:12512
    ds_read_b64_tr_b16 v[150:151], v11 offset:13280
    s_add_u32 m0, s58, 63808
    s_nop 0
    buffer_load_dwordx4 v10, s[72:75], s57 offen lds
    s_add_u32 s57, s57, 88064
    s_waitcnt vmcnt(18)
    s_waitcnt lgkmcnt(10)
    v_mfma_f32_32x32x16_bf16 v[32:47], v[128:131], v[200:203], v[32:47]
    ds_read_b64_tr_b16 v[152:153], v11 offset:15424
    ds_read_b64_tr_b16 v[154:155], v11 offset:16192
    s_waitcnt lgkmcnt(10)
    v_mfma_f32_32x32x16_bf16 v[48:63], v[132:135], v[200:203], v[48:63]
    ds_read_b64_tr_b16 v[156:157], v11 offset:15456
    ds_read_b64_tr_b16 v[158:159], v11 offset:16224
    buffer_load_dwordx4 v[196:199], v3, s[20:23], s53 offen offset:1024
    s_waitcnt lgkmcnt(10)
    v_mfma_f32_32x32x16_bf16 v[64:79], v[136:139], v[200:203], v[64:79]
    ds_read_b64_tr_b16 v[160:161], v11 offset:15488
    ds_read_b64_tr_b16 v[162:163], v11 offset:16256
    s_waitcnt lgkmcnt(10)
    v_mfma_f32_32x32x16_bf16 v[80:95], v[140:143], v[200:203], v[80:95]
    ds_read_b64_tr_b16 v[164:165], v11 offset:15520
    ds_read_b64_tr_b16 v[166:167], v11 offset:16288
    s_waitcnt lgkmcnt(10)
    v_mfma_f32_32x32x16_bf16 v[96:111], v[144:147], v[200:203], v[96:111]
    ds_read_b64_tr_b16 v[168:169], v11 offset:15552
    ds_read_b64_tr_b16 v[170:171], v11 offset:16320
    s_waitcnt lgkmcnt(10)
    v_mfma_f32_32x32x16_bf16 v[112:127], v[148:151], v[200:203], v[112:127]
    ds_read_b64_tr_b16 v[172:173], v11 offset:15584
    ds_read_b64_tr_b16 v[174:175], v11 offset:16352
    buffer_load_dwordx4 v[200:203], v3, s[20:23], s53 offen offset:2048
    s_waitcnt vmcnt(16)
    s_barrier
    s_waitcnt lgkmcnt(10)
    v_mfma_f32_32x32x16_bf16 v[32:47], v[152:155], v[204:207], v[32:47]
    ds_read_b64_tr_b16 v[128:129], v11 offset:24704
    ds_read_b64_tr_b16 v[130:131], v11 offset:25472
    s_waitcnt lgkmcnt(10)
    v_mfma_f32_32x32x16_bf16 v[48:63], v[156:159], v[204:207], v[48:63]
    ds_read_b64_tr_b16 v[132:133], v11 offset:24736
    ds_read_b64_tr_b16 v[134:135], v11 offset:25504
    s_add_u32 m0, s58, 0
    s_nop 0
    buffer_load_dwordx4 v8, s[72:75], s57 offen lds
    s_waitcnt lgkmcnt(10)
    v_mfma_f32_32x32x16_bf16 v[64:79], v[160:163], v[204:207], v[64:79]
    ds_read_b64_tr_b16 v[136:137], v11 offset:24768
    ds_read_b64_tr_b16 v[138:139], v11 offset:25536
    s_waitcnt lgkmcnt(10)
    v_mfma_f32_32x32x16_bf16 v[80:95], v[164:167], v[204:207], v[80:95]
    ds_read_b64_tr_b16 v[140:141], v11 offset:24800
    ds_read_b64_tr_b16 v[142:143], v11 offset:25568
    s_add_u32 m0, s58, 1024
    s_nop 0
    buffer_load_dwordx4 v9, s[72:75], s57 offen lds
    s_waitcnt lgkmcnt(10)
    v_mfma_f32_32x32x16_bf16 v[96:111], v[168:171], v[204:207], v[96:111]
    ds_read_b64_tr_b16 v[144:145], v11 offset:24832
    ds_read_b64_tr_b16 v[146:147], v11 offset:25600
    s_waitcnt lgkmcnt(10)
    v_mfma_f32_32x32x16_bf16 v[112:127], v[172:175], v[204:207], v[112:127]
    ds_read_b64_tr_b16 v[148:149], v11 offset:24864
    ds_read_b64_tr_b16 v[150:151], v11 offset:25632
    s_add_u32 m0, s58, 2048
    s_nop 0
    buffer_load_dwordx4 v10, s[72:75], s57 offen lds
    s_add_u32 s57, s57, 88064
    s_waitcnt vmcnt(18)
    s_waitcnt lgkmcnt(10)
    v_mfma_f32_32x32x16_bf16 v[32:47], v[128:131], v[176:179], v[32:47]
    ds_read_b64_tr_b16 v[152:153], v11 offset:27776
    ds_read_b64_tr_b16 v[154:155], v11 offset:28544
    s_waitcnt lgkmcnt(10)
    v_mfma_f32_32x32x16_bf16 v[48:63], v[132:135], v[176:179], v[48:63]
    ds_read_b64_tr_b16 v[156:157], v11 offset:27808
    ds_read_b64_tr_b16 v[158:159], v11 offset:28576
    buffer_load_dwordx4 v[204:207], v3, s[20:23], s53 offen offset:3072
    s_add_u32 s53, s53, 4096
    s_waitcnt lgkmcnt(10)
    v_mfma_f32_32x32x16_bf16 v[64:79], v[136:139], v[176:179], v[64:79]
    ds_read_b64_tr_b16 v[160:161], v11 offset:27840
    ds_read_b64_tr_b16 v[162:163], v11 offset:28608
    s_waitcnt lgkmcnt(10)
    v_mfma_f32_32x32x16_bf16 v[80:95], v[140:143], v[176:179], v[80:95]
    ds_read_b64_tr_b16 v[164:165], v11 offset:27872
    ds_read_b64_tr_b16 v[166:167], v11 offset:28640
    s_waitcnt lgkmcnt(10)
    v_mfma_f32_32x32x16_bf16 v[96:111], v[144:147], v[176:179], v[96:111]
    ds_read_b64_tr_b16 v[168:169], v11 offset:27904
    ds_read_b64_tr_b16 v[170:171], v11 offset:28672
    s_waitcnt lgkmcnt(10)
    v_mfma_f32_32x32x16_bf16 v[112:127], v[148:151], v[176:179], v[112:127]
    ds_read_b64_tr_b16 v[172:173], v11 offset:27936
    ds_read_b64_tr_b16 v[174:175], v11 offset:28704
    buffer_load_dwordx4 v[176:179], v3, s[20:23], s53 offen offset:0
    s_waitcnt vmcnt(16)
    s_barrier
    s_waitcnt lgkmcnt(10)
    v_mfma_f32_32x32x16_bf16 v[32:47], v[152:155], v[180:183], v[32:47]
    ds_read_b64_tr_b16 v[128:129], v12 offset:0
    ds_read_b64_tr_b16 v[130:131], v12 offset:768
    s_waitcnt lgkmcnt(10)
    v_mfma_f32_32x32x16_bf16 v[48:63], v[156:159], v[180:183], v[48:63]
    ds_read_b64_tr_b16 v[132:133], v12 offset:32
    ds_read_b64_tr_b16 v[134:135], v12 offset:800
    s_add_u32 m0, s58, 12352
    s_nop 0
    buffer_load_dwordx4 v8, s[72:75], s57 offen lds
    s_waitcnt lgkmcnt(10)
    v_mfma_f32_32x32x16_bf16 v[64:79], v[160:163], v[180:183], v[64:79]
    ds_read_b64_tr_b16 v[136:137], v12 offset:64
    ds_read_b64_tr_b16 v[138:139], v12 offset:832
    s_waitcnt lgkmcnt(10)
    v_mfma_f32_32x32x16_bf16 v[80:95], v[164:167], v[180:183], v[80:95]
    ds_read_b64_tr_b16 v[140:141], v12 offset:96
    ds_read_b64_tr_b16 v[142:143], v12 offset:864
    s_add_u32 m0, s58, 13376
    s_nop 0
    buffer_load_dwordx4 v9, s[72:75], s57 offen lds
    s_waitcnt lgkmcnt(10)
    v_mfma_f32_32x32x16_bf16 v[96:111], v[168:171], v[180:183], v[96:111]
    ds_read_b64_tr_b16 v[144:145], v12 offset:128
    ds_read_b64_tr_b16 v[146:147], v12 offset:896
    s_waitcnt lgkmcnt(10)
    v_mfma_f32_32x32x16_bf16 v[112:127], v[172:175], v[180:183], v[112:127]
    ds_read_b64_tr_b16 v[148:149], v12 offset:160
    ds_read_b64_tr_b16 v[150:151], v12 offset:928
    s_add_u32 m0, s58, 14400
    s_nop 0
    buffer_load_dwordx4 v10, s[72:75], s57 offen lds
    s_add_u32 s57, s57, 88064
    s_waitcnt vmcnt(18)
    s_waitcnt lgkmcnt(10)
    v_mfma_f32_32x32x16_bf16 v[32:47], v[128:131], v[184:187], v[32:47]
    ds_read_b64_tr_b16 v[152:153], v12 offset:3072
    ds_read_b64_tr_b16 v[154:155], v12 offset:3840
    s_waitcnt lgkmcnt(10)
    v_mfma_f32_32x32x16_bf16 v[48:63], v[132:135], v[184:187], v[48:63]
    ds_read_b64_tr_b16 v[156:157], v12 offset:3104
    ds_read_b64_tr_b16 v[158:159], v12 offset:3872
    buffer_load_dwordx4 v[180:183], v3, s[20:23], s53 offen offset:1024
    s_waitcnt lgkmcnt(10)
    v_mfma_f32_32x32x16_bf16 v[64:79], v[136:139], v[184:187], v[64:79]
    ds_read_b64_tr_b16 v[160:161], v12 offset:3136
    ds_read_b64_tr_b16 v[162:163], v12 offset:3904
    s_waitcnt lgkmcnt(10)
    v_mfma_f32_32x32x16_bf16 v[80:95], v[140:143], v[184:187], v[80:95]
    ds_read_b64_tr_b16 v[164:165], v12 offset:3168
    ds_read_b64_tr_b16 v[166:167], v12 offset:3936
    s_waitcnt lgkmcnt(10)
    v_mfma_f32_32x32x16_bf16 v[96:111], v[144:147], v[184:187], v[96:111]
    ds_read_b64_tr_b16 v[168:169], v12 offset:3200
    ds_read_b64_tr_b16 v[170:171], v12 offset:3968
    s_waitcnt lgkmcnt(10)
    v_mfma_f32_32x32x16_bf16 v[112:127], v[148:151], v[184:187], v[112:127]
    ds_read_b64_tr_b16 v[172:173], v12 offset:3232
    ds_read_b64_tr_b16 v[174:175], v12 offset:4000
    buffer_load_dwordx4 v[184:187], v3, s[20:23], s53 offen offset:2048
    s_waitcnt vmcnt(16)
    s_barrier
    s_waitcnt lgkmcnt(10)
    v_mfma_f32_32x32x16_bf16 v[32:47], v[152:155], v[188:191], v[32:47]
    ds_read_b64_tr_b16 v[128:129], v12 offset:12352
    ds_read_b64_tr_b16 v[130:131], v12 offset:13120
    s_waitcnt lgkmcnt(10)
    v_mfma_f32_32x32x16_bf16 v[48:63], v[156:159], v[188:191], v[48:63]
    ds_read_b64_tr_b16 v[132:133], v12 offset:12384
    ds_read_b64_tr_b16 v[134:135], v12 offset:13152
    s_add_u32 m0, s58, 24704
    s_nop 0
    buffer_load_dwordx4 v8, s[72:75], s57 offen lds
    s_waitcnt lgkmcnt(10)
    v_mfma_f32_32x32x16_bf16 v[64:79], v[160:163], v[188:191], v[64:79]
    ds_read_b64_tr_b16 v[136:137], v12 offset:12416
    ds_read_b64_tr_b16 v[138:139], v12 offset:13184
    s_waitcnt lgkmcnt(10)
    v_mfma_f32_32x32x16_bf16 v[80:95], v[164:167], v[188:191], v[80:95]
    ds_read_b64_tr_b16 v[140:141], v12 offset:12448
    ds_read_b64_tr_b16 v[142:143], v12 offset:13216
    s_add_u32 m0, s58, 25728
    s_nop 0
    buffer_load_dwordx4 v9, s[72:75], s57 offen lds
    s_waitcnt lgkmcnt(10)
    v_mfma_f32_32x32x16_bf16 v[96:111], v[168:171], v[188:191], v[96:111]
    ds_read_b64_tr_b16 v[144:145], v12 offset:12480
    ds_read_b64_tr_b16 v[146:147], v12 offset:13248
    s_waitcnt lgkmcnt(10)
    v_mfma_f32_32x32x16_bf16 v[112:127], v[172:175], v[188:191], v[112:127]
    ds_read_b64_tr_b16 v[148:149], v12 offset:12512
    ds_read_b64_tr_b16 v[150:151], v12 offset:13280
    s_add_u32 m0, s58, 26752
    s_nop 0
    buffer_load_dwordx4 v10, s[72:75], s57 offen lds
    s_add_u32 s57, s57, 88064
    s_waitcnt vmcnt(18)
    s_waitcnt lgkmcnt(10)
    v_mfma_f32_32x32x16_bf16 v[32:47], v[128:131], v[192:195], v[32:47]
    ds_read_b64_tr_b16 v[152:153], v12 offset:15424
    ds_read_b64_tr_b16 v[154:155], v12 offset:16192
    s_waitcnt lgkmcnt(10)
    v_mfma_f32_32x32x16_bf16 v[48:63], v[132:135], v[192:195], v[48:63]
    ds_read_b64_tr_b16 v[156:157], v12 offset:15456
    ds_read_b64_tr_b16 v[158:159], v12 offset:16224
    buffer_load_dwordx4 v[188:191], v3, s[20:23], s53 offen offset:3072
    s_add_u32 s53, s53, 4096
    s_waitcnt lgkmcnt(10)
    v_mfma_f32_32x32x16_bf16 v[64:79], v[136:139], v[192:195], v[64:79]
    ds_read_b64_tr_b16 v[160:161], v12 offset:15488
    ds_read_b64_tr_b16 v[162:163], v12 offset:16256
    s_waitcnt lgkmcnt(10)
    v_mfma_f32_32x32x16_bf16 v[80:95], v[140:143], v[192:195], v[80:95]
    ds_read_b64_tr_b16 v[164:165], v12 offset:15520
    ds_read_b64_tr_b16 v[166:167], v12 offset:16288
    s_waitcnt lgkmcnt(10)
    v_mfma_f32_32x32x16_bf16 v[96:111], v[144:147], v[192:195], v[96:111]
    ds_read_b64_tr_b16 v[168:169], v12 offset:15552
    ds_read_b64_tr_b16 v[170:171], v12 offset:16320
    s_waitcnt lgkmcnt(10)
    v_mfma_f32_32x32x16_bf16 v[112:127], v[148:151], v[192:195], v[112:127]
    ds_read_b64_tr_b16 v[172:173], v12 offset:15584
    ds_read_b64_tr_b16 v[174:175], v12 offset:16352
    buffer_load_dwordx4 v[192:195], v3, s[20:23], s53 offen offset:0
    s_waitcnt vmcnt(16)
    s_barrier
    s_waitcnt lgkmcnt(10)
    v_mfma_f32_32x32x16_bf16 v[32:47], v[152:155], v[196:199], v[32:47]
    ds_read_b64_tr_b16 v[128:129], v12 offset:24704
    ds_read_b64_tr_b16 v[130:131], v12 offset:25472
    s_waitcnt lgkmcnt(10)
    v_mfma_f32_32x32x16_bf16 v[48:63], v[156:159], v[196:199], v[48:63]
    ds_read_b64_tr_b16 v[132:133], v12 offset:24736
    ds_read_b64_tr_b16 v[134:135], v12 offset:25504
    s_add_u32 m0, s58, 37056
    s_nop 0
    buffer_load_dwordx4 v8, s[72:75], s57 offen lds
    s_waitcnt lgkmcnt(10)
    v_mfma_f32_32x32x16_bf16 v[64:79], v[160:163], v[196:199], v[64:79]
    ds_read_b64_tr_b16 v[136:137], v12 offset:24768
    ds_read_b64_tr_b16 v[138:139], v12 offset:25536
    s_waitcnt lgkmcnt(10)
    v_mfma_f32_32x32x16_bf16 v[80:95], v[164:167], v[196:199], v[80:95]
    ds_read_b64_tr_b16 v[140:141], v12 offset:24800
    ds_read_b64_tr_b16 v[142:143], v12 offset:25568
    s_add_u32 m0, s58, 38080
    s_nop 0
    buffer_load_dwordx4 v9, s[72:75], s57 offen lds
    s_waitcnt lgkmcnt(10)
    v_mfma_f32_32x32x16_bf16 v[96:111], v[168:171], v[196:199], v[96:111]
    ds_read_b64_tr_b16 v[144:145], v12 offset:24832
    ds_read_b64_tr_b16 v[146:147], v12 offset:25600
    s_waitcnt lgkmcnt(10)
    v_mfma_f32_32x32x16_bf16 v[112:127], v[172:175], v[196:199], v[112:127]
    ds_read_b64_tr_b16 v[148:149], v12 offset:24864
    ds_read_b64_tr_b16 v[150:151], v12 offset:25632
    s_add_u32 m0, s58, 39104
    s_nop 0
    buffer_load_dwordx4 v10, s[72:75], s57 offen lds
    s_add_u32 s57, s57, 88064
    s_waitcnt vmcnt(18)
    s_waitcnt lgkmcnt(10)
    v_mfma_f32_32x32x16_bf16 v[32:47], v[128:131], v[200:203], v[32:47]
    ds_read_b64_tr_b16 v[152:153], v12 offset:27776
    ds_read_b64_tr_b16 v[154:155], v12 offset:28544
    s_waitcnt lgkmcnt(10)
    v_mfma_f32_32x32x16_bf16 v[48:63], v[132:135], v[200:203], v[48:63]
    ds_read_b64_tr_b16 v[156:157], v12 offset:27808
    ds_read_b64_tr_b16 v[158:159], v12 offset:28576
    buffer_load_dwordx4 v[196:199], v3, s[20:23], s53 offen offset:1024
    s_waitcnt lgkmcnt(10)
    v_mfma_f32_32x32x16_bf16 v[64:79], v[136:139], v[200:203], v[64:79]
    ds_read_b64_tr_b16 v[160:161], v12 offset:27840
    ds_read_b64_tr_b16 v[162:163], v12 offset:28608
    s_waitcnt lgkmcnt(10)
    v_mfma_f32_32x32x16_bf16 v[80:95], v[140:143], v[200:203], v[80:95]
    ds_read_b64_tr_b16 v[164:165], v12 offset:27872
    ds_read_b64_tr_b16 v[166:167], v12 offset:28640
    s_waitcnt lgkmcnt(10)
    v_mfma_f32_32x32x16_bf16 v[96:111], v[144:147], v[200:203], v[96:111]
    ds_read_b64_tr_b16 v[168:169], v12 offset:27904
    ds_read_b64_tr_b16 v[170:171], v12 offset:28672
    s_waitcnt lgkmcnt(10)
    v_mfma_f32_32x32x16_bf16 v[112:127], v[148:151], v[200:203], v[112:127]
    ds_read_b64_tr_b16 v[172:173], v12 offset:27936
    ds_read_b64_tr_b16 v[174:175], v12 offset:28704
    buffer_load_dwordx4 v[200:203], v3, s[20:23], s53 offen offset:2048
    s_waitcnt vmcnt(16)
    s_barrier
    s_waitcnt lgkmcnt(10)
    v_mfma_f32_32x32x16_bf16 v[32:47], v[152:155], v[204:207], v[32:47]
    ds_read_b64_tr_b16 v[128:129], v11 offset:0
    ds_read_b64_tr_b16 v[130:131], v11 offset:768
    s_waitcnt lgkmcnt(10)
    v_mfma_f32_32x32x16_bf16 v[48:63], v[156:159], v[204:207], v[48:63]
    ds_read_b64_tr_b16 v[132:133], v11 offset:32
    ds_read_b64_tr_b16 v[134:135], v11 offset:800
    s_waitcnt lgkmcnt(10)
    v_mfma_f32_32x32x16_bf16 v[64:79], v[160:163], v[204:207], v[64:79]
    ds_read_b64_tr_b16 v[136:137], v11 offset:64
    ds_read_b64_tr_b16 v[138:139], v11 offset:832
    s_waitcnt lgkmcnt(10)
    v_mfma_f32_32x32x16_bf16 v[80:95], v[164:167], v[204:207], v[80:95]
    ds_read_b64_tr_b16 v[140:141], v11 offset:96
    ds_read_b64_tr_b16 v[142:143], v11 offset:864
    s_waitcnt lgkmcnt(10)
    v_mfma_f32_32x32x16_bf16 v[96:111], v[168:171], v[204:207], v[96:111]
    ds_read_b64_tr_b16 v[144:145], v11 offset:128
    ds_read_b64_tr_b16 v[146:147], v11 offset:896
    s_waitcnt lgkmcnt(10)
    v_mfma_f32_32x32x16_bf16 v[112:127], v[172:175], v[204:207], v[112:127]
    ds_read_b64_tr_b16 v[148:149], v11 offset:160
    ds_read_b64_tr_b16 v[150:151], v11 offset:928
    buffer_load_dwordx4 v[204:207], v3, s[20:23], s53 offen offset:3072
    s_add_u32 s53, s53, 4096
    s_waitcnt vmcnt(16)
    s_waitcnt lgkmcnt(10)
    v_mfma_f32_32x32x16_bf16 v[32:47], v[128:131], v[176:179], v[32:47]
    ds_read_b64_tr_b16 v[152:153], v11 offset:3072
    ds_read_b64_tr_b16 v[154:155], v11 offset:3840
    s_waitcnt lgkmcnt(10)
    v_mfma_f32_32x32x16_bf16 v[48:63], v[132:135], v[176:179], v[48:63]
    ds_read_b64_tr_b16 v[156:157], v11 offset:3104
    ds_read_b64_tr_b16 v[158:159], v11 offset:3872
    s_waitcnt lgkmcnt(10)
    v_mfma_f32_32x32x16_bf16 v[64:79], v[136:139], v[176:179], v[64:79]
    ds_read_b64_tr_b16 v[160:161], v11 offset:3136
    ds_read_b64_tr_b16 v[162:163], v11 offset:3904
    s_waitcnt lgkmcnt(10)
    v_mfma_f32_32x32x16_bf16 v[80:95], v[140:143], v[176:179], v[80:95]
    ds_read_b64_tr_b16 v[164:165], v11 offset:3168
    ds_read_b64_tr_b16 v[166:167], v11 offset:3936
    s_waitcnt lgkmcnt(10)
    v_mfma_f32_32x32x16_bf16 v[96:111], v[144:147], v[176:179], v[96:111]
    ds_read_b64_tr_b16 v[168:169], v11 offset:3200
    ds_read_b64_tr_b16 v[170:171], v11 offset:3968
    s_waitcnt lgkmcnt(10)
    v_mfma_f32_32x32x16_bf16 v[112:127], v[148:151], v[176:179], v[112:127]
    ds_read_b64_tr_b16 v[172:173], v11 offset:3232
    ds_read_b64_tr_b16 v[174:175], v11 offset:4000
    s_waitcnt vmcnt(12)
    s_barrier
    s_waitcnt lgkmcnt(10)
    v_mfma_f32_32x32x16_bf16 v[32:47], v[152:155], v[180:183], v[32:47]
    ds_read_b64_tr_b16 v[128:129], v11 offset:12352
    ds_read_b64_tr_b16 v[130:131], v11 offset:13120
    s_waitcnt lgkmcnt(10)
    v_mfma_f32_32x32x16_bf16 v[48:63], v[156:159], v[180:183], v[48:63]
    ds_read_b64_tr_b16 v[132:133], v11 offset:12384
    ds_read_b64_tr_b16 v[134:135], v11 offset:13152
    s_waitcnt lgkmcnt(10)
    v_mfma_f32_32x32x16_bf16 v[64:79], v[160:163], v[180:183], v[64:79]
    ds_read_b64_tr_b16 v[136:137], v11 offset:12416
    ds_read_b64_tr_b16 v[138:139], v11 offset:13184
    s_waitcnt lgkmcnt(10)
    v_mfma_f32_32x32x16_bf16 v[80:95], v[164:167], v[180:183], v[80:95]
    ds_read_b64_tr_b16 v[140:141], v11 offset:12448
    ds_read_b64_tr_b16 v[142:143], v11 offset:13216
    s_waitcnt lgkmcnt(10)
    v_mfma_f32_32x32x16_bf16 v[96:111], v[168:171], v[180:183], v[96:111]
    ds_read_b64_tr_b16 v[144:145], v11 offset:12480
    ds_read_b64_tr_b16 v[146:147], v11 offset:13248
    s_waitcnt lgkmcnt(10)
    v_mfma_f32_32x32x16_bf16 v[112:127], v[172:175], v[180:183], v[112:127]
    ds_read_b64_tr_b16 v[148:149], v11 offset:12512
    ds_read_b64_tr_b16 v[150:151], v11 offset:13280
    s_waitcnt vmcnt(11)
    s_waitcnt lgkmcnt(10)
    v_mfma_f32_32x32x16_bf16 v[32:47], v[128:131], v[184:187], v[32:47]
    ds_read_b64_tr_b16 v[152:153], v11 offset:15424
    ds_read_b64_tr_b16 v[154:155], v11 offset:16192
    s_waitcnt lgkmcnt(10)
    v_mfma_f32_32x32x16_bf16 v[48:63], v[132:135], v[184:187], v[48:63]
    ds_read_b64_tr_b16 v[156:157], v11 offset:15456
    ds_read_b64_tr_b16 v[158:159], v11 offset:16224
    s_waitcnt lgkmcnt(10)
    v_mfma_f32_32x32x16_bf16 v[64:79], v[136:139], v[184:187], v[64:79]
    ds_read_b64_tr_b16 v[160:161], v11 offset:15488
    ds_read_b64_tr_b16 v[162:163], v11 offset:16256
    s_waitcnt lgkmcnt(10)
    v_mfma_f32_32x32x16_bf16 v[80:95], v[140:143], v[184:187], v[80:95]
    ds_read_b64_tr_b16 v[164:165], v11 offset:15520
    ds_read_b64_tr_b16 v[166:167], v11 offset:16288
    s_waitcnt lgkmcnt(10)
    v_mfma_f32_32x32x16_bf16 v[96:111], v[144:147], v[184:187], v[96:111]
    ds_read_b64_tr_b16 v[168:169], v11 offset:15552
    ds_read_b64_tr_b16 v[170:171], v11 offset:16320
    s_waitcnt lgkmcnt(10)
    v_mfma_f32_32x32x16_bf16 v[112:127], v[148:151], v[184:187], v[112:127]
    ds_read_b64_tr_b16 v[172:173], v11 offset:15584
    ds_read_b64_tr_b16 v[174:175], v11 offset:16352
    s_waitcnt vmcnt(7)
    s_barrier
    s_waitcnt lgkmcnt(10)
    v_mfma_f32_32x32x16_bf16 v[32:47], v[152:155], v[188:191], v[32:47]
    ds_read_b64_tr_b16 v[128:129], v11 offset:24704
    ds_read_b64_tr_b16 v[130:131], v11 offset:25472
    s_waitcnt lgkmcnt(10)
    v_mfma_f32_32x32x16_bf16 v[48:63], v[156:159], v[188:191], v[48:63]
    ds_read_b64_tr_b16 v[132:133], v11 offset:24736
    ds_read_b64_tr_b16 v[134:135], v11 offset:25504
    s_waitcnt lgkmcnt(10)
    v_mfma_f32_32x32x16_bf16 v[64:79], v[160:163], v[188:191], v[64:79]
    ds_read_b64_tr_b16 v[136:137], v11 offset:24768
    ds_read_b64_tr_b16 v[138:139], v11 offset:25536
    s_waitcnt lgkmcnt(10)
    v_mfma_f32_32x32x16_bf16 v[80:95], v[164:167], v[188:191], v[80:95]
    ds_read_b64_tr_b16 v[140:141], v11 offset:24800
    ds_read_b64_tr_b16 v[142:143], v11 offset:25568
    s_waitcnt lgkmcnt(10)
    v_mfma_f32_32x32x16_bf16 v[96:111], v[168:171], v[188:191], v[96:111]
    ds_read_b64_tr_b16 v[144:145], v11 offset:24832
    ds_read_b64_tr_b16 v[146:147], v11 offset:25600
    s_waitcnt lgkmcnt(10)
    v_mfma_f32_32x32x16_bf16 v[112:127], v[172:175], v[188:191], v[112:127]
    ds_read_b64_tr_b16 v[148:149], v11 offset:24864
    ds_read_b64_tr_b16 v[150:151], v11 offset:25632
    s_waitcnt vmcnt(6)
    s_waitcnt lgkmcnt(10)
    v_mfma_f32_32x32x16_bf16 v[32:47], v[128:131], v[192:195], v[32:47]
    ds_read_b64_tr_b16 v[152:153], v11 offset:27776
    ds_read_b64_tr_b16 v[154:155], v11 offset:28544
    s_waitcnt lgkmcnt(10)
    v_mfma_f32_32x32x16_bf16 v[48:63], v[132:135], v[192:195], v[48:63]
    ds_read_b64_tr_b16 v[156:157], v11 offset:27808
    ds_read_b64_tr_b16 v[158:159], v11 offset:28576
    s_waitcnt lgkmcnt(10)
    v_mfma_f32_32x32x16_bf16 v[64:79], v[136:139], v[192:195], v[64:79]
    ds_read_b64_tr_b16 v[160:161], v11 offset:27840
    ds_read_b64_tr_b16 v[162:163], v11 offset:28608
    s_waitcnt lgkmcnt(10)
    v_mfma_f32_32x32x16_bf16 v[80:95], v[140:143], v[192:195], v[80:95]
    ds_read_b64_tr_b16 v[164:165], v11 offset:27872
    ds_read_b64_tr_b16 v[166:167], v11 offset:28640
    s_waitcnt lgkmcnt(10)
    v_mfma_f32_32x32x16_bf16 v[96:111], v[144:147], v[192:195], v[96:111]
    ds_read_b64_tr_b16 v[168:169], v11 offset:27904
    ds_read_b64_tr_b16 v[170:171], v11 offset:28672
    s_waitcnt lgkmcnt(10)
    v_mfma_f32_32x32x16_bf16 v[112:127], v[148:151], v[192:195], v[112:127]
    ds_read_b64_tr_b16 v[172:173], v11 offset:27936
    ds_read_b64_tr_b16 v[174:175], v11 offset:28704
    s_waitcnt vmcnt(2)
    s_barrier
    s_waitcnt lgkmcnt(10)
    v_mfma_f32_32x32x16_bf16 v[32:47], v[152:155], v[196:199], v[32:47]
    ds_read_b64_tr_b16 v[128:129], v12 offset:0
    ds_read_b64_tr_b16 v[130:131], v12 offset:768
    s_waitcnt lgkmcnt(10)
    v_mfma_f32_32x32x16_bf16 v[48:63], v[156:159], v[196:199], v[48:63]
    ds_read_b64_tr_b16 v[132:133], v12 offset:32
    ds_read_b64_tr_b16 v[134:135], v12 offset:800
    s_waitcnt lgkmcnt(10)
    v_mfma_f32_32x32x16_bf16 v[64:79], v[160:163], v[196:199], v[64:79]
    ds_read_b64_tr_b16 v[136:137], v12 offset:64
    ds_read_b64_tr_b16 v[138:139], v12 offset:832
    s_waitcnt lgkmcnt(10)
    v_mfma_f32_32x32x16_bf16 v[80:95], v[164:167], v[196:199], v[80:95]
    ds_read_b64_tr_b16 v[140:141], v12 offset:96
    ds_read_b64_tr_b16 v[142:143], v12 offset:864
    s_waitcnt lgkmcnt(10)
    v_mfma_f32_32x32x16_bf16 v[96:111], v[168:171], v[196:199], v[96:111]
    ds_read_b64_tr_b16 v[144:145], v12 offset:128
    ds_read_b64_tr_b16 v[146:147], v12 offset:896
    s_waitcnt lgkmcnt(10)
    v_mfma_f32_32x32x16_bf16 v[112:127], v[172:175], v[196:199], v[112:127]
    ds_read_b64_tr_b16 v[148:149], v12 offset:160
    ds_read_b64_tr_b16 v[150:151], v12 offset:928
    s_waitcnt vmcnt(1)
    s_waitcnt lgkmcnt(10)
    v_mfma_f32_32x32x16_bf16 v[32:47], v[128:131], v[200:203], v[32:47]
    ds_read_b64_tr_b16 v[152:153], v12 offset:3072
    ds_read_b64_tr_b16 v[154:155], v12 offset:3840
    s_waitcnt lgkmcnt(10)
    v_mfma_f32_32x32x16_bf16 v[48:63], v[132:135], v[200:203], v[48:63]
    ds_read_b64_tr_b16 v[156:157], v12 offset:3104
    ds_read_b64_tr_b16 v[158:159], v12 offset:3872
    s_waitcnt lgkmcnt(10)
    v_mfma_f32_32x32x16_bf16 v[64:79], v[136:139], v[200:203], v[64:79]
    ds_read_b64_tr_b16 v[160:161], v12 offset:3136
    ds_read_b64_tr_b16 v[162:163], v12 offset:3904
    s_waitcnt lgkmcnt(10)
    v_mfma_f32_32x32x16_bf16 v[80:95], v[140:143], v[200:203], v[80:95]
    ds_read_b64_tr_b16 v[164:165], v12 offset:3168
    ds_read_b64_tr_b16 v[166:167], v12 offset:3936
    s_waitcnt lgkmcnt(10)
    v_mfma_f32_32x32x16_bf16 v[96:111], v[144:147], v[200:203], v[96:111]
    ds_read_b64_tr_b16 v[168:169], v12 offset:3200
    ds_read_b64_tr_b16 v[170:171], v12 offset:3968
    s_waitcnt lgkmcnt(10)
    v_mfma_f32_32x32x16_bf16 v[112:127], v[148:151], v[200:203], v[112:127]
    ds_read_b64_tr_b16 v[172:173], v12 offset:3232
    ds_read_b64_tr_b16 v[174:175], v12 offset:4000
    s_waitcnt vmcnt(0)
    s_waitcnt lgkmcnt(10)
    v_mfma_f32_32x32x16_bf16 v[32:47], v[152:155], v[204:207], v[32:47]
    s_waitcnt lgkmcnt(8)
    v_mfma_f32_32x32x16_bf16 v[48:63], v[156:159], v[204:207], v[48:63]
    s_waitcnt lgkmcnt(6)
    v_mfma_f32_32x32x16_bf16 v[64:79], v[160:163], v[204:207], v[64:79]
    s_waitcnt lgkmcnt(4)
    v_mfma_f32_32x32x16_bf16 v[80:95], v[164:167], v[204:207], v[80:95]
    s_waitcnt lgkmcnt(2)
    v_mfma_f32_32x32x16_bf16 v[96:111], v[168:171], v[204:207], v[96:111]
    s_waitcnt lgkmcnt(0)
    s_barrier
    v_mfma_f32_32x32x16_bf16 v[112:127], v[172:175], v[204:207], v[112:127]
    s_nop 0
    v_cvt_pk_bf16_f32 v128, v32, v33
    v_cvt_pk_bf16_f32 v129, v40, v41
    v_cvt_pk_bf16_f32 v132, v34, v35
    v_cvt_pk_bf16_f32 v133, v42, v43
    v_cvt_pk_bf16_f32 v136, v36, v37
    v_cvt_pk_bf16_f32 v137, v44, v45
    v_cvt_pk_bf16_f32 v140, v38, v39
    v_cvt_pk_bf16_f32 v141, v46, v47
    v_lshlrev_b32 v32, 16, v128
    v_and_b32 v33, 0xffff0000, v128
    v_lshlrev_b32 v40, 16, v129
    v_and_b32 v41, 0xffff0000, v129
    v_lshlrev_b32 v34, 16, v132
    v_and_b32 v35, 0xffff0000, v132
    v_lshlrev_b32 v42, 16, v133
    v_and_b32 v43, 0xffff0000, v133
    v_lshlrev_b32 v36, 16, v136
    v_and_b32 v37, 0xffff0000, v136
    v_lshlrev_b32 v44, 16, v137
    v_and_b32 v45, 0xffff0000, v137
    v_lshlrev_b32 v38, 16, v140
    v_and_b32 v39, 0xffff0000, v140
    v_lshlrev_b32 v46, 16, v141
    v_and_b32 v47, 0xffff0000, v141
    v_pk_mul_f32 v[128:129], v[32:33], v[32:33]
    v_pk_mul_f32 v[132:133], v[34:35], v[34:35]
    v_pk_mul_f32 v[136:137], v[36:37], v[36:37]
    v_pk_mul_f32 v[140:141], v[38:39], v[38:39]
    v_pk_fma_f32 v[128:129], v[128:129], s[60:61], v[14:15]
    v_pk_fma_f32 v[132:133], v[132:133], s[60:61], v[14:15]
    v_pk_fma_f32 v[136:137], v[136:137], s[60:61], v[14:15]
    v_pk_fma_f32 v[140:141], v[140:141], s[60:61], v[14:15]
    v_pk_mul_f32 v[128:129], v[128:129], v[32:33]
    v_pk_mul_f32 v[132:133], v[132:133], v[34:35]
    v_pk_mul_f32 v[136:137], v[136:137], v[36:37]
    v_pk_mul_f32 v[140:141], v[140:141], v[38:39]
    v_exp_f32 v128, v128
    v_exp_f32 v129, v129
    v_exp_f32 v132, v132
    v_exp_f32 v133, v133
    v_exp_f32 v136, v136
    v_exp_f32 v137, v137
    v_exp_f32 v140, v140
    v_exp_f32 v141, v141
    v_pk_add_f32 v[128:129], v[128:129], 1.0 op_sel_hi:[1,0]
    v_pk_add_f32 v[132:133], v[132:133], 1.0 op_sel_hi:[1,0]
    v_pk_add_f32 v[136:137], v[136:137], 1.0 op_sel_hi:[1,0]
    v_pk_add_f32 v[140:141], v[140:141], 1.0 op_sel_hi:[1,0]
    v_rcp_f32 v128, v128
    v_rcp_f32 v129, v129
    v_rcp_f32 v132, v132
    v_rcp_f32 v133, v133
    v_rcp_f32 v136, v136
    v_rcp_f32 v137, v137
    v_rcp_f32 v140, v140
    v_rcp_f32 v141, v141
    v_pk_mul_f32 v[32:33], v[32:33], v[128:129]
    v_pk_mul_f32 v[34:35], v[34:35], v[132:133]
    v_pk_mul_f32 v[36:37], v[36:37], v[136:137]
    v_pk_mul_f32 v[38:39], v[38:39], v[140:141]
    v_cvt_pk_bf16_f32 v128, v32, v33
    v_cvt_pk_bf16_f32 v132, v34, v35
    v_cvt_pk_bf16_f32 v136, v36, v37
    v_cvt_pk_bf16_f32 v140, v38, v39
    v_lshlrev_b32 v32, 16, v128
    v_and_b32 v33, 0xffff0000, v128
    v_lshlrev_b32 v34, 16, v132
    v_and_b32 v35, 0xffff0000, v132
    v_lshlrev_b32 v36, 16, v136
    v_and_b32 v37, 0xffff0000, v136
    v_lshlrev_b32 v38, 16, v140
    v_and_b32 v39, 0xffff0000, v140
    v_pk_mul_f32 v[32:33], v[32:33], v[40:41]
    v_pk_mul_f32 v[34:35], v[34:35], v[42:43]
    v_pk_mul_f32 v[36:37], v[36:37], v[44:45]
    v_pk_mul_f32 v[38:39], v[38:39], v[46:47]
    v_cvt_pk_bf16_f32 v144, v32, v33
    v_cvt_pk_bf16_f32 v145, v34, v35
    v_cvt_pk_bf16_f32 v146, v36, v37
    v_cvt_pk_bf16_f32 v147, v38, v39
    buffer_store_dwordx4 v[144:147], v2, s[76:79], s59 offen sc0 sc1
    s_add_u32 s59, s59, 131072
    v_cvt_pk_bf16_f32 v152, v48, v49
    v_cvt_pk_bf16_f32 v153, v56, v57
    v_cvt_pk_bf16_f32 v156, v50, v51
    v_cvt_pk_bf16_f32 v157, v58, v59
    v_cvt_pk_bf16_f32 v160, v52, v53
    v_cvt_pk_bf16_f32 v161, v60, v61
    v_cvt_pk_bf16_f32 v164, v54, v55
    v_cvt_pk_bf16_f32 v165, v62, v63
    v_lshlrev_b32 v48, 16, v152
    v_and_b32 v49, 0xffff0000, v152
    v_lshlrev_b32 v56, 16, v153
    v_and_b32 v57, 0xffff0000, v153
    v_lshlrev_b32 v50, 16, v156
    v_and_b32 v51, 0xffff0000, v156
    v_lshlrev_b32 v58, 16, v157
    v_and_b32 v59, 0xffff0000, v157
    v_lshlrev_b32 v52, 16, v160
    v_and_b32 v53, 0xffff0000, v160
    v_lshlrev_b32 v60, 16, v161
    v_and_b32 v61, 0xffff0000, v161
    v_lshlrev_b32 v54, 16, v164
    v_and_b32 v55, 0xffff0000, v164
    v_lshlrev_b32 v62, 16, v165
    v_and_b32 v63, 0xffff0000, v165
    v_pk_mul_f32 v[152:153], v[48:49], v[48:49]
    v_pk_mul_f32 v[156:157], v[50:51], v[50:51]
    v_pk_mul_f32 v[160:161], v[52:53], v[52:53]
    v_pk_mul_f32 v[164:165], v[54:55], v[54:55]
    v_pk_fma_f32 v[152:153], v[152:153], s[60:61], v[14:15]
    v_pk_fma_f32 v[156:157], v[156:157], s[60:61], v[14:15]
    v_pk_fma_f32 v[160:161], v[160:161], s[60:61], v[14:15]
    v_pk_fma_f32 v[164:165], v[164:165], s[60:61], v[14:15]
    v_pk_mul_f32 v[152:153], v[152:153], v[48:49]
    v_pk_mul_f32 v[156:157], v[156:157], v[50:51]
    v_pk_mul_f32 v[160:161], v[160:161], v[52:53]
    v_pk_mul_f32 v[164:165], v[164:165], v[54:55]
    v_exp_f32 v152, v152
    v_exp_f32 v153, v153
    v_exp_f32 v156, v156
    v_exp_f32 v157, v157
    v_exp_f32 v160, v160
    v_exp_f32 v161, v161
    v_exp_f32 v164, v164
    v_exp_f32 v165, v165
    v_pk_add_f32 v[152:153], v[152:153], 1.0 op_sel_hi:[1,0]
    v_pk_add_f32 v[156:157], v[156:157], 1.0 op_sel_hi:[1,0]
    v_pk_add_f32 v[160:161], v[160:161], 1.0 op_sel_hi:[1,0]
    v_pk_add_f32 v[164:165], v[164:165], 1.0 op_sel_hi:[1,0]
    v_rcp_f32 v152, v152
    v_rcp_f32 v153, v153
    v_rcp_f32 v156, v156
    v_rcp_f32 v157, v157
    v_rcp_f32 v160, v160
    v_rcp_f32 v161, v161
    v_rcp_f32 v164, v164
    v_rcp_f32 v165, v165
    v_pk_mul_f32 v[48:49], v[48:49], v[152:153]
    v_pk_mul_f32 v[50:51], v[50:51], v[156:157]
    v_pk_mul_f32 v[52:53], v[52:53], v[160:161]
    v_pk_mul_f32 v[54:55], v[54:55], v[164:165]
    v_cvt_pk_bf16_f32 v152, v48, v49
    v_cvt_pk_bf16_f32 v156, v50, v51
    v_cvt_pk_bf16_f32 v160, v52, v53
    v_cvt_pk_bf16_f32 v164, v54, v55
    v_lshlrev_b32 v48, 16, v152
    v_and_b32 v49, 0xffff0000, v152
    v_lshlrev_b32 v50, 16, v156
    v_and_b32 v51, 0xffff0000, v156
    v_lshlrev_b32 v52, 16, v160
    v_and_b32 v53, 0xffff0000, v160
    v_lshlrev_b32 v54, 16, v164
    v_and_b32 v55, 0xffff0000, v164
    v_pk_mul_f32 v[48:49], v[48:49], v[56:57]
    v_pk_mul_f32 v[50:51], v[50:51], v[58:59]
    v_pk_mul_f32 v[52:53], v[52:53], v[60:61]
    v_pk_mul_f32 v[54:55], v[54:55], v[62:63]
    v_cvt_pk_bf16_f32 v168, v48, v49
    v_cvt_pk_bf16_f32 v169, v50, v51
    v_cvt_pk_bf16_f32 v170, v52, v53
    v_cvt_pk_bf16_f32 v171, v54, v55
    buffer_store_dwordx4 v[168:171], v2, s[76:79], s59 offen sc0 sc1
    s_add_u32 s59, s59, 131072
    v_cvt_pk_bf16_f32 v176, v64, v65
    v_cvt_pk_bf16_f32 v177, v72, v73
    v_cvt_pk_bf16_f32 v180, v66, v67
    v_cvt_pk_bf16_f32 v181, v74, v75
    v_cvt_pk_bf16_f32 v184, v68, v69
    v_cvt_pk_bf16_f32 v185, v76, v77
    v_cvt_pk_bf16_f32 v188, v70, v71
    v_cvt_pk_bf16_f32 v189, v78, v79
    v_lshlrev_b32 v64, 16, v176
    v_and_b32 v65, 0xffff0000, v176
    v_lshlrev_b32 v72, 16, v177
    v_and_b32 v73, 0xffff0000, v177
    v_lshlrev_b32 v66, 16, v180
    v_and_b32 v67, 0xffff0000, v180
    v_lshlrev_b32 v74, 16, v181
    v_and_b32 v75, 0xffff0000, v181
    v_lshlrev_b32 v68, 16, v184
    v_and_b32 v69, 0xffff0000, v184
    v_lshlrev_b32 v76, 16, v185
    v_and_b32 v77, 0xffff0000, v185
    v_lshlrev_b32 v70, 16, v188
    v_and_b32 v71, 0xffff0000, v188
    v_lshlrev_b32 v78, 16, v189
    v_and_b32 v79, 0xffff0000, v189
    v_pk_mul_f32 v[176:177], v[64:65], v[64:65]
    v_pk_mul_f32 v[180:181], v[66:67], v[66:67]
    v_pk_mul_f32 v[184:185], v[68:69], v[68:69]
    v_pk_mul_f32 v[188:189], v[70:71], v[70:71]
    v_pk_fma_f32 v[176:177], v[176:177], s[60:61], v[14:15]
    v_pk_fma_f32 v[180:181], v[180:181], s[60:61], v[14:15]
    v_pk_fma_f32 v[184:185], v[184:185], s[60:61], v[14:15]
    v_pk_fma_f32 v[188:189], v[188:189], s[60:61], v[14:15]
    v_pk_mul_f32 v[176:177], v[176:177], v[64:65]
    v_pk_mul_f32 v[180:181], v[180:181], v[66:67]
    v_pk_mul_f32 v[184:185], v[184:185], v[68:69]
    v_pk_mul_f32 v[188:189], v[188:189], v[70:71]
    v_exp_f32 v176, v176
    v_exp_f32 v177, v177
    v_exp_f32 v180, v180
    v_exp_f32 v181, v181
    v_exp_f32 v184, v184
    v_exp_f32 v185, v185
    v_exp_f32 v188, v188
    v_exp_f32 v189, v189
    v_pk_add_f32 v[176:177], v[176:177], 1.0 op_sel_hi:[1,0]
    v_pk_add_f32 v[180:181], v[180:181], 1.0 op_sel_hi:[1,0]
    v_pk_add_f32 v[184:185], v[184:185], 1.0 op_sel_hi:[1,0]
    v_pk_add_f32 v[188:189], v[188:189], 1.0 op_sel_hi:[1,0]
    v_rcp_f32 v176, v176
    v_rcp_f32 v177, v177
    v_rcp_f32 v180, v180
    v_rcp_f32 v181, v181
    v_rcp_f32 v184, v184
    v_rcp_f32 v185, v185
    v_rcp_f32 v188, v188
    v_rcp_f32 v189, v189
    v_pk_mul_f32 v[64:65], v[64:65], v[176:177]
    v_pk_mul_f32 v[66:67], v[66:67], v[180:181]
    v_pk_mul_f32 v[68:69], v[68:69], v[184:185]
    v_pk_mul_f32 v[70:71], v[70:71], v[188:189]
    v_cvt_pk_bf16_f32 v176, v64, v65
    v_cvt_pk_bf16_f32 v180, v66, v67
    v_cvt_pk_bf16_f32 v184, v68, v69
    v_cvt_pk_bf16_f32 v188, v70, v71
    v_lshlrev_b32 v64, 16, v176
    v_and_b32 v65, 0xffff0000, v176
    v_lshlrev_b32 v66, 16, v180
    v_and_b32 v67, 0xffff0000, v180
    v_lshlrev_b32 v68, 16, v184
    v_and_b32 v69, 0xffff0000, v184
    v_lshlrev_b32 v70, 16, v188
    v_and_b32 v71, 0xffff0000, v188
    v_pk_mul_f32 v[64:65], v[64:65], v[72:73]
    v_pk_mul_f32 v[66:67], v[66:67], v[74:75]
    v_pk_mul_f32 v[68:69], v[68:69], v[76:77]
    v_pk_mul_f32 v[70:71], v[70:71], v[78:79]
    v_cvt_pk_bf16_f32 v192, v64, v65
    v_cvt_pk_bf16_f32 v193, v66, v67
    v_cvt_pk_bf16_f32 v194, v68, v69
    v_cvt_pk_bf16_f32 v195, v70, v71
    buffer_store_dwordx4 v[192:195], v2, s[76:79], s59 offen sc0 sc1
    s_add_u32 s59, s59, 131072
    v_cvt_pk_bf16_f32 v128, v80, v81
    v_cvt_pk_bf16_f32 v129, v88, v89
    v_cvt_pk_bf16_f32 v132, v82, v83
    v_cvt_pk_bf16_f32 v133, v90, v91
    v_cvt_pk_bf16_f32 v136, v84, v85
    v_cvt_pk_bf16_f32 v137, v92, v93
    v_cvt_pk_bf16_f32 v140, v86, v87
    v_cvt_pk_bf16_f32 v141, v94, v95
    v_lshlrev_b32 v80, 16, v128
    v_and_b32 v81, 0xffff0000, v128
    v_lshlrev_b32 v88, 16, v129
    v_and_b32 v89, 0xffff0000, v129
    v_lshlrev_b32 v82, 16, v132
    v_and_b32 v83, 0xffff0000, v132
    v_lshlrev_b32 v90, 16, v133
    v_and_b32 v91, 0xffff0000, v133
    v_lshlrev_b32 v84, 16, v136
    v_and_b32 v85, 0xffff0000, v136
    v_lshlrev_b32 v92, 16, v137
    v_and_b32 v93, 0xffff0000, v137
    v_lshlrev_b32 v86, 16, v140
    v_and_b32 v87, 0xffff0000, v140
    v_lshlrev_b32 v94, 16, v141
    v_and_b32 v95, 0xffff0000, v141
    v_pk_mul_f32 v[128:129], v[80:81], v[80:81]
    v_pk_mul_f32 v[132:133], v[82:83], v[82:83]
    v_pk_mul_f32 v[136:137], v[84:85], v[84:85]
    v_pk_mul_f32 v[140:141], v[86:87], v[86:87]
    v_pk_fma_f32 v[128:129], v[128:129], s[60:61], v[14:15]
    v_pk_fma_f32 v[132:133], v[132:133], s[60:61], v[14:15]
    v_pk_fma_f32 v[136:137], v[136:137], s[60:61], v[14:15]
    v_pk_fma_f32 v[140:141], v[140:141], s[60:61], v[14:15]
    v_pk_mul_f32 v[128:129], v[128:129], v[80:81]
    v_pk_mul_f32 v[132:133], v[132:133], v[82:83]
    v_pk_mul_f32 v[136:137], v[136:137], v[84:85]
    v_pk_mul_f32 v[140:141], v[140:141], v[86:87]
    v_exp_f32 v128, v128
    v_exp_f32 v129, v129
    v_exp_f32 v132, v132
    v_exp_f32 v133, v133
    v_exp_f32 v136, v136
    v_exp_f32 v137, v137
    v_exp_f32 v140, v140
    v_exp_f32 v141, v141
    v_pk_add_f32 v[128:129], v[128:129], 1.0 op_sel_hi:[1,0]
    v_pk_add_f32 v[132:133], v[132:133], 1.0 op_sel_hi:[1,0]
    v_pk_add_f32 v[136:137], v[136:137], 1.0 op_sel_hi:[1,0]
    v_pk_add_f32 v[140:141], v[140:141], 1.0 op_sel_hi:[1,0]
    v_rcp_f32 v128, v128
    v_rcp_f32 v129, v129
    v_rcp_f32 v132, v132
    v_rcp_f32 v133, v133
    v_rcp_f32 v136, v136
    v_rcp_f32 v137, v137
    v_rcp_f32 v140, v140
    v_rcp_f32 v141, v141
    v_pk_mul_f32 v[80:81], v[80:81], v[128:129]
    v_pk_mul_f32 v[82:83], v[82:83], v[132:133]
    v_pk_mul_f32 v[84:85], v[84:85], v[136:137]
    v_pk_mul_f32 v[86:87], v[86:87], v[140:141]
    v_cvt_pk_bf16_f32 v128, v80, v81
    v_cvt_pk_bf16_f32 v132, v82, v83
    v_cvt_pk_bf16_f32 v136, v84, v85
    v_cvt_pk_bf16_f32 v140, v86, v87
    v_lshlrev_b32 v80, 16, v128
    v_and_b32 v81, 0xffff0000, v128
    v_lshlrev_b32 v82, 16, v132
    v_and_b32 v83, 0xffff0000, v132
    v_lshlrev_b32 v84, 16, v136
    v_and_b32 v85, 0xffff0000, v136
    v_lshlrev_b32 v86, 16, v140
    v_and_b32 v87, 0xffff0000, v140
    v_pk_mul_f32 v[80:81], v[80:81], v[88:89]
    v_pk_mul_f32 v[82:83], v[82:83], v[90:91]
    v_pk_mul_f32 v[84:85], v[84:85], v[92:93]
    v_pk_mul_f32 v[86:87], v[86:87], v[94:95]
    v_cvt_pk_bf16_f32 v144, v80, v81
    v_cvt_pk_bf16_f32 v145, v82, v83
    v_cvt_pk_bf16_f32 v146, v84, v85
    v_cvt_pk_bf16_f32 v147, v86, v87
    buffer_store_dwordx4 v[144:147], v2, s[76:79], s59 offen sc0 sc1
    s_add_u32 s59, s59, 131072
    v_cvt_pk_bf16_f32 v152, v96, v97
    v_cvt_pk_bf16_f32 v153, v104, v105
    v_cvt_pk_bf16_f32 v156, v98, v99
    v_cvt_pk_bf16_f32 v157, v106, v107
    v_cvt_pk_bf16_f32 v160, v100, v101
    v_cvt_pk_bf16_f32 v161, v108, v109
    v_cvt_pk_bf16_f32 v164, v102, v103
    v_cvt_pk_bf16_f32 v165, v110, v111
    v_lshlrev_b32 v96, 16, v152
    v_and_b32 v97, 0xffff0000, v152
    v_lshlrev_b32 v104, 16, v153
    v_and_b32 v105, 0xffff0000, v153
    v_lshlrev_b32 v98, 16, v156
    v_and_b32 v99, 0xffff0000, v156
    v_lshlrev_b32 v106, 16, v157
    v_and_b32 v107, 0xffff0000, v157
    v_lshlrev_b32 v100, 16, v160
    v_and_b32 v101, 0xffff0000, v160
    v_lshlrev_b32 v108, 16, v161
    v_and_b32 v109, 0xffff0000, v161
    v_lshlrev_b32 v102, 16, v164
    v_and_b32 v103, 0xffff0000, v164
    v_lshlrev_b32 v110, 16, v165
    v_and_b32 v111, 0xffff0000, v165
    v_pk_mul_f32 v[152:153], v[96:97], v[96:97]
    v_pk_mul_f32 v[156:157], v[98:99], v[98:99]
    v_pk_mul_f32 v[160:161], v[100:101], v[100:101]
    v_pk_mul_f32 v[164:165], v[102:103], v[102:103]
    v_pk_fma_f32 v[152:153], v[152:153], s[60:61], v[14:15]
    v_pk_fma_f32 v[156:157], v[156:157], s[60:61], v[14:15]
    v_pk_fma_f32 v[160:161], v[160:161], s[60:61], v[14:15]
    v_pk_fma_f32 v[164:165], v[164:165], s[60:61], v[14:15]
    v_pk_mul_f32 v[152:153], v[152:153], v[96:97]
    v_pk_mul_f32 v[156:157], v[156:157], v[98:99]
    v_pk_mul_f32 v[160:161], v[160:161], v[100:101]
    v_pk_mul_f32 v[164:165], v[164:165], v[102:103]
    v_exp_f32 v152, v152
    v_exp_f32 v153, v153
    v_exp_f32 v156, v156
    v_exp_f32 v157, v157
    v_exp_f32 v160, v160
    v_exp_f32 v161, v161
    v_exp_f32 v164, v164
    v_exp_f32 v165, v165
    v_pk_add_f32 v[152:153], v[152:153], 1.0 op_sel_hi:[1,0]
    v_pk_add_f32 v[156:157], v[156:157], 1.0 op_sel_hi:[1,0]
    v_pk_add_f32 v[160:161], v[160:161], 1.0 op_sel_hi:[1,0]
    v_pk_add_f32 v[164:165], v[164:165], 1.0 op_sel_hi:[1,0]
    v_rcp_f32 v152, v152
    v_rcp_f32 v153, v153
    v_rcp_f32 v156, v156
    v_rcp_f32 v157, v157
    v_rcp_f32 v160, v160
    v_rcp_f32 v161, v161
    v_rcp_f32 v164, v164
    v_rcp_f32 v165, v165
    v_pk_mul_f32 v[96:97], v[96:97], v[152:153]
    v_pk_mul_f32 v[98:99], v[98:99], v[156:157]
    v_pk_mul_f32 v[100:101], v[100:101], v[160:161]
    v_pk_mul_f32 v[102:103], v[102:103], v[164:165]
    v_cvt_pk_bf16_f32 v152, v96, v97
    v_cvt_pk_bf16_f32 v156, v98, v99
    v_cvt_pk_bf16_f32 v160, v100, v101
    v_cvt_pk_bf16_f32 v164, v102, v103
    v_lshlrev_b32 v96, 16, v152
    v_and_b32 v97, 0xffff0000, v152
    v_lshlrev_b32 v98, 16, v156
    v_and_b32 v99, 0xffff0000, v156
    v_lshlrev_b32 v100, 16, v160
    v_and_b32 v101, 0xffff0000, v160
    v_lshlrev_b32 v102, 16, v164
    v_and_b32 v103, 0xffff0000, v164
    v_pk_mul_f32 v[96:97], v[96:97], v[104:105]
    v_pk_mul_f32 v[98:99], v[98:99], v[106:107]
    v_pk_mul_f32 v[100:101], v[100:101], v[108:109]
    v_pk_mul_f32 v[102:103], v[102:103], v[110:111]
    v_cvt_pk_bf16_f32 v168, v96, v97
    v_cvt_pk_bf16_f32 v169, v98, v99
    v_cvt_pk_bf16_f32 v170, v100, v101
    v_cvt_pk_bf16_f32 v171, v102, v103
    buffer_store_dwordx4 v[168:171], v2, s[76:79], s59 offen sc0 sc1
    s_add_u32 s59, s59, 131072
    v_cvt_pk_bf16_f32 v176, v112, v113
    v_cvt_pk_bf16_f32 v177, v120, v121
    v_cvt_pk_bf16_f32 v180, v114, v115
    v_cvt_pk_bf16_f32 v181, v122, v123
    v_cvt_pk_bf16_f32 v184, v116, v117
    v_cvt_pk_bf16_f32 v185, v124, v125
    v_cvt_pk_bf16_f32 v188, v118, v119
    v_cvt_pk_bf16_f32 v189, v126, v127
    v_lshlrev_b32 v112, 16, v176
    v_and_b32 v113, 0xffff0000, v176
    v_lshlrev_b32 v120, 16, v177
    v_and_b32 v121, 0xffff0000, v177
    v_lshlrev_b32 v114, 16, v180
    v_and_b32 v115, 0xffff0000, v180
    v_lshlrev_b32 v122, 16, v181
    v_and_b32 v123, 0xffff0000, v181
    v_lshlrev_b32 v116, 16, v184
    v_and_b32 v117, 0xffff0000, v184
    v_lshlrev_b32 v124, 16, v185
    v_and_b32 v125, 0xffff0000, v185
    v_lshlrev_b32 v118, 16, v188
    v_and_b32 v119, 0xffff0000, v188
    v_lshlrev_b32 v126, 16, v189
    v_and_b32 v127, 0xffff0000, v189
    v_pk_mul_f32 v[176:177], v[112:113], v[112:113]
    v_pk_mul_f32 v[180:181], v[114:115], v[114:115]
    v_pk_mul_f32 v[184:185], v[116:117], v[116:117]
    v_pk_mul_f32 v[188:189], v[118:119], v[118:119]
    v_pk_fma_f32 v[176:177], v[176:177], s[60:61], v[14:15]
    v_pk_fma_f32 v[180:181], v[180:181], s[60:61], v[14:15]
    v_pk_fma_f32 v[184:185], v[184:185], s[60:61], v[14:15]
    v_pk_fma_f32 v[188:189], v[188:189], s[60:61], v[14:15]
    v_pk_mul_f32 v[176:177], v[176:177], v[112:113]
    v_pk_mul_f32 v[180:181], v[180:181], v[114:115]
    v_pk_mul_f32 v[184:185], v[184:185], v[116:117]
    v_pk_mul_f32 v[188:189], v[188:189], v[118:119]
    v_exp_f32 v176, v176
    v_exp_f32 v177, v177
    v_exp_f32 v180, v180
    v_exp_f32 v181, v181
    v_exp_f32 v184, v184
    v_exp_f32 v185, v185
    v_exp_f32 v188, v188
    v_exp_f32 v189, v189
    v_pk_add_f32 v[176:177], v[176:177], 1.0 op_sel_hi:[1,0]
    v_pk_add_f32 v[180:181], v[180:181], 1.0 op_sel_hi:[1,0]
    v_pk_add_f32 v[184:185], v[184:185], 1.0 op_sel_hi:[1,0]
    v_pk_add_f32 v[188:189], v[188:189], 1.0 op_sel_hi:[1,0]
    v_rcp_f32 v176, v176
    v_rcp_f32 v177, v177
    v_rcp_f32 v180, v180
    v_rcp_f32 v181, v181
    v_rcp_f32 v184, v184
    v_rcp_f32 v185, v185
    v_rcp_f32 v188, v188
    v_rcp_f32 v189, v189
    v_pk_mul_f32 v[112:113], v[112:113], v[176:177]
    v_pk_mul_f32 v[114:115], v[114:115], v[180:181]
    v_pk_mul_f32 v[116:117], v[116:117], v[184:185]
    v_pk_mul_f32 v[118:119], v[118:119], v[188:189]
    v_cvt_pk_bf16_f32 v176, v112, v113
    v_cvt_pk_bf16_f32 v180, v114, v115
    v_cvt_pk_bf16_f32 v184, v116, v117
    v_cvt_pk_bf16_f32 v188, v118, v119
    v_lshlrev_b32 v112, 16, v176
    v_and_b32 v113, 0xffff0000, v176
    v_lshlrev_b32 v114, 16, v180
    v_and_b32 v115, 0xffff0000, v180
    v_lshlrev_b32 v116, 16, v184
    v_and_b32 v117, 0xffff0000, v184
    v_lshlrev_b32 v118, 16, v188
    v_and_b32 v119, 0xffff0000, v188
    v_pk_mul_f32 v[112:113], v[112:113], v[120:121]
    v_pk_mul_f32 v[114:115], v[114:115], v[122:123]
    v_pk_mul_f32 v[116:117], v[116:117], v[124:125]
    v_pk_mul_f32 v[118:119], v[118:119], v[126:127]
    v_cvt_pk_bf16_f32 v192, v112, v113
    v_cvt_pk_bf16_f32 v193, v114, v115
    v_cvt_pk_bf16_f32 v194, v116, v117
    v_cvt_pk_bf16_f32 v195, v118, v119
    buffer_store_dwordx4 v[192:195], v2, s[76:79], s59 offen sc0 sc1
    s_add_u32 s59, s59, 131072
    s_mul_i32 s3, s70, 4352
    s_lshl_b32 s59, s71, 2
    s_add_u32 s59, s59, s3
    s_add_u32 s59, s59, 263168
    v_mov_b32 v18, 1
    v_mov_b32 v19, 0
    s_waitcnt vmcnt(0)
    s_barrier
    s_cmp_lg_u32 s50, 0
    s_cbranch_scc1 L_g_nof
    s_mov_b64 exec, 1
    buffer_store_dword v18, v19, s[32:35], s59 offen sc0 sc1
    s_mov_b64 exec, -1
    s_nop 0
L_g_nof:
    s_add_u32 m0, s62, 0
    s_nop 0
    buffer_load_dwordx4 v17, s[24:27], s64 offen lds
    s_add_u32 s64, s64, s44
    s_add_u32 m0, s62, 1024
    s_nop 0
    buffer_load_dwordx4 v17, s[24:27], s64 offen lds
    s_add_u32 s64, s64, s44
    s_add_u32 m0, s62, 2048
    s_nop 0
    buffer_load_dwordx4 v17, s[24:27], s64 offen lds
    s_add_u32 s64, s64, s44
    s_add_u32 m0, s62, 3072
    s_nop 0
    buffer_load_dwordx4 v17, s[24:27], s64 offen lds
    s_add_u32 s64, s64, s44
    s_add_u32 m0, s62, 4096
    s_nop 0
    buffer_load_dwordx4 v17, s[24:27], s64 offen lds
    s_add_u32 s64, s64, s44
    s_add_u32 m0, s62, 5120
    s_nop 0
    buffer_load_dwordx4 v17, s[24:27], s64 offen lds
    s_add_u32 s64, s64, s44
    s_add_u32 m0, s62, 6144
    s_nop 0
    buffer_load_dwordx4 v17, s[24:27], s64 offen lds
    s_add_u32 s64, s64, s44
    s_add_u32 m0, s62, 7168
    s_nop 0
    buffer_load_dwordx4 v17, s[24:27], s64 offen lds
    s_add_u32 s64, s64, s44
    s_add_u32 m0, s62, 8192
    s_nop 0
    buffer_load_dwordx4 v17, s[24:27], s64 offen lds
    s_add_u32 s64, s64, s44
    s_add_u32 m0, s62, 9216
    s_nop 0
    buffer_load_dwordx4 v17, s[24:27], s64 offen lds
    s_add_u32 s64, s64, s44
    s_add_u32 m0, s62, 10240
    s_nop 0
    buffer_load_dwordx4 v17, s[24:27], s64 offen lds
    s_add_u32 s64, s64, s44
    s_add_u32 m0, s62, 11264
    s_nop 0
    buffer_load_dwordx4 v17, s[24:27], s64 offen lds
    s_add_u32 s64, s64, s44
    s_add_u32 m0, s62, 12288
    s_nop 0
    buffer_load_dwordx4 v17, s[24:27], s64 offen lds
    s_add_u32 s64, s64, s44
    s_add_u32 m0, s62, 13312
    s_nop 0
    buffer_load_dwordx4 v17, s[24:27], s64 offen lds
    s_add_u32 s64, s64, s44
    s_add_u32 m0, s62, 14336
    s_nop 0
    buffer_load_dwordx4 v17, s[24:27], s64 offen lds
    s_add_u32 s64, s64, s44
    s_add_u32 m0, s62, 15360
    s_nop 0
    buffer_load_dwordx4 v17, s[24:27], s64 offen lds
    s_add_u32 s64, s64, s44
    s_add_u32 m0, s62, 16384
    s_nop 0
    buffer_load_dwordx4 v17, s[24:27], s64 offen lds
    s_add_u32 s64, s64, s44
    s_add_u32 m0, s62, 17408
    s_nop 0
    buffer_load_dwordx4 v17, s[24:27], s64 offen lds
    s_add_u32 s64, s64, s44
    s_branch L_g_b2
L_g_b:
    s_add_u32 m0, s62, 0
    s_nop 0
    buffer_load_dwordx4 v17, s[24:27], s64 offen lds
    s_add_u32 s64, s64, s44
    s_add_u32 m0, s62, 1024
    s_nop 0
    buffer_load_dwordx4 v17, s[24:27], s64 offen lds
    s_add_u32 s64, s64, s44
    s_add_u32 m0, s62, 2048
    s_nop 0
    buffer_load_dwordx4 v17, s[24:27], s64 offen lds
    s_add_u32 s64, s64, s44
    s_add_u32 m0, s62, 3072
    s_nop 0
    buffer_load_dwordx4 v17, s[24:27], s64 offen lds
    s_add_u32 s64, s64, s44
    s_add_u32 m0, s62, 4096
    s_nop 0
    buffer_load_dwordx4 v17, s[24:27], s64 offen lds
    s_add_u32 s64, s64, s44
    s_add_u32 m0, s62, 5120
    s_nop 0
    buffer_load_dwordx4 v17, s[24:27], s64 offen lds
    s_add_u32 s64, s64, s44
    s_add_u32 m0, s62, 6144
    s_nop 0
    buffer_load_dwordx4 v17, s[24:27], s64 offen lds
    s_add_u32 s64, s64, s44
    s_add_u32 m0, s62, 7168
    s_nop 0
    buffer_load_dwordx4 v17, s[24:27], s64 offen lds
    s_add_u32 s64, s64, s44
    s_add_u32 m0, s62, 8192
    s_nop 0
    buffer_load_dwordx4 v17, s[24:27], s64 offen lds
    s_add_u32 s64, s64, s44
    s_add_u32 m0, s62, 9216
    s_nop 0
    buffer_load_dwordx4 v17, s[24:27], s64 offen lds
    s_add_u32 s64, s64, s44
    s_add_u32 m0, s62, 10240
    s_nop 0
    buffer_load_dwordx4 v17, s[24:27], s64 offen lds
    s_add_u32 s64, s64, s44
    s_add_u32 m0, s62, 11264
    s_nop 0
    buffer_load_dwordx4 v17, s[24:27], s64 offen lds
    s_add_u32 s64, s64, s44
    s_add_u32 m0, s62, 12288
    s_nop 0
    buffer_load_dwordx4 v17, s[24:27], s64 offen lds
    s_add_u32 s64, s64, s44
    s_add_u32 m0, s62, 13312
    s_nop 0
    buffer_load_dwordx4 v17, s[24:27], s64 offen lds
    s_add_u32 s64, s64, s44
    s_add_u32 m0, s62, 14336
    s_nop 0
    buffer_load_dwordx4 v17, s[24:27], s64 offen lds
    s_add_u32 s64, s64, s44
    s_add_u32 m0, s62, 15360
    s_nop 0
    buffer_load_dwordx4 v17, s[24:27], s64 offen lds
    s_add_u32 s64, s64, s44
    s_add_u32 m0, s62, 16384
    s_nop 0
    buffer_load_dwordx4 v17, s[24:27], s64 offen lds
    s_add_u32 s64, s64, s44
    s_add_u32 m0, s62, 17408
    s_nop 0
    buffer_load_dwordx4 v17, s[24:27], s64 offen lds
    s_add_u32 s64, s64, s44
    s_sleep 127
    s_sleep 127
L_g_b2:
L_g_b3:
    v_mov_b32 v168, v16
    v_mov_b32 v169, v17
    s_add_u32 s28, s16, 0x1800000
    s_addc_u32 s29, s17, 0
    s_and_b32 s29, s29, 0xffff
    s_mov_b32 s30, 0x400000
    s_mov_b32 s31, 0x00020000
    s_mov_b32 s36, s4
    s_and_b32 s37, s5, 0xffff
    s_mov_b32 s38, 0x200000
    s_mov_b32 s39, 0x00020000
    s_mov_b32 s40, s6
    s_and_b32 s41, s7, 0xffff
    s_mov_b32 s42, 0x200000
    s_mov_b32 s43, 0x00020000
    v_lshrrev_b32 v170, 3, v0
    v_and_b32 v4, 7, v0
    v_lshlrev_b32 v4, 4, v4
    v_lshrrev_b32 v5, 4, v170
    v_mul_u32_u24 v5, 18432, v5
    v_and_b32 v6, 15, v170
    v_mul_u32_u24 v6, 144, v6
    v_add3_u32 v171, v5, v6, v4
    v_lshl_add_u32 v174, v170, 11, v4
    s_lshl_b32 s48, s52, 7
    s_add_u32 s3, s48, 640
    s_lshr_b32 s3, s3, 10
    s_lshl_b32 s3, s3, 7
    s_add_u32 s48, s48, s3
    s_lshl_b32 s3, s51, 17
    s_add_u32 s48, s48, s3
    s_add_u32 s49, s48, 0x10000
    v_lshl_add_u32 v170, v170, 10, v4
    s_lshl_b32 s58, s51, 16
    s_lshl_b32 s3, s52, 7
    s_add_u32 s58, s58, s3
    s_add_u32 s59, s58, 0x8000
    v_and_b32 v172, 15, v1
    v_lshlrev_b32 v172, 2, v172
    s_mul_i32 s60, s51, 4352
    s_add_u32 s60, s60, 526336
    s_lshr_b32 s61, s51, 1
    s_mul_i32 s61, s61, 4352
    s_add_u32 s61, s61, 263168
    s_mov_b32 s67, 0
    s_cmp_lg_u32 s50, 0
    s_cbranch_scc1 L_g_goh
    s_movk_i32 s69, 0x7fff
L_g_pollh:
    buffer_load_dword v173, v172, s[32:35], s61 offen sc0 sc1
    s_add_u32 s67, s67, 1
    s_waitcnt vmcnt(0)
    v_cmp_ne_u32 vcc, 1, v173
    s_and_b32 s3, vcc_lo, s69
    s_nop 3
    s_cbranch_scc0 L_g_goh
    s_sleep 4
    s_cmp_lt_u32 s67, 0x40000
    s_cbranch_scc1 L_g_pollh
L_g_goh:
    s_waitcnt vmcnt(0)
    s_barrier
    s_add_u32 s3, s65, 0
    buffer_load_dwordx4 v[72:75], v2, s[76:79], s3 offen
    buffer_load_dwordx4 v[76:79], v2, s[76:79], s3 offen offset:2048
    s_add_u32 s3, s65, 131072
    buffer_load_dwordx4 v[80:83], v2, s[76:79], s3 offen
    buffer_load_dwordx4 v[84:87], v2, s[76:79], s3 offen offset:2048
    s_add_u32 s3, s65, 262144
    buffer_load_dwordx4 v[88:91], v2, s[76:79], s3 offen
    buffer_load_dwordx4 v[92:95], v2, s[76:79], s3 offen offset:2048
    s_add_u32 s3, s65, 393216
    buffer_load_dwordx4 v[96:99], v2, s[76:79], s3 offen
    buffer_load_dwordx4 v[100:103], v2, s[76:79], s3 offen offset:2048
    s_add_u32 s3, s65, 524288
    buffer_load_dwordx4 v[104:107], v2, s[76:79], s3 offen
    buffer_load_dwordx4 v[108:111], v2, s[76:79], s3 offen offset:2048
    s_add_u32 s3, s65, 655360
    buffer_load_dwordx4 v[112:115], v2, s[76:79], s3 offen
    buffer_load_dwordx4 v[116:119], v2, s[76:79], s3 offen offset:2048
    s_add_u32 s3, s65, 786432
    buffer_load_dwordx4 v[120:123], v2, s[76:79], s3 offen
    buffer_load_dwordx4 v[124:127], v2, s[76:79], s3 offen offset:2048
    s_add_u32 s3, s65, 917504
    buffer_load_dwordx4 v[128:131], v2, s[76:79], s3 offen
    buffer_load_dwordx4 v[132:135], v2, s[76:79], s3 offen offset:2048
    ds_read_b64_tr_b16 v[136:137], v168 offset:0
    ds_read_b64_tr_b16 v[138:139], v168 offset:1024
    ds_read_b64_tr_b16 v[140:141], v168 offset:256
    ds_read_b64_tr_b16 v[142:143], v168 offset:1280
    buffer_load_dwordx4 v[152:155], v170, s[36:39], s58 offen
    buffer_load_dwordx4 v[156:159], v170, s[36:39], s59 offen
    s_waitcnt vmcnt(17) lgkmcnt(0)
    ds_read_b64_tr_b16 v[144:145], v168 offset:2048
    ds_read_b64_tr_b16 v[146:147], v168 offset:3072
    ds_read_b64_tr_b16 v[148:149], v168 offset:2304
    ds_read_b64_tr_b16 v[150:151], v168 offset:3328
    v_mfma_f32_32x32x16_bf16 v[8:23], v[136:139], v[72:75], 0
    s_add_u32 m0, s62, 0
    s_nop 0
    buffer_load_dwordx4 v169, s[24:27], s64 offen lds
    s_add_u32 s64, s64, s44
    s_add_u32 m0, s62, 1024
    s_nop 0
    buffer_load_dwordx4 v169, s[24:27], s64 offen lds
    s_add_u32 s64, s64, s44
    v_mfma_f32_32x32x16_bf16 v[40:55], v[140:143], v[72:75], 0
    s_waitcnt vmcnt(18)
    v_mfma_f32_32x32x16_bf16 v[24:39], v[136:139], v[76:79], 0
    v_mfma_f32_32x32x16_bf16 v[56:71], v[140:143], v[76:79], 0
    s_add_u32 s3, s65, 1048576
    buffer_load_dwordx4 v[72:75], v2, s[76:79], s3 offen
    buffer_load_dwordx4 v[76:79], v2, s[76:79], s3 offen offset:2048
    s_waitcnt vmcnt(19) lgkmcnt(0)
    ds_read_b64_tr_b16 v[136:137], v168 offset:4096
    ds_read_b64_tr_b16 v[138:139], v168 offset:5120
    ds_read_b64_tr_b16 v[140:141], v168 offset:4352
    ds_read_b64_tr_b16 v[142:143], v168 offset:5376
    v_mfma_f32_32x32x16_bf16 v[8:23], v[144:147], v[80:83], v[8:23]
    s_add_u32 m0, s62, 2048
    s_nop 0
    buffer_load_dwordx4 v169, s[24:27], s64 offen lds
    s_add_u32 s64, s64, s44
    s_add_u32 m0, s62, 3072
    s_nop 0
    buffer_load_dwordx4 v169, s[24:27], s64 offen lds
    s_add_u32 s64, s64, s44
    v_mfma_f32_32x32x16_bf16 v[40:55], v[148:151], v[80:83], v[40:55]
    s_waitcnt vmcnt(20)
    v_mfma_f32_32x32x16_bf16 v[24:39], v[144:147], v[84:87], v[24:39]
    v_mfma_f32_32x32x16_bf16 v[56:71], v[148:151], v[84:87], v[56:71]
    s_add_u32 s3, s65, 1179648
    buffer_load_dwordx4 v[80:83], v2, s[76:79], s3 offen
    buffer_load_dwordx4 v[84:87], v2, s[76:79], s3 offen offset:2048
    s_waitcnt vmcnt(21) lgkmcnt(0)
    ds_read_b64_tr_b16 v[144:145], v168 offset:6144
    ds_read_b64_tr_b16 v[146:147], v168 offset:7168
    ds_read_b64_tr_b16 v[148:149], v168 offset:6400
    ds_read_b64_tr_b16 v[150:151], v168 offset:7424
    v_mfma_f32_32x32x16_bf16 v[8:23], v[136:139], v[88:91], v[8:23]
    s_add_u32 m0, s62, 4096
    s_nop 0
    buffer_load_dwordx4 v169, s[24:27], s64 offen lds
    s_add_u32 s64, s64, s44
    s_add_u32 m0, s62, 5120
    s_nop 0
    buffer_load_dwordx4 v169, s[24:27], s64 offen lds
    s_add_u32 s64, s64, s44
    v_mfma_f32_32x32x16_bf16 v[40:55], v[140:143], v[88:91], v[40:55]
    s_waitcnt vmcnt(22)
    v_mfma_f32_32x32x16_bf16 v[24:39], v[136:139], v[92:95], v[24:39]
    v_mfma_f32_32x32x16_bf16 v[56:71], v[140:143], v[92:95], v[56:71]
    s_add_u32 s3, s65, 1310720
    buffer_load_dwordx4 v[88:91], v2, s[76:79], s3 offen
    buffer_load_dwordx4 v[92:95], v2, s[76:79], s3 offen offset:2048
    s_waitcnt vmcnt(23) lgkmcnt(0)
    ds_read_b64_tr_b16 v[136:137], v168 offset:8192
    ds_read_b64_tr_b16 v[138:139], v168 offset:9216
    ds_read_b64_tr_b16 v[140:141], v168 offset:8448
    ds_read_b64_tr_b16 v[142:143], v168 offset:9472
    v_mfma_f32_32x32x16_bf16 v[8:23], v[144:147], v[96:99], v[8:23]
    s_add_u32 m0, s62, 6144
    s_nop 0
    buffer_load_dwordx4 v169, s[24:27], s64 offen lds
    s_add_u32 s64, s64, s44
    s_add_u32 m0, s62, 7168
    s_nop 0
    buffer_load_dwordx4 v169, s[24:27], s64 offen lds
    s_add_u32 s64, s64, s44
    v_mfma_f32_32x32x16_bf16 v[40:55], v[148:151], v[96:99], v[40:55]
    s_waitcnt vmcnt(24)
    v_mfma_f32_32x32x16_bf16 v[24:39], v[144:147], v[100:103], v[24:39]
    v_mfma_f32_32x32x16_bf16 v[56:71], v[148:151], v[100:103], v[56:71]
    s_add_u32 s3, s65, 1441792
    buffer_load_dwordx4 v[96:99], v2, s[76:79], s3 offen
    buffer_load_dwordx4 v[100:103], v2, s[76:79], s3 offen offset:2048
    s_waitcnt vmcnt(25) lgkmcnt(0)
    ds_read_b64_tr_b16 v[144:145], v168 offset:10240
    ds_read_b64_tr_b16 v[146:147], v168 offset:11264
    ds_read_b64_tr_b16 v[148:149], v168 offset:10496
    ds_read_b64_tr_b16 v[150:151], v168 offset:11520
    v_mfma_f32_32x32x16_bf16 v[8:23], v[136:139], v[104:107], v[8:23]
    s_add_u32 m0, s62, 8192
    s_nop 0
    buffer_load_dwordx4 v169, s[24:27], s64 offen lds
    s_add_u32 s64, s64, s44
    s_add_u32 m0, s62, 9216
    s_nop 0
    buffer_load_dwordx4 v169, s[24:27], s64 offen lds
    s_add_u32 s64, s64, s44
    v_mfma_f32_32x32x16_bf16 v[40:55], v[140:143], v[104:107], v[40:55]
    s_waitcnt vmcnt(26)
    v_mfma_f32_32x32x16_bf16 v[24:39], v[136:139], v[108:111], v[24:39]
    v_mfma_f32_32x32x16_bf16 v[56:71], v[140:143], v[108:111], v[56:71]
    s_add_u32 s3, s65, 1572864
    buffer_load_dwordx4 v[104:107], v2, s[76:79], s3 offen
    buffer_load_dwordx4 v[108:111], v2, s[76:79], s3 offen offset:2048
    s_waitcnt vmcnt(27) lgkmcnt(0)
    ds_read_b64_tr_b16 v[136:137], v168 offset:12288
    ds_read_b64_tr_b16 v[138:139], v168 offset:13312
    ds_read_b64_tr_b16 v[140:141], v168 offset:12544
    ds_read_b64_tr_b16 v[142:143], v168 offset:13568
    v_mfma_f32_32x32x16_bf16 v[8:23], v[144:147], v[112:115], v[8:23]
    s_add_u32 m0, s62, 10240
    s_nop 0
    buffer_load_dwordx4 v169, s[24:27], s64 offen lds
    s_add_u32 s64, s64, s44
    s_add_u32 m0, s62, 11264
    s_nop 0
    buffer_load_dwordx4 v169, s[24:27], s64 offen lds
    s_add_u32 s64, s64, s44
    v_mfma_f32_32x32x16_bf16 v[40:55], v[148:151], v[112:115], v[40:55]
    s_waitcnt vmcnt(28)
    v_mfma_f32_32x32x16_bf16 v[24:39], v[144:147], v[116:119], v[24:39]
    v_mfma_f32_32x32x16_bf16 v[56:71], v[148:151], v[116:119], v[56:71]
    s_add_u32 s3, s65, 1703936
    buffer_load_dwordx4 v[112:115], v2, s[76:79], s3 offen
    buffer_load_dwordx4 v[116:119], v2, s[76:79], s3 offen offset:2048
    s_waitcnt vmcnt(29) lgkmcnt(0)
    ds_read_b64_tr_b16 v[144:145], v168 offset:14336
    ds_read_b64_tr_b16 v[146:147], v168 offset:15360
    ds_read_b64_tr_b16 v[148:149], v168 offset:14592
    ds_read_b64_tr_b16 v[150:151], v168 offset:15616
    v_mfma_f32_32x32x16_bf16 v[8:23], v[136:139], v[120:123], v[8:23]
    s_add_u32 m0, s62, 12288
    s_nop 0
    buffer_load_dwordx4 v169, s[24:27], s64 offen lds
    s_add_u32 s64, s64, s44
    s_add_u32 m0, s62, 13312
    s_nop 0
    buffer_load_dwordx4 v169, s[24:27], s64 offen lds
    s_add_u32 s64, s64, s44
    v_mfma_f32_32x32x16_bf16 v[40:55], v[140:143], v[120:123], v[40:55]
    s_waitcnt vmcnt(30)
    v_mfma_f32_32x32x16_bf16 v[24:39], v[136:139], v[124:127], v[24:39]
    v_mfma_f32_32x32x16_bf16 v[56:71], v[140:143], v[124:127], v[56:71]
    s_add_u32 s3, s65, 1835008
    buffer_load_dwordx4 v[120:123], v2, s[76:79], s3 offen
    buffer_load_dwordx4 v[124:127], v2, s[76:79], s3 offen offset:2048
    s_waitcnt vmcnt(31) lgkmcnt(0)
    ds_read_b64_tr_b16 v[136:137], v168 offset:16384
    ds_read_b64_tr_b16 v[138:139], v168 offset:17408
    ds_read_b64_tr_b16 v[140:141], v168 offset:16640
    ds_read_b64_tr_b16 v[142:143], v168 offset:17664
    v_mfma_f32_32x32x16_bf16 v[8:23], v[144:147], v[128:131], v[8:23]
    s_add_u32 m0, s62, 14336
    s_nop 0
    buffer_load_dwordx4 v169, s[24:27], s64 offen lds
    s_add_u32 s64, s64, s44
    s_add_u32 m0, s62, 15360
    s_nop 0
    buffer_load_dwordx4 v169, s[24:27], s64 offen lds
    s_add_u32 s64, s64, s44
    v_mfma_f32_32x32x16_bf16 v[40:55], v[148:151], v[128:131], v[40:55]
    s_waitcnt vmcnt(32)
    v_mfma_f32_32x32x16_bf16 v[24:39], v[144:147], v[132:135], v[24:39]
    v_mfma_f32_32x32x16_bf16 v[56:71], v[148:151], v[132:135], v[56:71]
    s_add_u32 s3, s65, 1966080
    buffer_load_dwordx4 v[128:131], v2, s[76:79], s3 offen
    buffer_load_dwordx4 v[132:135], v2, s[76:79], s3 offen offset:2048
    s_waitcnt vmcnt(29) lgkmcnt(0)
    ds_read_b64_tr_b16 v[144:145], v168 offset:0
    ds_read_b64_tr_b16 v[146:147], v168 offset:1024
    ds_read_b64_tr_b16 v[148:149], v168 offset:256
    ds_read_b64_tr_b16 v[150:151], v168 offset:1280
    v_mfma_f32_32x32x16_bf16 v[8:23], v[136:139], v[72:75], v[8:23]
    s_add_u32 m0, s62, 16384
    s_nop 0
    buffer_load_dwordx4 v169, s[24:27], s64 offen lds
    s_add_u32 s64, s64, s44
    s_add_u32 m0, s62, 17408
    s_nop 0
    buffer_load_dwordx4 v169, s[24:27], s64 offen lds
    s_add_u32 s64, s64, s44
    v_mfma_f32_32x32x16_bf16 v[40:55], v[140:143], v[72:75], v[40:55]
    s_waitcnt vmcnt(30)
    v_mfma_f32_32x32x16_bf16 v[24:39], v[136:139], v[76:79], v[24:39]
    v_mfma_f32_32x32x16_bf16 v[56:71], v[140:143], v[76:79], v[56:71]
    s_add_u32 s3, s65, 2097152
    buffer_load_dwordx4 v[72:75], v2, s[76:79], s3 offen
    buffer_load_dwordx4 v[76:79], v2, s[76:79], s3 offen offset:2048
    s_waitcnt vmcnt(29) lgkmcnt(0)
    ds_read_b64_tr_b16 v[136:137], v168 offset:2048
    ds_read_b64_tr_b16 v[138:139], v168 offset:3072
    ds_read_b64_tr_b16 v[140:141], v168 offset:2304
    ds_read_b64_tr_b16 v[142:143], v168 offset:3328
    v_mfma_f32_32x32x16_bf16 v[8:23], v[144:147], v[80:83], v[8:23]
    s_add_u32 m0, s62, 0
    s_nop 0
    buffer_load_dwordx4 v169, s[24:27], s64 offen lds
    s_add_u32 s64, s64, s44
    s_add_u32 m0, s62, 1024
    s_nop 0
    buffer_load_dwordx4 v169, s[24:27], s64 offen lds
    s_add_u32 s64, s64, s44
    v_mfma_f32_32x32x16_bf16 v[40:55], v[148:151], v[80:83], v[40:55]
    s_waitcnt vmcnt(30)
    v_mfma_f32_32x32x16_bf16 v[24:39], v[144:147], v[84:87], v[24:39]
    v_mfma_f32_32x32x16_bf16 v[56:71], v[148:151], v[84:87], v[56:71]
    s_add_u32 s3, s65, 2228224
    buffer_load_dwordx4 v[80:83], v2, s[76:79], s3 offen
    buffer_load_dwordx4 v[84:87], v2, s[76:79], s3 offen offset:2048
    s_waitcnt vmcnt(29) lgkmcnt(0)
    ds_read_b64_tr_b16 v[144:145], v168 offset:4096
    ds_read_b64_tr_b16 v[146:147], v168 offset:5120
    ds_read_b64_tr_b16 v[148:149], v168 offset:4352
    ds_read_b64_tr_b16 v[150:151], v168 offset:5376
    v_mfma_f32_32x32x16_bf16 v[8:23], v[136:139], v[88:91], v[8:23]
    s_add_u32 m0, s62, 2048
    s_nop 0
    buffer_load_dwordx4 v169, s[24:27], s64 offen lds
    s_add_u32 s64, s64, s44
    s_add_u32 m0, s62, 3072
    s_nop 0
    buffer_load_dwordx4 v169, s[24:27], s64 offen lds
    s_add_u32 s64, s64, s44
    v_mfma_f32_32x32x16_bf16 v[40:55], v[140:143], v[88:91], v[40:55]
    s_waitcnt vmcnt(30)
    v_mfma_f32_32x32x16_bf16 v[24:39], v[136:139], v[92:95], v[24:39]
    v_mfma_f32_32x32x16_bf16 v[56:71], v[140:143], v[92:95], v[56:71]
    s_add_u32 s3, s65, 2359296
    buffer_load_dwordx4 v[88:91], v2, s[76:79], s3 offen
    buffer_load_dwordx4 v[92:95], v2, s[76:79], s3 offen offset:2048
    s_waitcnt vmcnt(29) lgkmcnt(0)
    ds_read_b64_tr_b16 v[136:137], v168 offset:6144
    ds_read_b64_tr_b16 v[138:139], v168 offset:7168
    ds_read_b64_tr_b16 v[140:141], v168 offset:6400
    ds_read_b64_tr_b16 v[142:143], v168 offset:7424
    v_mfma_f32_32x32x16_bf16 v[8:23], v[144:147], v[96:99], v[8:23]
    s_add_u32 m0, s62, 4096
    s_min_u32 s64, s64, s45
    buffer_load_dwordx4 v169, s[24:27], s64 offen lds
    s_add_u32 s64, s64, s44
    s_add_u32 m0, s62, 5120
    s_min_u32 s64, s64, s45
    buffer_load_dwordx4 v169, s[24:27], s64 offen lds
    s_add_u32 s64, s64, s44
    v_mfma_f32_32x32x16_bf16 v[40:55], v[148:151], v[96:99], v[40:55]
    s_waitcnt vmcnt(30)
    v_mfma_f32_32x32x16_bf16 v[24:39], v[144:147], v[100:103], v[24:39]
    v_mfma_f32_32x32x16_bf16 v[56:71], v[148:151], v[100:103], v[56:71]
    s_add_u32 s3, s65, 2490368
    buffer_load_dwordx4 v[96:99], v2, s[76:79], s3 offen
    buffer_load_dwordx4 v[100:103], v2, s[76:79], s3 offen offset:2048
    buffer_load_dword v173, v172, s[32:35], s60 offen sc0 sc1
    s_waitcnt vmcnt(30) lgkmcnt(0)
    ds_read_b64_tr_b16 v[144:145], v168 offset:8192
    ds_read_b64_tr_b16 v[146:147], v168 offset:9216
    ds_read_b64_tr_b16 v[148:149], v168 offset:8448
    ds_read_b64_tr_b16 v[150:151], v168 offset:9472
    v_mfma_f32_32x32x16_bf16 v[8:23], v[136:139], v[104:107], v[8:23]
    s_add_u32 m0, s62, 6144
    s_min_u32 s64, s64, s45
    buffer_load_dwordx4 v169, s[24:27], s64 offen lds
    s_add_u32 s64, s64, s44
    s_add_u32 m0, s62, 7168
    s_min_u32 s64, s64, s45
    buffer_load_dwordx4 v169, s[24:27], s64 offen lds
    s_add_u32 s64, s64, s44
    v_mfma_f32_32x32x16_bf16 v[40:55], v[140:143], v[104:107], v[40:55]
    s_waitcnt vmcnt(31)
    v_mfma_f32_32x32x16_bf16 v[24:39], v[136:139], v[108:111], v[24:39]
    v_mfma_f32_32x32x16_bf16 v[56:71], v[140:143], v[108:111], v[56:71]
    s_add_u32 s3, s65, 2621440
    buffer_load_dwordx4 v[104:107], v2, s[76:79], s3 offen
    buffer_load_dwordx4 v[108:111], v2, s[76:79], s3 offen offset:2048
    s_waitcnt vmcnt(30) lgkmcnt(0)
    ds_read_b64_tr_b16 v[136:137], v168 offset:10240
    ds_read_b64_tr_b16 v[138:139], v168 offset:11264
    ds_read_b64_tr_b16 v[140:141], v168 offset:10496
    ds_read_b64_tr_b16 v[142:143], v168 offset:11520
    v_mfma_f32_32x32x16_bf16 v[8:23], v[144:147], v[112:115], v[8:23]
    v_mfma_f32_32x32x16_bf16 v[40:55], v[148:151], v[112:115], v[40:55]
    s_waitcnt vmcnt(29)
    v_mfma_f32_32x32x16_bf16 v[24:39], v[144:147], v[116:119], v[24:39]
    v_mfma_f32_32x32x16_bf16 v[56:71], v[148:151], v[116:119], v[56:71]
    s_add_u32 s3, s65, 2752512
    buffer_load_dwordx4 v[112:115], v2, s[76:79], s3 offen
    buffer_load_dwordx4 v[116:119], v2, s[76:79], s3 offen offset:2048
    s_waitcnt vmcnt(28) lgkmcnt(0)
    ds_read_b64_tr_b16 v[144:145], v168 offset:12288
    ds_read_b64_tr_b16 v[146:147], v168 offset:13312
    ds_read_b64_tr_b16 v[148:149], v168 offset:12544
    ds_read_b64_tr_b16 v[150:151], v168 offset:13568
    v_mfma_f32_32x32x16_bf16 v[8:23], v[136:139], v[120:123], v[8:23]
    v_mfma_f32_32x32x16_bf16 v[40:55], v[140:143], v[120:123], v[40:55]
    s_waitcnt vmcnt(27)
    v_mfma_f32_32x32x16_bf16 v[24:39], v[136:139], v[124:127], v[24:39]
    v_mfma_f32_32x32x16_bf16 v[56:71], v[140:143], v[124:127], v[56:71]
    s_waitcnt vmcnt(24) lgkmcnt(0)
    ds_read_b64_tr_b16 v[136:137], v168 offset:14336
    ds_read_b64_tr_b16 v[138:139], v168 offset:15360
    ds_read_b64_tr_b16 v[140:141], v168 offset:14592
    ds_read_b64_tr_b16 v[142:143], v168 offset:15616
    v_mfma_f32_32x32x16_bf16 v[8:23], v[144:147], v[128:131], v[8:23]
    v_mfma_f32_32x32x16_bf16 v[40:55], v[148:151], v[128:131], v[40:55]
    s_waitcnt vmcnt(23)
    v_mfma_f32_32x32x16_bf16 v[24:39], v[144:147], v[132:135], v[24:39]
    v_mfma_f32_32x32x16_bf16 v[56:71], v[148:151], v[132:135], v[56:71]
    s_waitcnt vmcnt(20) lgkmcnt(0)
    ds_read_b64_tr_b16 v[144:145], v168 offset:16384
    ds_read_b64_tr_b16 v[146:147], v168 offset:17408
    ds_read_b64_tr_b16 v[148:149], v168 offset:16640
    ds_read_b64_tr_b16 v[150:151], v168 offset:17664
    v_mfma_f32_32x32x16_bf16 v[8:23], v[136:139], v[72:75], v[8:23]
    v_mfma_f32_32x32x16_bf16 v[40:55], v[140:143], v[72:75], v[40:55]
    s_waitcnt vmcnt(19)
    v_mfma_f32_32x32x16_bf16 v[24:39], v[136:139], v[76:79], v[24:39]
    v_mfma_f32_32x32x16_bf16 v[56:71], v[140:143], v[76:79], v[56:71]
    s_waitcnt vmcnt(16) lgkmcnt(0)
    ds_read_b64_tr_b16 v[136:137], v168 offset:0
    ds_read_b64_tr_b16 v[138:139], v168 offset:1024
    ds_read_b64_tr_b16 v[140:141], v168 offset:256
    ds_read_b64_tr_b16 v[142:143], v168 offset:1280
    v_mfma_f32_32x32x16_bf16 v[8:23], v[144:147], v[80:83], v[8:23]
    v_mfma_f32_32x32x16_bf16 v[40:55], v[148:151], v[80:83], v[40:55]
    s_waitcnt vmcnt(15)
    v_mfma_f32_32x32x16_bf16 v[24:39], v[144:147], v[84:87], v[24:39]
    v_mfma_f32_32x32x16_bf16 v[56:71], v[148:151], v[84:87], v[56:71]
    s_waitcnt vmcnt(12) lgkmcnt(0)
    ds_read_b64_tr_b16 v[144:145], v168 offset:2048
    ds_read_b64_tr_b16 v[146:147], v168 offset:3072
    ds_read_b64_tr_b16 v[148:149], v168 offset:2304
    ds_read_b64_tr_b16 v[150:151], v168 offset:3328
    v_mfma_f32_32x32x16_bf16 v[8:23], v[136:139], v[88:91], v[8:23]
    v_mfma_f32_32x32x16_bf16 v[40:55], v[140:143], v[88:91], v[40:55]
    s_waitcnt vmcnt(11)
    v_mfma_f32_32x32x16_bf16 v[24:39], v[136:139], v[92:95], v[24:39]
    v_mfma_f32_32x32x16_bf16 v[56:71], v[140:143], v[92:95], v[56:71]
    s_waitcnt vmcnt(8) lgkmcnt(0)
    ds_read_b64_tr_b16 v[136:137], v168 offset:4096
    ds_read_b64_tr_b16 v[138:139], v168 offset:5120
    ds_read_b64_tr_b16 v[140:141], v168 offset:4352
    ds_read_b64_tr_b16 v[142:143], v168 offset:5376
    v_mfma_f32_32x32x16_bf16 v[8:23], v[144:147], v[96:99], v[8:23]
    v_mfma_f32_32x32x16_bf16 v[40:55], v[148:151], v[96:99], v[40:55]
    s_waitcnt vmcnt(7)
    v_mfma_f32_32x32x16_bf16 v[24:39], v[144:147], v[100:103], v[24:39]
    v_mfma_f32_32x32x16_bf16 v[56:71], v[148:151], v[100:103], v[56:71]
    s_waitcnt vmcnt(3) lgkmcnt(0)
    ds_read_b64_tr_b16 v[144:145], v168 offset:6144
    ds_read_b64_tr_b16 v[146:147], v168 offset:7168
    ds_read_b64_tr_b16 v[148:149], v168 offset:6400
    ds_read_b64_tr_b16 v[150:151], v168 offset:7424
    v_cmp_ne_u32 vcc, 1, v173
    s_and_b32 s66, vcc_lo, 0xff
    buffer_load_dwordx4 v[160:163], v174, s[28:31], s48 offen sc0 sc1
    buffer_load_dwordx4 v[164:167], v174, s[28:31], s49 offen sc0 sc1
    v_mfma_f32_32x32x16_bf16 v[8:23], v[136:139], v[104:107], v[8:23]
    v_mfma_f32_32x32x16_bf16 v[40:55], v[140:143], v[104:107], v[40:55]
    s_waitcnt vmcnt(4)
    v_mfma_f32_32x32x16_bf16 v[24:39], v[136:139], v[108:111], v[24:39]
    v_mfma_f32_32x32x16_bf16 v[56:71], v[140:143], v[108:111], v[56:71]
    s_waitcnt vmcnt(3) lgkmcnt(0)
    v_mfma_f32_32x32x16_bf16 v[8:23], v[144:147], v[112:115], v[8:23]
    v_mfma_f32_32x32x16_bf16 v[40:55], v[148:151], v[112:115], v[40:55]
    s_waitcnt vmcnt(2)
    v_mfma_f32_32x32x16_bf16 v[24:39], v[144:147], v[116:119], v[24:39]
    v_mfma_f32_32x32x16_bf16 v[56:71], v[148:151], v[116:119], v[56:71]
    s_mov_b32 s61, 0
    s_cmp_eq_u32 s66, 0
    s_nop 9
    s_cbranch_scc1 L_k2g_go2
L_k2g_poll:
    buffer_load_dword v173, v172, s[32:35], s60 offen sc0 sc1
    s_add_u32 s61, s61, 1
    s_waitcnt vmcnt(0)
    v_cmp_ne_u32 vcc, 1, v173
    s_and_b32 s3, vcc_lo, 0xff
    s_nop 3
    s_cbranch_scc0 L_k2g_go
    s_sleep 4
    s_cmp_lt_u32 s61, 0x40000
    s_cbranch_scc1 L_k2g_poll
L_k2g_go:
    buffer_load_dwordx4 v[160:163], v174, s[28:31], s48 offen sc0 sc1
    buffer_load_dwordx4 v[164:167], v174, s[28:31], s49 offen sc0 sc1
L_k2g_go2:
    v_add_u32 v4, s62, v3
    s_sub_u32 s56, 3, s50
    s_and_b32 s56, s56, 3
    s_lshl_b32 s56, s56, 12
    v_add_u32 v5, s56, v4
    s_cmp_eq_u32 s50, 0
    s_nop 1
    s_cbranch_scc1 L_k2g_own0
    ds_write_b128 v5, v[8:11] offset:0
    ds_write_b128 v5, v[12:15] offset:1024
    ds_write_b128 v5, v[16:19] offset:2048
    ds_write_b128 v5, v[20:23] offset:3072
    s_branch L_k2g_nx0
L_k2g_own0:
    v_mov_b32 v72, v8
    v_mov_b32 v73, v9
    v_mov_b32 v74, v10
    v_mov_b32 v75, v11
    v_mov_b32 v76, v12
    v_mov_b32 v77, v13
    v_mov_b32 v78, v14
    v_mov_b32 v79, v15
    v_mov_b32 v80, v16
    v_mov_b32 v81, v17
    v_mov_b32 v82, v18
    v_mov_b32 v83, v19
    v_mov_b32 v84, v20
    v_mov_b32 v85, v21
    v_mov_b32 v86, v22
    v_mov_b32 v87, v23
    s_nop 2
L_k2g_nx0:
    s_sub_u32 s56, 4, s50
    s_and_b32 s56, s56, 3
    s_lshl_b32 s56, s56, 12
    v_add_u32 v5, s56, v4
    s_cmp_eq_u32 s50, 1
    s_nop 1
    s_cbranch_scc1 L_k2g_own1
    ds_write_b128 v5, v[24:27] offset:0
    ds_write_b128 v5, v[28:31] offset:1024
    ds_write_b128 v5, v[32:35] offset:2048
    ds_write_b128 v5, v[36:39] offset:3072
    s_branch L_k2g_nx1
L_k2g_own1:
    v_mov_b32 v72, v24
    v_mov_b32 v73, v25
    v_mov_b32 v74, v26
    v_mov_b32 v75, v27
    v_mov_b32 v76, v28
    v_mov_b32 v77, v29
    v_mov_b32 v78, v30
    v_mov_b32 v79, v31
    v_mov_b32 v80, v32
    v_mov_b32 v81, v33
    v_mov_b32 v82, v34
    v_mov_b32 v83, v35
    v_mov_b32 v84, v36
    v_mov_b32 v85, v37
    v_mov_b32 v86, v38
    v_mov_b32 v87, v39
    s_nop 2
L_k2g_nx1:
    s_sub_u32 s56, 5, s50
    s_and_b32 s56, s56, 3
    s_lshl_b32 s56, s56, 12
    v_add_u32 v5, s56, v4
    s_cmp_eq_u32 s50, 2
    s_nop 1
    s_cbranch_scc1 L_k2g_own2
    ds_write_b128 v5, v[40:43] offset:0
    ds_write_b128 v5, v[44:47] offset:1024
    ds_write_b128 v5, v[48:51] offset:2048
    ds_write_b128 v5, v[52:55] offset:3072
    s_branch L_k2g_nx2
L_k2g_own2:
    v_mov_b32 v72, v40
    v_mov_b32 v73, v41
    v_mov_b32 v74, v42
    v_mov_b32 v75, v43
    v_mov_b32 v76, v44
    v_mov_b32 v77, v45
    v_mov_b32 v78, v46
    v_mov_b32 v79, v47
    v_mov_b32 v80, v48
    v_mov_b32 v81, v49
    v_mov_b32 v82, v50
    v_mov_b32 v83, v51
    v_mov_b32 v84, v52
    v_mov_b32 v85, v53
    v_mov_b32 v86, v54
    v_mov_b32 v87, v55
    s_nop 2
L_k2g_nx2:
    s_sub_u32 s56, 6, s50
    s_and_b32 s56, s56, 3
    s_lshl_b32 s56, s56, 12
    v_add_u32 v5, s56, v4
    s_cmp_eq_u32 s50, 3
    s_nop 1
    s_cbranch_scc1 L_k2g_own3
    ds_write_b128 v5, v[56:59] offset:0
    ds_write_b128 v5, v[60:63] offset:1024
    ds_write_b128 v5, v[64:67] offset:2048
    ds_write_b128 v5, v[68:71] offset:3072
    s_branch L_k2g_nx3
L_k2g_own3:
    v_mov_b32 v72, v56
    v_mov_b32 v73, v57
    v_mov_b32 v74, v58
    v_mov_b32 v75, v59
    v_mov_b32 v76, v60
    v_mov_b32 v77, v61
    v_mov_b32 v78, v62
    v_mov_b32 v79, v63
    v_mov_b32 v80, v64
    v_mov_b32 v81, v65
    v_mov_b32 v82, v66
    v_mov_b32 v83, v67
    v_mov_b32 v84, v68
    v_mov_b32 v85, v69
    v_mov_b32 v86, v70
    v_mov_b32 v87, v71
    s_nop 2
L_k2g_nx3:
    s_waitcnt lgkmcnt(0)
    s_barrier
    s_sub_u32 s56, s50, 1
    s_and_b32 s56, s56, 3
    s_mul_i32 s56, s56, 18432
    s_add_u32 s56, s56, 0
    v_add_u32 v4, s56, v3
    ds_read_b128 v[8:11], v4 offset:0
    ds_read_b128 v[12:15], v4 offset:1024
    ds_read_b128 v[16:19], v4 offset:2048
    ds_read_b128 v[20:23], v4 offset:3072
    s_sub_u32 s56, s50, 2
    s_and_b32 s56, s56, 3
    s_mul_i32 s56, s56, 18432
    s_add_u32 s56, s56, 4096
    v_add_u32 v4, s56, v3
    ds_read_b128 v[24:27], v4 offset:0
    ds_read_b128 v[28:31], v4 offset:1024
    ds_read_b128 v[32:35], v4 offset:2048
    ds_read_b128 v[36:39], v4 offset:3072
    s_sub_u32 s56, s50, 3
    s_and_b32 s56, s56, 3
    s_mul_i32 s56, s56, 18432
    s_add_u32 s56, s56, 8192
    v_add_u32 v4, s56, v3
    ds_read_b128 v[40:43], v4 offset:0
    ds_read_b128 v[44:47], v4 offset:1024
    ds_read_b128 v[48:51], v4 offset:2048
    ds_read_b128 v[52:55], v4 offset:3072
    v_and_b32 v5, 15, v1
    v_mul_u32_u24 v5, 144, v5
    v_bfe_u32 v6, v1, 4, 1
    v_mul_u32_u24 v6, 18432, v6
    v_add_u32 v5, v5, v6
    v_lshrrev_b32 v6, 5, v1
    s_and_b32 s56, s50, 1
    s_mul_i32 s56, s56, 36864
    s_lshr_b32 s57, s50, 1
    s_lshl_b32 s57, s57, 6
    s_add_u32 s56, s56, s57
    s_add_u32 s56, s56, 12288
    v_lshl_add_u32 v5, v6, 3, v5
    v_add_u32 v5, s56, v5
    s_mov_b32 s66, 0xbfb8aa3b
    s_mov_b32 s67, 0xbfb8aa3b
    s_waitcnt lgkmcnt(8)
    v_pk_add_f32 v[72:73], v[72:73], v[8:9]
    v_pk_add_f32 v[74:75], v[74:75], v[10:11]
    v_pk_add_f32 v[76:77], v[76:77], v[12:13]
    v_pk_add_f32 v[78:79], v[78:79], v[14:15]
    v_pk_add_f32 v[80:81], v[80:81], v[16:17]
    v_pk_add_f32 v[82:83], v[82:83], v[18:19]
    v_pk_add_f32 v[84:85], v[84:85], v[20:21]
    v_pk_add_f32 v[86:87], v[86:87], v[22:23]
    s_waitcnt lgkmcnt(4)
    v_pk_add_f32 v[72:73], v[72:73], v[24:25]
    v_pk_add_f32 v[74:75], v[74:75], v[26:27]
    v_pk_add_f32 v[76:77], v[76:77], v[28:29]
    v_pk_add_f32 v[78:79], v[78:79], v[30:31]
    v_pk_add_f32 v[80:81], v[80:81], v[32:33]
    v_pk_add_f32 v[82:83], v[82:83], v[34:35]
    v_pk_add_f32 v[84:85], v[84:85], v[36:37]
    v_pk_add_f32 v[86:87], v[86:87], v[38:39]
    s_waitcnt lgkmcnt(0)
    v_pk_add_f32 v[72:73], v[72:73], v[40:41]
    v_pk_add_f32 v[74:75], v[74:75], v[42:43]
    v_pk_add_f32 v[76:77], v[76:77], v[44:45]
    v_pk_add_f32 v[78:79], v[78:79], v[46:47]
    v_pk_add_f32 v[80:81], v[80:81], v[48:49]
    v_pk_add_f32 v[82:83], v[82:83], v[50:51]
    v_pk_add_f32 v[84:85], v[84:85], v[52:53]
    v_pk_add_f32 v[86:87], v[86:87], v[54:55]
    v_cvt_pk_bf16_f32 v8, v72, v73
    v_cvt_pk_bf16_f32 v10, v74, v75
    v_cvt_pk_bf16_f32 v12, v76, v77
    v_cvt_pk_bf16_f32 v14, v78, v79
    v_cvt_pk_bf16_f32 v16, v80, v81
    v_cvt_pk_bf16_f32 v18, v82, v83
    v_cvt_pk_bf16_f32 v20, v84, v85
    v_cvt_pk_bf16_f32 v22, v86, v87
    v_lshlrev_b32 v72, 16, v8
    v_and_b32 v73, 0xffff0000, v8
    v_lshlrev_b32 v74, 16, v10
    v_and_b32 v75, 0xffff0000, v10
    v_lshlrev_b32 v76, 16, v12
    v_and_b32 v77, 0xffff0000, v12
    v_lshlrev_b32 v78, 16, v14
    v_and_b32 v79, 0xffff0000, v14
    v_lshlrev_b32 v80, 16, v16
    v_and_b32 v81, 0xffff0000, v16
    v_lshlrev_b32 v82, 16, v18
    v_and_b32 v83, 0xffff0000, v18
    v_lshlrev_b32 v84, 16, v20
    v_and_b32 v85, 0xffff0000, v20
    v_lshlrev_b32 v86, 16, v22
    v_and_b32 v87, 0xffff0000, v22
    v_pk_mul_f32 v[8:9], v[72:73], s[66:67]
    v_pk_mul_f32 v[10:11], v[74:75], s[66:67]
    v_pk_mul_f32 v[12:13], v[76:77], s[66:67]
    v_pk_mul_f32 v[14:15], v[78:79], s[66:67]
    v_pk_mul_f32 v[16:17], v[80:81], s[66:67]
    v_pk_mul_f32 v[18:19], v[82:83], s[66:67]
    v_pk_mul_f32 v[20:21], v[84:85], s[66:67]
    v_pk_mul_f32 v[22:23], v[86:87], s[66:67]
    v_exp_f32 v8, v8
    v_exp_f32 v9, v9
    v_exp_f32 v10, v10
    v_exp_f32 v11, v11
    v_exp_f32 v12, v12
    v_exp_f32 v13, v13
    v_exp_f32 v14, v14
    v_exp_f32 v15, v15
    v_exp_f32 v16, v16
    v_exp_f32 v17, v17
    v_exp_f32 v18, v18
    v_exp_f32 v19, v19
    v_exp_f32 v20, v20
    v_exp_f32 v21, v21
    v_exp_f32 v22, v22
    v_exp_f32 v23, v23
    v_pk_add_f32 v[8:9], v[8:9], 1.0 op_sel_hi:[1,0]
    v_pk_add_f32 v[10:11], v[10:11], 1.0 op_sel_hi:[1,0]
    v_pk_add_f32 v[12:13], v[12:13], 1.0 op_sel_hi:[1,0]
    v_pk_add_f32 v[14:15], v[14:15], 1.0 op_sel_hi:[1,0]
    v_pk_add_f32 v[16:17], v[16:17], 1.0 op_sel_hi:[1,0]
    v_pk_add_f32 v[18:19], v[18:19], 1.0 op_sel_hi:[1,0]
    v_pk_add_f32 v[20:21], v[20:21], 1.0 op_sel_hi:[1,0]
    v_pk_add_f32 v[22:23], v[22:23], 1.0 op_sel_hi:[1,0]
    v_rcp_f32 v8, v8
    v_rcp_f32 v9, v9
    v_rcp_f32 v10, v10
    v_rcp_f32 v11, v11
    v_rcp_f32 v12, v12
    v_rcp_f32 v13, v13
    v_rcp_f32 v14, v14
    v_rcp_f32 v15, v15
    v_rcp_f32 v16, v16
    v_rcp_f32 v17, v17
    v_rcp_f32 v18, v18
    v_rcp_f32 v19, v19
    v_rcp_f32 v20, v20
    v_rcp_f32 v21, v21
    v_rcp_f32 v22, v22
    v_rcp_f32 v23, v23
    v_pk_mul_f32 v[72:73], v[72:73], v[8:9]
    v_pk_mul_f32 v[74:75], v[74:75], v[10:11]
    v_pk_mul_f32 v[76:77], v[76:77], v[12:13]
    v_pk_mul_f32 v[78:79], v[78:79], v[14:15]
    v_pk_mul_f32 v[80:81], v[80:81], v[16:17]
    v_pk_mul_f32 v[82:83], v[82:83], v[18:19]
    v_pk_mul_f32 v[84:85], v[84:85], v[20:21]
    v_pk_mul_f32 v[86:87], v[86:87], v[22:23]
    v_cvt_pk_bf16_f32 v88, v72, v73
    v_cvt_pk_bf16_f32 v89, v74, v75
    v_cvt_pk_bf16_f32 v90, v76, v77
    v_cvt_pk_bf16_f32 v91, v78, v79
    v_cvt_pk_bf16_f32 v92, v80, v81
    v_cvt_pk_bf16_f32 v93, v82, v83
    v_cvt_pk_bf16_f32 v94, v84, v85
    v_cvt_pk_bf16_f32 v95, v86, v87
    ds_write_b64 v5, v[88:89] offset:0
    ds_write_b64 v5, v[90:91] offset:16
    ds_write_b64 v5, v[92:93] offset:32
    ds_write_b64 v5, v[94:95] offset:48
    s_waitcnt vmcnt(0)
    v_lshlrev_b32 v24, 16, v160
    v_and_b32 v25, 0xffff0000, v160
    v_lshlrev_b32 v26, 16, v161
    v_and_b32 v27, 0xffff0000, v161
    v_lshlrev_b32 v28, 16, v162
    v_and_b32 v29, 0xffff0000, v162
    v_lshlrev_b32 v30, 16, v163
    v_and_b32 v31, 0xffff0000, v163
    v_lshlrev_b32 v32, 16, v164
    v_and_b32 v33, 0xffff0000, v164
    v_lshlrev_b32 v34, 16, v165
    v_and_b32 v35, 0xffff0000, v165
    v_lshlrev_b32 v36, 16, v166
    v_and_b32 v37, 0xffff0000, v166
    v_lshlrev_b32 v38, 16, v167
    v_and_b32 v39, 0xffff0000, v167
    s_waitcnt lgkmcnt(0)
    s_barrier
    ds_read_b128 v[8:11], v171 offset:12288
    ds_read_b128 v[12:15], v171 offset:49152
    v_lshlrev_b32 v40, 16, v152
    v_and_b32 v41, 0xffff0000, v152
    v_lshlrev_b32 v42, 16, v153
    v_and_b32 v43, 0xffff0000, v153
    v_lshlrev_b32 v44, 16, v154
    v_and_b32 v45, 0xffff0000, v154
    v_lshlrev_b32 v46, 16, v155
    v_and_b32 v47, 0xffff0000, v155
    v_lshlrev_b32 v48, 16, v156
    v_and_b32 v49, 0xffff0000, v156
    v_lshlrev_b32 v50, 16, v157
    v_and_b32 v51, 0xffff0000, v157
    v_lshlrev_b32 v52, 16, v158
    v_and_b32 v53, 0xffff0000, v158
    v_lshlrev_b32 v54, 16, v159
    v_and_b32 v55, 0xffff0000, v159
    s_waitcnt lgkmcnt(0)
    v_lshlrev_b32 v56, 16, v8
    v_and_b32 v57, 0xffff0000, v8
    v_lshlrev_b32 v58, 16, v9
    v_and_b32 v59, 0xffff0000, v9
    v_lshlrev_b32 v60, 16, v10
    v_and_b32 v61, 0xffff0000, v10
    v_lshlrev_b32 v62, 16, v11
    v_and_b32 v63, 0xffff0000, v11
    v_lshlrev_b32 v64, 16, v12
    v_and_b32 v65, 0xffff0000, v12
    v_lshlrev_b32 v66, 16, v13
    v_and_b32 v67, 0xffff0000, v13
    v_lshlrev_b32 v68, 16, v14
    v_and_b32 v69, 0xffff0000, v14
    v_lshlrev_b32 v70, 16, v15
    v_and_b32 v71, 0xffff0000, v15
    v_pk_mul_f32 v[24:25], v[24:25], v[56:57]
    v_pk_mul_f32 v[26:27], v[26:27], v[58:59]
    v_pk_mul_f32 v[28:29], v[28:29], v[60:61]
    v_pk_mul_f32 v[30:31], v[30:31], v[62:63]
    v_pk_mul_f32 v[32:33], v[32:33], v[64:65]
    v_pk_mul_f32 v[34:35], v[34:35], v[66:67]
    v_pk_mul_f32 v[36:37], v[36:37], v[68:69]
    v_pk_mul_f32 v[38:39], v[38:39], v[70:71]
    v_cvt_pk_bf16_f32 v8, v24, v25
    v_cvt_pk_bf16_f32 v9, v26, v27
    v_cvt_pk_bf16_f32 v10, v28, v29
    v_cvt_pk_bf16_f32 v11, v30, v31
    v_cvt_pk_bf16_f32 v12, v32, v33
    v_cvt_pk_bf16_f32 v13, v34, v35
    v_cvt_pk_bf16_f32 v14, v36, v37
    v_cvt_pk_bf16_f32 v15, v38, v39
    v_lshlrev_b32 v24, 16, v8
    v_and_b32 v25, 0xffff0000, v8
    v_lshlrev_b32 v26, 16, v9
    v_and_b32 v27, 0xffff0000, v9
    v_lshlrev_b32 v28, 16, v10
    v_and_b32 v29, 0xffff0000, v10
    v_lshlrev_b32 v30, 16, v11
    v_and_b32 v31, 0xffff0000, v11
    v_lshlrev_b32 v32, 16, v12
    v_and_b32 v33, 0xffff0000, v12
    v_lshlrev_b32 v34, 16, v13
    v_and_b32 v35, 0xffff0000, v13
    v_lshlrev_b32 v36, 16, v14
    v_and_b32 v37, 0xffff0000, v14
    v_lshlrev_b32 v38, 16, v15
    v_and_b32 v39, 0xffff0000, v15
    v_pk_add_f32 v[24:25], v[24:25], v[40:41]
    v_pk_add_f32 v[26:27], v[26:27], v[42:43]
    v_pk_add_f32 v[28:29], v[28:29], v[44:45]
    v_pk_add_f32 v[30:31], v[30:31], v[46:47]
    v_pk_add_f32 v[32:33], v[32:33], v[48:49]
    v_pk_add_f32 v[34:35], v[34:35], v[50:51]
    v_pk_add_f32 v[36:37], v[36:37], v[52:53]
    v_pk_add_f32 v[38:39], v[38:39], v[54:55]
    v_cvt_pk_bf16_f32 v8, v24, v25
    v_cvt_pk_bf16_f32 v9, v26, v27
    v_cvt_pk_bf16_f32 v10, v28, v29
    v_cvt_pk_bf16_f32 v11, v30, v31
    v_cvt_pk_bf16_f32 v12, v32, v33
    v_cvt_pk_bf16_f32 v13, v34, v35
    v_cvt_pk_bf16_f32 v14, v36, v37
    v_cvt_pk_bf16_f32 v15, v38, v39
    buffer_store_dwordx4 v[8:11], v170, s[40:43], s58 offen sc0 sc1
    buffer_store_dwordx4 v[12:15], v170, s[40:43], s59 offen sc0 sc1
    s_endpgm
    s_nop 0
L_k1_col:
    s_setprio 3
    s_sub_u32 s2, s2, 256
    s_load_dwordx2 s[12:13], s[0:1], 72
    s_lshr_b32 s3, s2, 3
    s_and_b32 s3, s3, 1
    s_and_b32 s15, s2, 7
    s_lshl_b32 s15, s15, 1
    s_or_b32 s3, s3, s15
    s_and_b32 s15, s2, 0xf0
    s_or_b32 s14, s3, s15
    s_xor_b32 s14, s14, 255
    s_getpc_b64 s[20:21]
L_k2_pc:
    s_add_u32 s20, s20, TWTAB-L_k2_pc
    s_addc_u32 s21, s21, 0
    s_and_b32 s21, s21, 0xffff
    s_mov_b32 s22, 23296
    s_mov_b32 s23, 0x00020000
    s_mov_b32 s48, 0x3f3504f3
    s_mov_b32 s49, 0x3f3504f3
    v_lshlrev_b32 v3, 3, v0
    v_lshlrev_b32 v4, 4, v0
    v_and_b32 v5, 31, v0
    v_lshlrev_b32 v6, 4, v5
    v_and_b32 v101, 3, v0
    v_lshlrev_b32 v7, 4, v101
    s_mov_b32 s3, 4608
    buffer_load_dwordx4 v[40:43], v4, s[20:23], s3 offen
    s_mov_b32 s3, 8704
    buffer_load_dwordx4 v[44:47], v4, s[20:23], s3 offen
    s_mov_b32 s3, 12800
    buffer_load_dwordx4 v[48:51], v4, s[20:23], s3 offen
    s_mov_b32 s3, 16896
    buffer_load_dwordx4 v[52:55], v4, s[20:23], s3 offen
    v_lshrrev_b32 v96, 3, v0
    v_mul_u32_u24 v96, 16640, v96
    v_and_b32 v97, 7, v0
    v_lshlrev_b32 v97, 3, v97
    v_add_u32 v96, v96, v97
    s_waitcnt lgkmcnt(0)
    s_mov_b32 s24, s12
    s_and_b32 s25, s13, 0xffff
    s_mov_b32 s26, 0x410000
    s_mov_b32 s27, 0x00020000
    s_lshl_b32 s50, s14, 6
    buffer_load_dwordx2 v[8:9], v96, s[24:27], s50 offen
    s_add_u32 s50, s50, 532480
    buffer_load_dwordx2 v[10:11], v96, s[24:27], s50 offen
    s_add_u32 s50, s50, 532480
    buffer_load_dwordx2 v[12:13], v96, s[24:27], s50 offen
    s_add_u32 s50, s50, 532480
    buffer_load_dwordx2 v[14:15], v96, s[24:27], s50 offen
    s_add_u32 s50, s50, 532480
    buffer_load_dwordx2 v[16:17], v96, s[24:27], s50 offen
    s_add_u32 s50, s50, 532480
    buffer_load_dwordx2 v[18:19], v96, s[24:27], s50 offen
    s_add_u32 s50, s50, 532480
    buffer_load_dwordx2 v[20:21], v96, s[24:27], s50 offen
    s_add_u32 s50, s50, 532480
    buffer_load_dwordx2 v[22:23], v96, s[24:27], s50 offen
    s_add_u32 s28, s12, 0x500000
    s_addc_u32 s29, s13, 0
    s_and_b32 s29, s29, 0xffff
    s_mov_b32 s30, 0x410000
    s_mov_b32 s31, 0x00020000
    s_add_u32 s36, s12, 0x1580000
    s_addc_u32 s37, s13, 0
    s_and_b32 s37, s37, 0xffff
    s_mov_b32 s38, 0x208000
    s_mov_b32 s39, 0x00020000
    s_mul_i32 s50, s14, 16640
    s_lshl_b32 s51, s14, 13
    s_mov_b32 s3, 20992
    buffer_load_dwordx4 v[56:59], v6, s[20:23], s3 offen
    s_mov_b32 s3, 21504
    buffer_load_dwordx4 v[60:63], v6, s[20:23], s3 offen
    s_mov_b32 s3, 22016
    buffer_load_dwordx4 v[64:67], v6, s[20:23], s3 offen
    s_mov_b32 s3, 22528
    buffer_load_dwordx4 v[68:71], v6, s[20:23], s3 offen
    s_mov_b32 s3, 23040
    buffer_load_dwordx4 v[72:75], v7, s[20:23], s3 offen
    s_mov_b32 s3, 23104
    buffer_load_dwordx4 v[76:79], v7, s[20:23], s3 offen
    s_mov_b32 s3, 23168
    buffer_load_dwordx4 v[80:83], v7, s[20:23], s3 offen
    s_mov_b32 s3, 23232
    buffer_load_dwordx4 v[84:87], v7, s[20:23], s3 offen
    v_lshlrev_b32 v107, 5, v0
    buffer_load_dwordx4 v[88:91], v107, s[36:39], s51 offen
    buffer_load_dwordx4 v[92:95], v107, s[36:39], s51 offen offset:16
    s_mov_b32 s52, 2097152
    v_add_u32 v6, 0x1000, v3
    v_add_u32 v7, 0x2000, v3
    v_add_u32 v105, 0x3000, v3
    v_lshrrev_b32 v106, 5, v0
    v_lshlrev_b32 v96, 8, v106
    v_add_u32 v96, v96, v5
    v_lshlrev_b32 v96, 3, v96
    v_lshrrev_b32 v97, 6, v0
    v_mul_u32_u24 v97, 5120, v97
    v_add_u32 v97, 16384, v97
    v_and_b32 v98, 1, v106
    v_mul_u32_u24 v98, 288, v98
    v_add_u32 v99, v98, v5
    v_lshlrev_b32 v99, 3, v99
    v_add_u32 v99, v99, v97
    v_lshrrev_b32 v100, 2, v5
    v_mul_u32_u24 v100, 36, v100
    v_add_u32 v100, v100, v101
    v_add_u32 v100, v100, v98
    v_lshlrev_b32 v100, 3, v100
    v_add_u32 v100, v100, v97
    v_and_b32 v102, 63, v0
    v_lshrrev_b32 v102, 2, v102
    v_mul_u32_u24 v102, 20, v102
    v_mul_u32_u24 v103, 5, v101
    v_add_u32 v103, v103, v102
    v_lshlrev_b32 v103, 4, v103
    v_add_u32 v103, v103, v97
    v_add_u32 v104, v102, v101
    v_lshlrev_b32 v104, 4, v104
    v_add_u32 v104, v104, v97
    s_waitcnt vmcnt(10)
    v_add_f32 v24, v8, v16
    v_add_f32 v25, v9, v17
    v_sub_f32 v32, v8, v16
    v_sub_f32 v33, v9, v17
    v_add_f32 v26, v10, v18
    v_add_f32 v27, v11, v19
    v_sub_f32 v34, v10, v18
    v_sub_f32 v35, v11, v19
    v_add_f32 v28, v12, v20
    v_add_f32 v29, v13, v21
    v_sub_f32 v36, v12, v20
    v_sub_f32 v37, v13, v21
    v_add_f32 v30, v14, v22
    v_add_f32 v31, v15, v23
    v_sub_f32 v38, v14, v22
    v_sub_f32 v39, v15, v23
    v_add_f32 v8, v34, v35
    v_sub_f32 v9, v35, v34
    v_mul_f32 v34, s48, v8
    v_mul_f32 v35, s48, v9
    v_sub_f32 v10, v38, v39
    v_add_f32 v11, v39, v38
    v_mul_f32 v38, -v10, s48
    v_mul_f32 v39, -v11, s48
    v_add_f32 v8, v24, v28
    v_add_f32 v9, v25, v29
    v_sub_f32 v10, v24, v28
    v_sub_f32 v11, v25, v29
    v_add_f32 v12, v26, v30
    v_add_f32 v13, v27, v31
    v_sub_f32 v14, v26, v30
    v_sub_f32 v15, v27, v31
    v_add_f32 v16, v32, v37
    v_sub_f32 v17, v33, v36
    v_sub_f32 v18, v32, v37
    v_add_f32 v19, v33, v36
    v_add_f32 v20, v34, v38
    v_add_f32 v21, v35, v39
    v_sub_f32 v22, v34, v38
    v_sub_f32 v23, v35, v39
    v_add_f32 v24, v8, v12
    v_add_f32 v25, v9, v13
    v_sub_f32 v32, v8, v12
    v_sub_f32 v33, v9, v13
    v_add_f32 v28, v10, v15
    v_sub_f32 v29, v11, v14
    v_sub_f32 v36, v10, v15
    v_add_f32 v37, v11, v14
    v_add_f32 v26, v16, v20
    v_add_f32 v27, v17, v21
    v_sub_f32 v34, v16, v20
    v_sub_f32 v35, v17, v21
    v_add_f32 v30, v18, v23
    v_sub_f32 v31, v19, v22
    v_sub_f32 v38, v18, v23
    v_add_f32 v39, v19, v22
    v_mul_f32 v10, v26, v42
    v_mul_f32 v11, v27, v42
    v_fma_f32 v10, -v27, v43, v10
    v_fmac_f32 v11, v26, v43
    v_mul_f32 v12, v28, v44
    v_mul_f32 v13, v29, v44
    v_fma_f32 v12, -v29, v45, v12
    v_fmac_f32 v13, v28, v45
    v_mul_f32 v14, v30, v46
    v_mul_f32 v15, v31, v46
    v_fma_f32 v14, -v31, v47, v14
    v_fmac_f32 v15, v30, v47
    v_mul_f32 v16, v32, v48
    v_mul_f32 v17, v33, v48
    v_fma_f32 v16, -v33, v49, v16
    v_fmac_f32 v17, v32, v49
    v_mul_f32 v18, v34, v50
    v_mul_f32 v19, v35, v50
    v_fma_f32 v18, -v35, v51, v18
    v_fmac_f32 v19, v34, v51
    v_mul_f32 v20, v36, v52
    v_mul_f32 v21, v37, v52
    v_fma_f32 v20, -v37, v53, v20
    v_fmac_f32 v21, v36, v53
    v_mul_f32 v22, v38, v54
    v_mul_f32 v23, v39, v54
    v_fma_f32 v22, -v39, v55, v22
    v_fmac_f32 v23, v38, v55
    ds_write_b64 v3, v[24:25] offset:0
    ds_write_b64 v3, v[10:11] offset:2048
    ds_write_b64 v3, v[12:13] offset:4096
    ds_write_b64 v3, v[14:15] offset:6144
    ds_write_b64 v3, v[16:17] offset:8192
    ds_write_b64 v3, v[18:19] offset:10240
    ds_write_b64 v3, v[20:21] offset:12288
    ds_write_b64 v3, v[22:23] offset:14336
    s_waitcnt lgkmcnt(0)
    s_barrier
    ds_read_b64 v[8:9], v96 offset:0
    ds_read_b64 v[10:11], v96 offset:256
    ds_read_b64 v[12:13], v96 offset:512
    ds_read_b64 v[14:15], v96 offset:768
    ds_read_b64 v[16:17], v96 offset:1024
    ds_read_b64 v[18:19], v96 offset:1280
    ds_read_b64 v[20:21], v96 offset:1536
    ds_read_b64 v[22:23], v96 offset:1792
    s_waitcnt vmcnt(2) lgkmcnt(0)
    s_cmp_lg_u32 s14, 0
    s_cbranch_scc1 L_k2_nouv
    v_lshlrev_b32 v176, 7, v0
    buffer_load_dwordx4 v[128:131], v176, s[36:39], s52 offen offset:0
    buffer_load_dwordx4 v[132:135], v176, s[36:39], s52 offen offset:16
    buffer_load_dwordx4 v[136:139], v176, s[36:39], s52 offen offset:32
    buffer_load_dwordx4 v[140:143], v176, s[36:39], s52 offen offset:48
    buffer_load_dwordx4 v[144:147], v176, s[36:39], s52 offen offset:64
    buffer_load_dwordx4 v[148:151], v176, s[36:39], s52 offen offset:80
    buffer_load_dwordx4 v[152:155], v176, s[36:39], s52 offen offset:96
    buffer_load_dwordx4 v[156:159], v176, s[36:39], s52 offen offset:112
    v_bfe_u32 v108, v0, 2, 3
    v_lshl_add_u32 v108, v108, 3, v106
    v_lshrrev_b32 v109, 5, v108
    v_lshl_add_u32 v109, v109, 2, v108
    v_mul_u32_u24 v110, 162, v101
    v_add_u32 v109, v109, v110
    v_lshlrev_b32 v109, 3, v109
    v_add_u32 v176, 53248, v109
    v_sub_u32 v177, 57856, v109
    v_and_b32 v110, 31, v108
    v_cmp_ne_u32 vcc, 0, v110
    s_nop 1
    v_cndmask_b32 v110, 0, 32, vcc
    v_sub_u32 v177, v177, v110
    v_subrev_u32 v178, 144, v177
    v_cmp_ne_u32 vcc, 0, v108
    s_nop 1
    v_cndmask_b32 v177, v177, v178, vcc
    v_mov_b32 v110, 73984
    v_cmp_eq_u32 vcc, 0, v0
    s_nop 1
    v_cndmask_b32 v179, v176, v110, vcc
    s_nop 2
L_k2_nouv:
    v_add_f32 v24, v8, v16
    v_add_f32 v25, v9, v17
    v_sub_f32 v32, v8, v16
    v_sub_f32 v33, v9, v17
    v_add_f32 v26, v10, v18
    v_add_f32 v27, v11, v19
    v_sub_f32 v34, v10, v18
    v_sub_f32 v35, v11, v19
    v_add_f32 v28, v12, v20
    v_add_f32 v29, v13, v21
    v_sub_f32 v36, v12, v20
    v_sub_f32 v37, v13, v21
    v_add_f32 v30, v14, v22
    v_add_f32 v31, v15, v23
    v_sub_f32 v38, v14, v22
    v_sub_f32 v39, v15, v23
    v_add_f32 v8, v34, v35
    v_sub_f32 v9, v35, v34
    v_mul_f32 v34, s48, v8
    v_mul_f32 v35, s48, v9
    v_sub_f32 v10, v38, v39
    v_add_f32 v11, v39, v38
    v_mul_f32 v38, -v10, s48
    v_mul_f32 v39, -v11, s48
    v_add_f32 v8, v24, v28
    v_add_f32 v9, v25, v29
    v_sub_f32 v10, v24, v28
    v_sub_f32 v11, v25, v29
    v_add_f32 v12, v26, v30
    v_add_f32 v13, v27, v31
    v_sub_f32 v14, v26, v30
    v_sub_f32 v15, v27, v31
    v_add_f32 v16, v32, v37
    v_sub_f32 v17, v33, v36
    v_sub_f32 v18, v32, v37
    v_add_f32 v19, v33, v36
    v_add_f32 v20, v34, v38
    v_add_f32 v21, v35, v39
    v_sub_f32 v22, v34, v38
    v_sub_f32 v23, v35, v39
    v_add_f32 v24, v8, v12
    v_add_f32 v25, v9, v13
    v_sub_f32 v32, v8, v12
    v_sub_f32 v33, v9, v13
    v_add_f32 v28, v10, v15
    v_sub_f32 v29, v11, v14
    v_sub_f32 v36, v10, v15
    v_add_f32 v37, v11, v14
    v_add_f32 v26, v16, v20
    v_add_f32 v27, v17, v21
    v_sub_f32 v34, v16, v20
    v_sub_f32 v35, v17, v21
    v_add_f32 v30, v18, v23
    v_sub_f32 v31, v19, v22
    v_sub_f32 v38, v18, v23
    v_add_f32 v39, v19, v22
    v_mul_f32 v10, v26, v58
    v_mul_f32 v11, v27, v58
    v_fma_f32 v10, -v27, v59, v10
    v_fmac_f32 v11, v26, v59
    v_mul_f32 v12, v28, v60
    v_mul_f32 v13, v29, v60
    v_fma_f32 v12, -v29, v61, v12
    v_fmac_f32 v13, v28, v61
    v_mul_f32 v14, v30, v62
    v_mul_f32 v15, v31, v62
    v_fma_f32 v14, -v31, v63, v14
    v_fmac_f32 v15, v30, v63
    v_mul_f32 v16, v32, v64
    v_mul_f32 v17, v33, v64
    v_fma_f32 v16, -v33, v65, v16
    v_fmac_f32 v17, v32, v65
    v_mul_f32 v18, v34, v66
    v_mul_f32 v19, v35, v66
    v_fma_f32 v18, -v35, v67, v18
    v_fmac_f32 v19, v34, v67
    v_mul_f32 v20, v36, v68
    v_mul_f32 v21, v37, v68
    v_fma_f32 v20, -v37, v69, v20
    v_fmac_f32 v21, v36, v69
    v_mul_f32 v22, v38, v70
    v_mul_f32 v23, v39, v70
    v_fma_f32 v22, -v39, v71, v22
    v_fmac_f32 v23, v38, v71
    ds_write_b64 v99, v[24:25]
    ds_write_b64 v99, v[10:11] offset:288
    ds_write_b64 v99, v[12:13] offset:576
    ds_write_b64 v99, v[14:15] offset:864
    ds_write_b64 v99, v[16:17] offset:1152
    ds_write_b64 v99, v[18:19] offset:1440
    ds_write_b64 v99, v[20:21] offset:1728
    ds_write_b64 v99, v[22:23] offset:2016
    ds_read_b64 v[8:9], v100 offset:0
    ds_read_b64 v[10:11], v100 offset:32
    ds_read_b64 v[12:13], v100 offset:64
    ds_read_b64 v[14:15], v100 offset:96
    ds_read_b64 v[16:17], v100 offset:128
    ds_read_b64 v[18:19], v100 offset:160
    ds_read_b64 v[20:21], v100 offset:192
    ds_read_b64 v[22:23], v100 offset:224
    s_waitcnt lgkmcnt(0)
    v_add_f32 v24, v8, v16
    v_add_f32 v25, v9, v17
    v_sub_f32 v32, v8, v16
    v_sub_f32 v33, v9, v17
    v_add_f32 v26, v10, v18
    v_add_f32 v27, v11, v19
    v_sub_f32 v34, v10, v18
    v_sub_f32 v35, v11, v19
    v_add_f32 v28, v12, v20
    v_add_f32 v29, v13, v21
    v_sub_f32 v36, v12, v20
    v_sub_f32 v37, v13, v21
    v_add_f32 v30, v14, v22
    v_add_f32 v31, v15, v23
    v_sub_f32 v38, v14, v22
    v_sub_f32 v39, v15, v23
    v_add_f32 v8, v34, v35
    v_sub_f32 v9, v35, v34
    v_mul_f32 v34, s48, v8
    v_mul_f32 v35, s48, v9
    v_sub_f32 v10, v38, v39
    v_add_f32 v11, v39, v38
    v_mul_f32 v38, -v10, s48
    v_mul_f32 v39, -v11, s48
    v_add_f32 v8, v24, v28
    v_add_f32 v9, v25, v29
    v_sub_f32 v10, v24, v28
    v_sub_f32 v11, v25, v29
    v_add_f32 v12, v26, v30
    v_add_f32 v13, v27, v31
    v_sub_f32 v14, v26, v30
    v_sub_f32 v15, v27, v31
    v_add_f32 v16, v32, v37
    v_sub_f32 v17, v33, v36
    v_sub_f32 v18, v32, v37
    v_add_f32 v19, v33, v36
    v_add_f32 v20, v34, v38
    v_add_f32 v21, v35, v39
    v_sub_f32 v22, v34, v38
    v_sub_f32 v23, v35, v39
    v_add_f32 v24, v8, v12
    v_add_f32 v25, v9, v13
    v_sub_f32 v32, v8, v12
    v_sub_f32 v33, v9, v13
    v_add_f32 v28, v10, v15
    v_sub_f32 v29, v11, v14
    v_sub_f32 v36, v10, v15
    v_add_f32 v37, v11, v14
    v_add_f32 v26, v16, v20
    v_add_f32 v27, v17, v21
    v_sub_f32 v34, v16, v20
    v_sub_f32 v35, v17, v21
    v_add_f32 v30, v18, v23
    v_sub_f32 v31, v19, v22
    v_sub_f32 v38, v18, v23
    v_add_f32 v39, v19, v22
    v_mov_b32 v8, v24
    v_mov_b32 v9, v25
    v_mul_f32 v10, v26, v74
    v_mul_f32 v11, v27, v74
    v_fma_f32 v10, -v27, v75, v10
    v_fmac_f32 v11, v26, v75
    v_mul_f32 v12, v28, v76
    v_mul_f32 v13, v29, v76
    v_fma_f32 v12, -v29, v77, v12
    v_fmac_f32 v13, v28, v77
    v_mul_f32 v14, v30, v78
    v_mul_f32 v15, v31, v78
    v_fma_f32 v14, -v31, v79, v14
    v_fmac_f32 v15, v30, v79
    v_mul_f32 v16, v32, v80
    v_mul_f32 v17, v33, v80
    v_fma_f32 v16, -v33, v81, v16
    v_fmac_f32 v17, v32, v81
    v_mul_f32 v18, v34, v82
    v_mul_f32 v19, v35, v82
    v_fma_f32 v18, -v35, v83, v18
    v_fmac_f32 v19, v34, v83
    v_mul_f32 v20, v36, v84
    v_mul_f32 v21, v37, v84
    v_fma_f32 v20, -v37, v85, v20
    v_fmac_f32 v21, v36, v85
    v_mul_f32 v22, v38, v86
    v_mul_f32 v23, v39, v86
    v_fma_f32 v22, -v39, v87, v22
    v_fmac_f32 v23, v38, v87
    ds_write_b128 v103, v[8:11] offset:0
    ds_write_b128 v103, v[12:15] offset:16
    ds_write_b128 v103, v[16:19] offset:32
    ds_write_b128 v103, v[20:23] offset:48
    ds_read_b128 v[24:27], v104 offset:0
    ds_read_b128 v[28:31], v104 offset:80
    ds_read_b128 v[32:35], v104 offset:160
    ds_read_b128 v[36:39], v104 offset:240
    s_waitcnt lgkmcnt(0)
    v_add_f32 v8, v24, v32
    v_add_f32 v9, v25, v33
    v_sub_f32 v10, v24, v32
    v_sub_f32 v11, v25, v33
    v_add_f32 v12, v28, v36
    v_add_f32 v13, v29, v37
    v_sub_f32 v14, v28, v36
    v_sub_f32 v15, v29, v37
    v_add_f32 v24, v8, v12
    v_add_f32 v25, v9, v13
    v_sub_f32 v32, v8, v12
    v_sub_f32 v33, v9, v13
    v_add_f32 v28, v10, v15
    v_sub_f32 v29, v11, v14
    v_sub_f32 v36, v10, v15
    v_add_f32 v37, v11, v14
    v_add_f32 v16, v26, v34
    v_add_f32 v17, v27, v35
    v_sub_f32 v18, v26, v34
    v_sub_f32 v19, v27, v35
    v_add_f32 v20, v30, v38
    v_add_f32 v21, v31, v39
    v_sub_f32 v22, v30, v38
    v_sub_f32 v23, v31, v39
    v_add_f32 v26, v16, v20
    v_add_f32 v27, v17, v21
    v_sub_f32 v34, v16, v20
    v_sub_f32 v35, v17, v21
    v_add_f32 v30, v18, v23
    v_sub_f32 v31, v19, v22
    v_sub_f32 v38, v18, v23
    v_add_f32 v39, v19, v22
    s_waitcnt vmcnt(0)
    s_cmp_eq_u32 s14, 0
    s_nop 0
    s_cbranch_scc1 L_k2_special
    v_lshlrev_b32 v108, 16, v88
    v_and_b32 v109, 0xffff0000, v88
    v_mul_f32 v8, v24, v108
    v_mul_f32 v9, v25, v108
    v_fma_f32 v8, -v25, v109, v8
    v_fmac_f32 v9, v24, v109
    v_lshlrev_b32 v110, 16, v89
    v_and_b32 v111, 0xffff0000, v89
    v_mul_f32 v12, v28, v110
    v_mul_f32 v13, v29, v110
    v_fma_f32 v12, -v29, v111, v12
    v_fmac_f32 v13, v28, v111
    v_lshlrev_b32 v108, 16, v90
    v_and_b32 v109, 0xffff0000, v90
    v_mul_f32 v16, v32, v108
    v_mul_f32 v17, v33, v108
    v_fma_f32 v16, -v33, v109, v16
    v_fmac_f32 v17, v32, v109
    v_lshlrev_b32 v110, 16, v91
    v_and_b32 v111, 0xffff0000, v91
    v_mul_f32 v20, v36, v110
    v_mul_f32 v21, v37, v110
    v_fma_f32 v20, -v37, v111, v20
    v_fmac_f32 v21, v36, v111
    v_lshlrev_b32 v108, 16, v92
    v_and_b32 v109, 0xffff0000, v92
    v_mul_f32 v10, v26, v108
    v_mul_f32 v11, v27, v108
    v_fma_f32 v10, -v27, v109, v10
    v_fmac_f32 v11, v26, v109
    v_lshlrev_b32 v110, 16, v93
    v_and_b32 v111, 0xffff0000, v93
    v_mul_f32 v14, v30, v110
    v_mul_f32 v15, v31, v110
    v_fma_f32 v14, -v31, v111, v14
    v_fmac_f32 v15, v30, v111
    v_lshlrev_b32 v108, 16, v94
    v_and_b32 v109, 0xffff0000, v94
    v_mul_f32 v18, v34, v108
    v_mul_f32 v19, v35, v108
    v_fma_f32 v18, -v35, v109, v18
    v_fmac_f32 v19, v34, v109
    v_lshlrev_b32 v110, 16, v95
    v_and_b32 v111, 0xffff0000, v95
    v_mul_f32 v22, v38, v110
    v_mul_f32 v23, v39, v110
    v_fma_f32 v22, -v39, v111, v22
    v_fmac_f32 v23, v38, v111
    s_nop 2
L_k2_back:
    v_add_f32 v24, v8, v16
    v_add_f32 v25, v9, v17
    v_sub_f32 v26, v8, v16
    v_sub_f32 v27, v9, v17
    v_add_f32 v28, v12, v20
    v_add_f32 v29, v13, v21
    v_sub_f32 v30, v12, v20
    v_sub_f32 v31, v13, v21
    v_add_f32 v8, v24, v28
    v_add_f32 v9, v25, v29
    v_sub_f32 v16, v24, v28
    v_sub_f32 v17, v25, v29
    v_sub_f32 v12, v26, v31
    v_add_f32 v13, v27, v30
    v_add_f32 v20, v26, v31
    v_sub_f32 v21, v27, v30
    v_add_f32 v32, v10, v18
    v_add_f32 v33, v11, v19
    v_sub_f32 v34, v10, v18
    v_sub_f32 v35, v11, v19
    v_add_f32 v36, v14, v22
    v_add_f32 v37, v15, v23
    v_sub_f32 v38, v14, v22
    v_sub_f32 v39, v15, v23
    v_add_f32 v10, v32, v36
    v_add_f32 v11, v33, v37
    v_sub_f32 v18, v32, v36
    v_sub_f32 v19, v33, v37
    v_sub_f32 v14, v34, v39
    v_add_f32 v15, v35, v38
    v_add_f32 v22, v34, v39
    v_sub_f32 v23, v35, v38
    ds_write_b128 v104, v[8:11] offset:0
    ds_write_b128 v104, v[12:15] offset:80
    ds_write_b128 v104, v[16:19] offset:160
    ds_write_b128 v104, v[20:23] offset:240
    ds_read_b128 v[24:27], v103 offset:0
    ds_read_b128 v[28:31], v103 offset:16
    ds_read_b128 v[32:35], v103 offset:32
    ds_read_b128 v[36:39], v103 offset:48
    s_waitcnt lgkmcnt(0)
    v_mov_b32 v8, v24
    v_mov_b32 v9, v25
    v_mul_f32 v10, v26, v74
    v_mul_f32 v11, v27, v74
    v_fmac_f32 v10, v27, v75
    v_fma_f32 v11, -v26, v75, v11
    v_mul_f32 v12, v28, v76
    v_mul_f32 v13, v29, v76
    v_fmac_f32 v12, v29, v77
    v_fma_f32 v13, -v28, v77, v13
    v_mul_f32 v14, v30, v78
    v_mul_f32 v15, v31, v78
    v_fmac_f32 v14, v31, v79
    v_fma_f32 v15, -v30, v79, v15
    v_mul_f32 v16, v32, v80
    v_mul_f32 v17, v33, v80
    v_fmac_f32 v16, v33, v81
    v_fma_f32 v17, -v32, v81, v17
    v_mul_f32 v18, v34, v82
    v_mul_f32 v19, v35, v82
    v_fmac_f32 v18, v35, v83
    v_fma_f32 v19, -v34, v83, v19
    v_mul_f32 v20, v36, v84
    v_mul_f32 v21, v37, v84
    v_fmac_f32 v20, v37, v85
    v_fma_f32 v21, -v36, v85, v21
    v_mul_f32 v22, v38, v86
    v_mul_f32 v23, v39, v86
    v_fmac_f32 v22, v39, v87
    v_fma_f32 v23, -v38, v87, v23
    v_add_f32 v24, v8, v16
    v_add_f32 v25, v9, v17
    v_sub_f32 v32, v8, v16
    v_sub_f32 v33, v9, v17
    v_add_f32 v26, v10, v18
    v_add_f32 v27, v11, v19
    v_sub_f32 v34, v10, v18
    v_sub_f32 v35, v11, v19
    v_add_f32 v28, v12, v20
    v_add_f32 v29, v13, v21
    v_sub_f32 v36, v12, v20
    v_sub_f32 v37, v13, v21
    v_add_f32 v30, v14, v22
    v_add_f32 v31, v15, v23
    v_sub_f32 v38, v14, v22
    v_sub_f32 v39, v15, v23
    v_sub_f32 v8, v34, v35
    v_add_f32 v9, v35, v34
    v_mul_f32 v34, s48, v8
    v_mul_f32 v35, s48, v9
    v_add_f32 v10, v38, v39
    v_sub_f32 v11, v39, v38
    v_mul_f32 v38, -v10, s48
    v_mul_f32 v39, -v11, s48
    v_add_f32 v8, v24, v28
    v_add_f32 v9, v25, v29
    v_sub_f32 v10, v24, v28
    v_sub_f32 v11, v25, v29
    v_add_f32 v12, v26, v30
    v_add_f32 v13, v27, v31
    v_sub_f32 v14, v26, v30
    v_sub_f32 v15, v27, v31
    v_sub_f32 v16, v32, v37
    v_add_f32 v17, v33, v36
    v_add_f32 v18, v32, v37
    v_sub_f32 v19, v33, v36
    v_add_f32 v20, v34, v38
    v_add_f32 v21, v35, v39
    v_sub_f32 v22, v34, v38
    v_sub_f32 v23, v35, v39
    v_add_f32 v24, v8, v12
    v_add_f32 v25, v9, v13
    v_sub_f32 v32, v8, v12
    v_sub_f32 v33, v9, v13
    v_sub_f32 v28, v10, v15
    v_add_f32 v29, v11, v14
    v_add_f32 v36, v10, v15
    v_sub_f32 v37, v11, v14
    v_add_f32 v26, v16, v20
    v_add_f32 v27, v17, v21
    v_sub_f32 v34, v16, v20
    v_sub_f32 v35, v17, v21
    v_sub_f32 v30, v18, v23
    v_add_f32 v31, v19, v22
    v_add_f32 v38, v18, v23
    v_sub_f32 v39, v19, v22
    ds_write_b64 v100, v[24:25] offset:0
    ds_write_b64 v100, v[26:27] offset:32
    ds_write_b64 v100, v[28:29] offset:64
    ds_write_b64 v100, v[30:31] offset:96
    ds_write_b64 v100, v[32:33] offset:128
    ds_write_b64 v100, v[34:35] offset:160
    ds_write_b64 v100, v[36:37] offset:192
    ds_write_b64 v100, v[38:39] offset:224
    ds_read_b64 v[8:9], v99
    ds_read_b64 v[26:27], v99 offset:288
    ds_read_b64 v[28:29], v99 offset:576
    ds_read_b64 v[30:31], v99 offset:864
    ds_read_b64 v[32:33], v99 offset:1152
    ds_read_b64 v[34:35], v99 offset:1440
    ds_read_b64 v[36:37], v99 offset:1728
    ds_read_b64 v[38:39], v99 offset:2016
    s_waitcnt lgkmcnt(0)
    v_mul_f32 v10, v26, v58
    v_mul_f32 v11, v27, v58
    v_fmac_f32 v10, v27, v59
    v_fma_f32 v11, -v26, v59, v11
    v_mul_f32 v12, v28, v60
    v_mul_f32 v13, v29, v60
    v_fmac_f32 v12, v29, v61
    v_fma_f32 v13, -v28, v61, v13
    v_mul_f32 v14, v30, v62
    v_mul_f32 v15, v31, v62
    v_fmac_f32 v14, v31, v63
    v_fma_f32 v15, -v30, v63, v15
    v_mul_f32 v16, v32, v64
    v_mul_f32 v17, v33, v64
    v_fmac_f32 v16, v33, v65
    v_fma_f32 v17, -v32, v65, v17
    v_mul_f32 v18, v34, v66
    v_mul_f32 v19, v35, v66
    v_fmac_f32 v18, v35, v67
    v_fma_f32 v19, -v34, v67, v19
    v_mul_f32 v20, v36, v68
    v_mul_f32 v21, v37, v68
    v_fmac_f32 v20, v37, v69
    v_fma_f32 v21, -v36, v69, v21
    v_mul_f32 v22, v38, v70
    v_mul_f32 v23, v39, v70
    v_fmac_f32 v22, v39, v71
    v_fma_f32 v23, -v38, v71, v23
    v_add_f32 v24, v8, v16
    v_add_f32 v25, v9, v17
    v_sub_f32 v32, v8, v16
    v_sub_f32 v33, v9, v17
    v_add_f32 v26, v10, v18
    v_add_f32 v27, v11, v19
    v_sub_f32 v34, v10, v18
    v_sub_f32 v35, v11, v19
    v_add_f32 v28, v12, v20
    v_add_f32 v29, v13, v21
    v_sub_f32 v36, v12, v20
    v_sub_f32 v37, v13, v21
    v_add_f32 v30, v14, v22
    v_add_f32 v31, v15, v23
    v_sub_f32 v38, v14, v22
    v_sub_f32 v39, v15, v23
    v_sub_f32 v8, v34, v35
    v_add_f32 v9, v35, v34
    v_mul_f32 v34, s48, v8
    v_mul_f32 v35, s48, v9
    v_add_f32 v10, v38, v39
    v_sub_f32 v11, v39, v38
    v_mul_f32 v38, -v10, s48
    v_mul_f32 v39, -v11, s48
    v_add_f32 v8, v24, v28
    v_add_f32 v9, v25, v29
    v_sub_f32 v10, v24, v28
    v_sub_f32 v11, v25, v29
    v_add_f32 v12, v26, v30
    v_add_f32 v13, v27, v31
    v_sub_f32 v14, v26, v30
    v_sub_f32 v15, v27, v31
    v_sub_f32 v16, v32, v37
    v_add_f32 v17, v33, v36
    v_add_f32 v18, v32, v37
    v_sub_f32 v19, v33, v36
    v_add_f32 v20, v34, v38
    v_add_f32 v21, v35, v39
    v_sub_f32 v22, v34, v38
    v_sub_f32 v23, v35, v39
    v_add_f32 v24, v8, v12
    v_add_f32 v25, v9, v13
    v_sub_f32 v32, v8, v12
    v_sub_f32 v33, v9, v13
    v_sub_f32 v28, v10, v15
    v_add_f32 v29, v11, v14
    v_add_f32 v36, v10, v15
    v_sub_f32 v37, v11, v14
    v_add_f32 v26, v16, v20
    v_add_f32 v27, v17, v21
    v_sub_f32 v34, v16, v20
    v_sub_f32 v35, v17, v21
    v_sub_f32 v30, v18, v23
    v_add_f32 v31, v19, v22
    v_add_f32 v38, v18, v23
    v_sub_f32 v39, v19, v22
    ds_write_b64 v96, v[24:25] offset:36864
    ds_write_b64 v96, v[26:27] offset:37120
    ds_write_b64 v96, v[28:29] offset:37376
    ds_write_b64 v96, v[30:31] offset:37632
    ds_write_b64 v96, v[32:33] offset:37888
    ds_write_b64 v96, v[34:35] offset:38144
    ds_write_b64 v96, v[36:37] offset:38400
    ds_write_b64 v96, v[38:39] offset:38656
    s_waitcnt lgkmcnt(0)
    s_barrier
    ds_read_b64 v[8:9], v3 offset:36864
    ds_read_b64 v[26:27], v3 offset:38912
    ds_read_b64 v[28:29], v3 offset:40960
    ds_read_b64 v[30:31], v3 offset:43008
    ds_read_b64 v[32:33], v3 offset:45056
    ds_read_b64 v[34:35], v3 offset:47104
    ds_read_b64 v[36:37], v3 offset:49152
    ds_read_b64 v[38:39], v3 offset:51200
    s_waitcnt lgkmcnt(0)
    v_mul_f32 v10, v26, v42
    v_mul_f32 v11, v27, v42
    v_fmac_f32 v10, v27, v43
    v_fma_f32 v11, -v26, v43, v11
    v_mul_f32 v12, v28, v44
    v_mul_f32 v13, v29, v44
    v_fmac_f32 v12, v29, v45
    v_fma_f32 v13, -v28, v45, v13
    v_mul_f32 v14, v30, v46
    v_mul_f32 v15, v31, v46
    v_fmac_f32 v14, v31, v47
    v_fma_f32 v15, -v30, v47, v15
    v_mul_f32 v16, v32, v48
    v_mul_f32 v17, v33, v48
    v_fmac_f32 v16, v33, v49
    v_fma_f32 v17, -v32, v49, v17
    v_mul_f32 v18, v34, v50
    v_mul_f32 v19, v35, v50
    v_fmac_f32 v18, v35, v51
    v_fma_f32 v19, -v34, v51, v19
    v_mul_f32 v20, v36, v52
    v_mul_f32 v21, v37, v52
    v_fmac_f32 v20, v37, v53
    v_fma_f32 v21, -v36, v53, v21
    v_mul_f32 v22, v38, v54
    v_mul_f32 v23, v39, v54
    v_fmac_f32 v22, v39, v55
    v_fma_f32 v23, -v38, v55, v23
    v_add_f32 v24, v8, v16
    v_add_f32 v25, v9, v17
    v_sub_f32 v32, v8, v16
    v_sub_f32 v33, v9, v17
    v_add_f32 v26, v10, v18
    v_add_f32 v27, v11, v19
    v_sub_f32 v34, v10, v18
    v_sub_f32 v35, v11, v19
    v_add_f32 v28, v12, v20
    v_add_f32 v29, v13, v21
    v_sub_f32 v36, v12, v20
    v_sub_f32 v37, v13, v21
    v_add_f32 v30, v14, v22
    v_add_f32 v31, v15, v23
    v_sub_f32 v38, v14, v22
    v_sub_f32 v39, v15, v23
    v_sub_f32 v8, v34, v35
    v_add_f32 v9, v35, v34
    v_mul_f32 v34, s48, v8
    v_mul_f32 v35, s48, v9
    v_add_f32 v10, v38, v39
    v_sub_f32 v11, v39, v38
    v_mul_f32 v38, -v10, s48
    v_mul_f32 v39, -v11, s48
    v_add_f32 v8, v24, v28
    v_add_f32 v9, v25, v29
    v_sub_f32 v10, v24, v28
    v_sub_f32 v11, v25, v29
    v_add_f32 v12, v26, v30
    v_add_f32 v13, v27, v31
    v_sub_f32 v14, v26, v30
    v_sub_f32 v15, v27, v31
    v_sub_f32 v16, v32, v37
    v_add_f32 v17, v33, v36
    v_add_f32 v18, v32, v37
    v_sub_f32 v19, v33, v36
    v_add_f32 v20, v34, v38
    v_add_f32 v21, v35, v39
    v_sub_f32 v22, v34, v38
    v_sub_f32 v23, v35, v39
    v_add_f32 v24, v8, v12
    v_add_f32 v25, v9, v13
    v_sub_f32 v32, v8, v12
    v_sub_f32 v33, v9, v13
    v_sub_f32 v28, v10, v15
    v_add_f32 v29, v11, v14
    v_add_f32 v36, v10, v15
    v_sub_f32 v37, v11, v14
    v_add_f32 v26, v16, v20
    v_add_f32 v27, v17, v21
    v_sub_f32 v34, v16, v20
    v_sub_f32 v35, v17, v21
    v_sub_f32 v30, v18, v23
    v_add_f32 v31, v19, v22
    v_add_f32 v38, v18, v23
    v_sub_f32 v39, v19, v22
    buffer_store_dwordx2 v[24:25], v3, s[28:31], s50 offen offset:0 sc0 sc1
    buffer_store_dwordx2 v[26:27], v3, s[28:31], s50 offen offset:2048 sc0 sc1
    buffer_store_dwordx2 v[28:29], v6, s[28:31], s50 offen offset:0 sc0 sc1
    buffer_store_dwordx2 v[30:31], v6, s[28:31], s50 offen offset:2048 sc0 sc1
    buffer_store_dwordx2 v[32:33], v7, s[28:31], s50 offen offset:0 sc0 sc1
    buffer_store_dwordx2 v[34:35], v7, s[28:31], s50 offen offset:2048 sc0 sc1
    buffer_store_dwordx2 v[36:37], v105, s[28:31], s50 offen offset:0 sc0 sc1
    buffer_store_dwordx2 v[38:39], v105, s[28:31], s50 offen offset:2048 sc0 sc1
    s_add_u32 s32, s12, 0x1e00000
    s_addc_u32 s33, s13, 0
    s_and_b32 s33, s33, 0xffff
    s_mov_b32 s34, 0x100000
    s_mov_b32 s35, 0x00020000
    v_and_b32 v1, 63, v0
    v_lshrrev_b32 v2, 6, v0
    s_nop 0
    v_readfirstlane_b32 s50, v2
    s_lshr_b32 s56, s14, 2
    s_mul_i32 s56, s56, 256
    s_and_b32 s3, s14, 3
    s_lshl_b32 s3, s3, 2
    s_add_u32 s56, s56, s3
    s_add_u32 s56, s56, 0
    v_mov_b32 v140, 1
    v_mov_b32 v141, 0
    s_and_b32 s14, s2, 3
    s_lshl_b32 s14, s14, 6
    s_and_b32 s3, s2, 4
    s_lshl_b32 s3, s3, 3
    s_or_b32 s14, s14, s3
    s_lshr_b32 s3, s2, 3
    s_and_b32 s3, s3, 31
    s_or_b32 s14, s14, s3
    v_lshrrev_b32 v5, 3, v1
    v_and_b32 v6, 7, v1
    v_lshlrev_b32 v3, 4, v1
    v_lshlrev_b32 v4, 4, v6
    s_lshl_b32 s51, s14, 3
    s_lshl_b32 s52, s50, 1
    s_add_u32 s51, s51, s52
    v_lshrrev_b32 v120, 2, v0
    v_and_b32 v121, 3, v0
    v_mul_u32_u24 v122, 16640, v120
    v_lshlrev_b32 v123, 4, v121
    v_add_u32 v122, v122, v123
    s_lshl_b32 s53, s14, 6
    v_mul_u32_u24 v142, 256, v1
    s_and_b32 s57, s2, 7
    s_mul_i32 s57, s57, 4352
    s_add_u32 s57, s57, 789504
    s_waitcnt vmcnt(0)
    s_barrier
    s_cmp_lg_u32 s50, 0
    s_cbranch_scc1 L_f_nof
    s_mov_b64 exec, 1
    buffer_store_dword v140, v141, s[32:35], s56 offen sc0 sc1
    s_mov_b64 exec, -1
    s_nop 0
L_f_nof:
    s_mov_b32 s3, 4096
    buffer_load_dwordx4 v[56:59], v4, s[20:23], s3 offen
    s_mov_b32 s3, 4224
    buffer_load_dwordx4 v[60:63], v4, s[20:23], s3 offen
    s_mov_b32 s3, 4352
    buffer_load_dwordx4 v[64:67], v4, s[20:23], s3 offen
    s_mov_b32 s3, 4480
    buffer_load_dwordx4 v[68:71], v4, s[20:23], s3 offen
    buffer_load_dwordx4 v[40:43], v3, s[20:23], 0 offen offset:0
    buffer_load_dwordx4 v[44:47], v3, s[20:23], 0 offen offset:1024
    buffer_load_dwordx4 v[48:51], v3, s[20:23], 0 offen offset:2048
    buffer_load_dwordx4 v[52:55], v3, s[20:23], 0 offen offset:3072
    s_add_u32 s24, s12, 0x1800000
    s_addc_u32 s25, s13, 0
    s_and_b32 s25, s25, 0xffff
    s_mov_b32 s26, 0x400000
    s_mov_b32 s27, 0x00020000
    s_lshl_b32 s55, s51, 11
    v_add_u32 v137, 640, v3
    v_lshrrev_b32 v137, 10, v137
    v_lshl_add_u32 v136, v137, 7, v3
    v_lshrrev_b32 v123, 3, v120
    v_add_u32 v123, v123, v120
    v_lshlrev_b32 v123, 4, v123
    v_mul_u32_u24 v124, 5152, v121
    v_add_u32 v123, v123, v124
    s_mul_i32 s61, s50, 5152
    v_mul_u32_u24 v124, 9, v6
    v_add_u32 v125, v124, v5
    v_lshlrev_b32 v125, 4, v125
    v_add_u32 v125, s61, v125
    v_lshlrev_b32 v7, 3, v6
    v_add_u32 v7, v7, v5
    v_sub_u32 v126, 64, v7
    v_lshrrev_b32 v127, 3, v126
    v_add_u32 v126, v126, v127
    v_lshlrev_b32 v126, 4, v126
    v_add_u32 v126, s61, v126
    v_sub_u32 v127, 256, v7
    v_and_b32 v127, 255, v127
    v_lshrrev_b32 v128, 3, v127
    v_add_u32 v127, v127, v128
    v_lshlrev_b32 v127, 4, v127
    v_add_u32 v127, s61, v127
    v_lshlrev_b32 v129, 3, v1
    v_add_u32 v129, s61, v129
    v_mul_u32_u24 v130, 72, v5
    v_add_u32 v131, v130, v6
    v_lshlrev_b32 v131, 3, v131
    v_add_u32 v131, s61, v131
    v_add_u32 v132, v124, v130
    v_lshlrev_b32 v132, 3, v132
    v_add_u32 v132, s61, v132
    v_lshlrev_b32 v133, 4, v5
    v_add_u32 v133, v133, v129
    v_mul_u32_u24 v134, 80, v1
    v_add_u32 v134, s61, v134
    s_mov_b32 s62, 0
    s_cmp_lg_u32 s50, 0
    s_nop 0
    s_cbranch_scc1 L_f_go
    s_lshr_b32 s3, s2, 3
    s_cmp_lg_u32 s3, 30
    s_cbranch_scc1 L_f_poll
    s_mov_b32 s63, 0
L_f_lead:
    buffer_load_dwordx4 v[144:147], v142, s[32:35], s63 offen sc0 sc1
    s_add_u32 s62, s62, 1
    s_waitcnt vmcnt(0)
    v_and_b32 v144, v144, v145
    v_and_b32 v146, v146, v147
    v_and_b32 v144, v144, v146
    v_cmp_ne_u32 vcc, 1, v144
    s_cmp_eq_u64 vcc, 0
    s_nop 3
    s_cbranch_scc1 L_f_pub
    s_sleep 4
    s_cmp_lt_u32 s62, 0x40000
    s_cbranch_scc1 L_f_lead
    s_branch L_f_go
L_f_pub:
    s_mov_b64 exec, 1
    buffer_store_dword v140, v141, s[32:35], s57 offen sc0 sc1
    s_mov_b64 exec, -1
    s_nop 0
    s_branch L_f_go
L_f_poll:
    buffer_load_dword v143, v141, s[32:35], s57 offen sc1
    s_waitcnt vmcnt(0)
    v_cmp_ne_u32 vcc, 1, v143
    s_cmp_eq_u64 vcc, 0
    s_nop 3
    s_cbranch_scc1 L_f_go
    s_sleep 8
    buffer_load_dword v143, v141, s[32:35], s57 offen sc1
    s_waitcnt vmcnt(0)
    v_cmp_ne_u32 vcc, 1, v143
    s_cmp_eq_u64 vcc, 0
    s_nop 3
    s_cbranch_scc1 L_f_go
    s_sleep 8
    buffer_load_dword v143, v141, s[32:35], s57 offen sc1
    s_waitcnt vmcnt(0)
    v_cmp_ne_u32 vcc, 1, v143
    s_cmp_eq_u64 vcc, 0
    s_nop 3
    s_cbranch_scc1 L_f_go
    s_sleep 8
    buffer_load_dword v143, v141, s[32:35], s57 offen sc0 sc1
    s_waitcnt vmcnt(0)
    v_cmp_ne_u32 vcc, 1, v143
    s_cmp_eq_u64 vcc, 0
    s_nop 3
    s_cbranch_scc1 L_f_go
    s_sleep 8
    s_add_u32 s62, s62, 1
    s_cmp_lt_u32 s62, 0x10000
    s_cbranch_scc1 L_f_poll
L_f_go:
    s_barrier
    s_setprio 1
    buffer_load_dwordx4 v[72:75], v122, s[28:31], s53 offen
    s_add_u32 s53, s53, 1064960
    buffer_load_dwordx4 v[76:79], v122, s[28:31], s53 offen
    s_add_u32 s53, s53, 1064960
    buffer_load_dwordx4 v[80:83], v122, s[28:31], s53 offen
    s_add_u32 s53, s53, 1064960
    buffer_load_dwordx4 v[84:87], v122, s[28:31], s53 offen
    s_waitcnt vmcnt(0)
    ds_write_b128 v123, v[72:75] offset:0
    ds_write_b128 v123, v[76:79] offset:1152
    ds_write_b128 v123, v[80:83] offset:2304
    ds_write_b128 v123, v[84:87] offset:3456
    s_waitcnt lgkmcnt(0)
    s_barrier
    ds_read_b128 v[72:75], v125 offset:0
    ds_read_b128 v[76:79], v125 offset:1152
    ds_read_b128 v[80:83], v125 offset:2304
    ds_read_b128 v[84:87], v125 offset:3456
    ds_read_b128 v[88:91], v127
    ds_read_b128 v[92:95], v126 offset:2304
    ds_read_b128 v[96:99], v126 offset:1152
    ds_read_b128 v[100:103], v126 offset:0
    s_waitcnt lgkmcnt(0)
    v_sub_f32 v8, v72, v75
    v_add_f32 v9, v73, v74
    v_sub_f32 v10, v76, v79
    v_add_f32 v11, v77, v78
    v_sub_f32 v12, v80, v83
    v_add_f32 v13, v81, v82
    v_sub_f32 v14, v84, v87
    v_add_f32 v15, v85, v86
    v_add_f32 v16, v88, v91
    v_sub_f32 v17, v90, v89
    v_add_f32 v18, v92, v95
    v_sub_f32 v19, v94, v93
    v_add_f32 v20, v96, v99
    v_sub_f32 v21, v98, v97
    v_add_f32 v22, v100, v103
    v_sub_f32 v23, v102, v101
    v_cmp_eq_u32 vcc, 0, v1
    s_nop 1
    v_cndmask_b32 v8, v8, v72, vcc
    v_cndmask_b32 v9, v9, v74, vcc
    v_cndmask_b32 v16, v16, v89, vcc
    v_cndmask_b32 v17, v17, v91, vcc
    v_add_f32 v24, v8, v16
    v_add_f32 v25, v9, v17
    v_sub_f32 v32, v8, v16
    v_sub_f32 v33, v9, v17
    v_add_f32 v26, v10, v18
    v_add_f32 v27, v11, v19
    v_sub_f32 v34, v10, v18
    v_sub_f32 v35, v11, v19
    v_add_f32 v28, v12, v20
    v_add_f32 v29, v13, v21
    v_sub_f32 v36, v12, v20
    v_sub_f32 v37, v13, v21
    v_add_f32 v30, v14, v22
    v_add_f32 v31, v15, v23
    v_sub_f32 v38, v14, v22
    v_sub_f32 v39, v15, v23
    v_sub_f32 v8, v34, v35
    v_add_f32 v9, v35, v34
    v_mul_f32 v34, s48, v8
    v_mul_f32 v35, s48, v9
    v_add_f32 v10, v38, v39
    v_sub_f32 v11, v39, v38
    v_mul_f32 v38, -v10, s48
    v_mul_f32 v39, -v11, s48
    v_add_f32 v8, v24, v28
    v_add_f32 v9, v25, v29
    v_sub_f32 v10, v24, v28
    v_sub_f32 v11, v25, v29
    v_add_f32 v12, v26, v30
    v_add_f32 v13, v27, v31
    v_sub_f32 v14, v26, v30
    v_sub_f32 v15, v27, v31
    v_sub_f32 v16, v32, v37
    v_add_f32 v17, v33, v36
    v_add_f32 v18, v32, v37
    v_sub_f32 v19, v33, v36
    v_add_f32 v20, v34, v38
    v_add_f32 v21, v35, v39
    v_sub_f32 v22, v34, v38
    v_sub_f32 v23, v35, v39
    v_add_f32 v24, v8, v12
    v_add_f32 v25, v9, v13
    v_sub_f32 v32, v8, v12
    v_sub_f32 v33, v9, v13
    v_sub_f32 v28, v10, v15
    v_add_f32 v29, v11, v14
    v_add_f32 v36, v10, v15
    v_sub_f32 v37, v11, v14
    v_add_f32 v26, v16, v20
    v_add_f32 v27, v17, v21
    v_sub_f32 v34, v16, v20
    v_sub_f32 v35, v17, v21
    v_sub_f32 v30, v18, v23
    v_add_f32 v31, v19, v22
    v_add_f32 v38, v18, v23
    v_sub_f32 v39, v19, v22
    ds_write_b64 v132, v[24:25] offset:0
    ds_write_b64 v132, v[26:27] offset:8
    ds_write_b64 v132, v[28:29] offset:16
    ds_write_b64 v132, v[30:31] offset:24
    ds_write_b64 v132, v[32:33] offset:32
    ds_write_b64 v132, v[34:35] offset:40
    ds_write_b64 v132, v[36:37] offset:48
    ds_write_b64 v132, v[38:39] offset:56
    ds_read_b64 v[8:9], v131
    ds_read_b64 v[26:27], v131 offset:72
    ds_read_b64 v[28:29], v131 offset:144
    ds_read_b64 v[30:31], v131 offset:216
    ds_read_b64 v[32:33], v131 offset:288
    ds_read_b64 v[34:35], v131 offset:360
    ds_read_b64 v[36:37], v131 offset:432
    ds_read_b64 v[38:39], v131 offset:504
    s_waitcnt lgkmcnt(0)
    v_mul_f32 v10, v26, v58
    v_mul_f32 v11, v27, v58
    v_fmac_f32 v10, v27, v59
    v_fma_f32 v11, -v26, v59, v11
    v_mul_f32 v12, v28, v60
    v_mul_f32 v13, v29, v60
    v_fmac_f32 v12, v29, v61
    v_fma_f32 v13, -v28, v61, v13
    v_mul_f32 v14, v30, v62
    v_mul_f32 v15, v31, v62
    v_fmac_f32 v14, v31, v63
    v_fma_f32 v15, -v30, v63, v15
    v_mul_f32 v16, v32, v64
    v_mul_f32 v17, v33, v64
    v_fmac_f32 v16, v33, v65
    v_fma_f32 v17, -v32, v65, v17
    v_mul_f32 v18, v34, v66
    v_mul_f32 v19, v35, v66
    v_fmac_f32 v18, v35, v67
    v_fma_f32 v19, -v34, v67, v19
    v_mul_f32 v20, v36, v68
    v_mul_f32 v21, v37, v68
    v_fmac_f32 v20, v37, v69
    v_fma_f32 v21, -v36, v69, v21
    v_mul_f32 v22, v38, v70
    v_mul_f32 v23, v39, v70
    v_fmac_f32 v22, v39, v71
    v_fma_f32 v23, -v38, v71, v23
    v_add_f32 v24, v8, v16
    v_add_f32 v25, v9, v17
    v_sub_f32 v32, v8, v16
    v_sub_f32 v33, v9, v17
    v_add_f32 v26, v10, v18
    v_add_f32 v27, v11, v19
    v_sub_f32 v34, v10, v18
    v_sub_f32 v35, v11, v19
    v_add_f32 v28, v12, v20
    v_add_f32 v29, v13, v21
    v_sub_f32 v36, v12, v20
    v_sub_f32 v37, v13, v21
    v_add_f32 v30, v14, v22
    v_add_f32 v31, v15, v23
    v_sub_f32 v38, v14, v22
    v_sub_f32 v39, v15, v23
    v_sub_f32 v8, v34, v35
    v_add_f32 v9, v35, v34
    v_mul_f32 v34, s48, v8
    v_mul_f32 v35, s48, v9
    v_add_f32 v10, v38, v39
    v_sub_f32 v11, v39, v38
    v_mul_f32 v38, -v10, s48
    v_mul_f32 v39, -v11, s48
    v_add_f32 v8, v24, v28
    v_add_f32 v9, v25, v29
    v_sub_f32 v10, v24, v28
    v_sub_f32 v11, v25, v29
    v_add_f32 v12, v26, v30
    v_add_f32 v13, v27, v31
    v_sub_f32 v14, v26, v30
    v_sub_f32 v15, v27, v31
    v_sub_f32 v16, v32, v37
    v_add_f32 v17, v33, v36
    v_add_f32 v18, v32, v37
    v_sub_f32 v19, v33, v36
    v_add_f32 v20, v34, v38
    v_add_f32 v21, v35, v39
    v_sub_f32 v22, v34, v38
    v_sub_f32 v23, v35, v39
    v_add_f32 v24, v8, v12
    v_add_f32 v25, v9, v13
    v_sub_f32 v32, v8, v12
    v_sub_f32 v33, v9, v13
    v_sub_f32 v28, v10, v15
    v_add_f32 v29, v11, v14
    v_add_f32 v36, v10, v15
    v_sub_f32 v37, v11, v14
    v_add_f32 v26, v16, v20
    v_add_f32 v27, v17, v21
    v_sub_f32 v34, v16, v20
    v_sub_f32 v35, v17, v21
    v_sub_f32 v30, v18, v23
    v_add_f32 v31, v19, v22
    v_add_f32 v38, v18, v23
    v_sub_f32 v39, v19, v22
    ds_write_b64 v131, v[24:25] offset:0
    ds_write_b64 v131, v[26:27] offset:64
    ds_write_b64 v131, v[28:29] offset:128
    ds_write_b64 v131, v[30:31] offset:192
    ds_write_b64 v131, v[32:33] offset:256
    ds_write_b64 v131, v[34:35] offset:320
    ds_write_b64 v131, v[36:37] offset:384
    ds_write_b64 v131, v[38:39] offset:448
    ds_read_b64 v[8:9], v129
    ds_read_b64 v[26:27], v129 offset:576
    ds_read_b64 v[28:29], v129 offset:1152
    ds_read_b64 v[30:31], v129 offset:1728
    ds_read_b64 v[32:33], v129 offset:2304
    ds_read_b64 v[34:35], v129 offset:2880
    ds_read_b64 v[36:37], v129 offset:3456
    ds_read_b64 v[38:39], v129 offset:4032
    s_waitcnt lgkmcnt(0)
    v_mul_f32 v10, v26, v42
    v_mul_f32 v11, v27, v42
    v_fmac_f32 v10, v27, v43
    v_fma_f32 v11, -v26, v43, v11
    v_mul_f32 v12, v28, v44
    v_mul_f32 v13, v29, v44
    v_fmac_f32 v12, v29, v45
    v_fma_f32 v13, -v28, v45, v13
    v_mul_f32 v14, v30, v46
    v_mul_f32 v15, v31, v46
    v_fmac_f32 v14, v31, v47
    v_fma_f32 v15, -v30, v47, v15
    v_mul_f32 v16, v32, v48
    v_mul_f32 v17, v33, v48
    v_fmac_f32 v16, v33, v49
    v_fma_f32 v17, -v32, v49, v17
    v_mul_f32 v18, v34, v50
    v_mul_f32 v19, v35, v50
    v_fmac_f32 v18, v35, v51
    v_fma_f32 v19, -v34, v51, v19
    v_mul_f32 v20, v36, v52
    v_mul_f32 v21, v37, v52
    v_fmac_f32 v20, v37, v53
    v_fma_f32 v21, -v36, v53, v21
    v_mul_f32 v22, v38, v54
    v_mul_f32 v23, v39, v54
    v_fmac_f32 v22, v39, v55
    v_fma_f32 v23, -v38, v55, v23
    v_add_f32 v24, v8, v16
    v_add_f32 v25, v9, v17
    v_sub_f32 v32, v8, v16
    v_sub_f32 v33, v9, v17
    v_add_f32 v26, v10, v18
    v_add_f32 v27, v11, v19
    v_sub_f32 v34, v10, v18
    v_sub_f32 v35, v11, v19
    v_add_f32 v28, v12, v20
    v_add_f32 v29, v13, v21
    v_sub_f32 v36, v12, v20
    v_sub_f32 v37, v13, v21
    v_add_f32 v30, v14, v22
    v_add_f32 v31, v15, v23
    v_sub_f32 v38, v14, v22
    v_sub_f32 v39, v15, v23
    v_sub_f32 v8, v34, v35
    v_add_f32 v9, v35, v34
    v_mul_f32 v34, s48, v8
    v_mul_f32 v35, s48, v9
    v_add_f32 v10, v38, v39
    v_sub_f32 v11, v39, v38
    v_mul_f32 v38, -v10, s48
    v_mul_f32 v39, -v11, s48
    v_add_f32 v8, v24, v28
    v_add_f32 v9, v25, v29
    v_sub_f32 v10, v24, v28
    v_sub_f32 v11, v25, v29
    v_add_f32 v12, v26, v30
    v_add_f32 v13, v27, v31
    v_sub_f32 v14, v26, v30
    v_sub_f32 v15, v27, v31
    v_sub_f32 v16, v32, v37
    v_add_f32 v17, v33, v36
    v_add_f32 v18, v32, v37
    v_sub_f32 v19, v33, v36
    v_add_f32 v20, v34, v38
    v_add_f32 v21, v35, v39
    v_sub_f32 v22, v34, v38
    v_sub_f32 v23, v35, v39
    v_add_f32 v24, v8, v12
    v_add_f32 v25, v9, v13
    v_sub_f32 v32, v8, v12
    v_sub_f32 v33, v9, v13
    v_sub_f32 v28, v10, v15
    v_add_f32 v29, v11, v14
    v_add_f32 v36, v10, v15
    v_sub_f32 v37, v11, v14
    v_add_f32 v26, v16, v20
    v_add_f32 v27, v17, v21
    v_sub_f32 v34, v16, v20
    v_sub_f32 v35, v17, v21
    v_sub_f32 v30, v18, v23
    v_add_f32 v31, v19, v22
    v_add_f32 v38, v18, v23
    v_sub_f32 v39, v19, v22
    ds_write_b64 v133, v[24:25] offset:0
    ds_write_b64 v133, v[26:27] offset:640
    ds_write_b64 v133, v[28:29] offset:1280
    ds_write_b64 v133, v[30:31] offset:1920
    ds_write_b64 v133, v[32:33] offset:2560
    ds_write_b64 v133, v[34:35] offset:3200
    ds_write_b64 v133, v[36:37] offset:3840
    ds_write_b64 v133, v[38:39] offset:4480
    ds_read_b128 v[8:11], v134 offset:0
    ds_read_b128 v[12:15], v134 offset:16
    ds_read_b128 v[16:19], v134 offset:32
    ds_read_b128 v[20:23], v134 offset:48
    s_mov_b32 s46, 0x35000000
    s_mov_b32 s47, 0x35000000
    s_and_b32 s56, s14, 7
    s_lshl_b32 s56, s56, 2
    s_lshr_b32 s3, s14, 3
    s_mul_i32 s3, s3, 4352
    s_add_u32 s56, s56, s3
    s_add_u32 s56, s56, 526336
    s_waitcnt lgkmcnt(0)
    v_mul_f32 v8, s46, v8
    v_mul_f32 v9, s46, v9
    v_mul_f32 v10, s46, v10
    v_mul_f32 v11, s46, v11
    v_mul_f32 v12, s46, v12
    v_mul_f32 v13, s46, v13
    v_mul_f32 v14, s46, v14
    v_mul_f32 v15, s46, v15
    v_mul_f32 v16, s46, v16
    v_mul_f32 v17, s46, v17
    v_mul_f32 v18, s46, v18
    v_mul_f32 v19, s46, v19
    v_mul_f32 v20, s46, v20
    v_mul_f32 v21, s46, v21
    v_mul_f32 v22, s46, v22
    v_mul_f32 v23, s46, v23
    v_cvt_pk_bf16_f32 v120, v8, v10
    v_cvt_pk_bf16_f32 v121, v12, v14
    v_cvt_pk_bf16_f32 v122, v16, v18
    v_cvt_pk_bf16_f32 v123, v20, v22
    v_cvt_pk_bf16_f32 v124, v9, v11
    v_cvt_pk_bf16_f32 v125, v13, v15
    v_cvt_pk_bf16_f32 v126, v17, v19
    v_cvt_pk_bf16_f32 v127, v21, v23
    buffer_store_dwordx4 v[120:123], v136, s[24:27], s55 offen sc0 sc1
    buffer_store_dwordx4 v[124:127], v136, s[24:27], s55 offen offset:2048 sc0 sc1
    s_waitcnt vmcnt(0)
    s_barrier
    s_cmp_lg_u32 s50, 0
    s_cbranch_scc1 L_f_nos
    s_mov_b64 exec, 1
    buffer_store_dword v140, v141, s[32:35], s56 offen sc0 sc1
    s_mov_b64 exec, -1
    s_nop 0
L_f_nos:
    s_endpgm
L_k2_special:
    ds_write_b64 v176, v[24:25] offset:0
    ds_write_b64 v176, v[28:29] offset:5184
    ds_write_b64 v176, v[32:33] offset:10368
    ds_write_b64 v176, v[36:37] offset:15552
    ds_write_b64 v176, v[26:27] offset:576
    ds_write_b64 v176, v[30:31] offset:5760
    ds_write_b64 v176, v[34:35] offset:10944
    ds_write_b64 v176, v[38:39] offset:16128
    ds_write_b64 v179, v[24:25]
    v_mul_f32 v8, v128, v24
    v_mul_f32 v9, v128, v25
    v_mul_f32 v12, v132, v28
    v_mul_f32 v13, v132, v29
    v_mul_f32 v16, v136, v32
    v_mul_f32 v17, v136, v33
    v_mul_f32 v20, v140, v36
    v_mul_f32 v21, v140, v37
    v_mul_f32 v10, v144, v26
    v_mul_f32 v11, v144, v27
    v_mul_f32 v14, v148, v30
    v_mul_f32 v15, v148, v31
    v_mul_f32 v18, v152, v34
    v_mul_f32 v19, v152, v35
    v_mul_f32 v22, v156, v38
    v_mul_f32 v23, v156, v39
    s_waitcnt lgkmcnt(0)
    s_barrier
    ds_read_b64 v[160:161], v177 offset:16128
    ds_read_b64 v[162:163], v177 offset:10944
    ds_read_b64 v[164:165], v177 offset:5760
    ds_read_b64 v[166:167], v177 offset:576
    ds_read_b64 v[168:169], v178 offset:15552
    ds_read_b64 v[170:171], v178 offset:10368
    ds_read_b64 v[172:173], v178 offset:5184
    ds_read_b64 v[174:175], v178 offset:0
    v_fma_f32 v8, -v129, v25, v8
    v_fma_f32 v9, v129, v24, v9
    v_fma_f32 v12, -v133, v29, v12
    v_fma_f32 v13, v133, v28, v13
    v_fma_f32 v16, -v137, v33, v16
    v_fma_f32 v17, v137, v32, v17
    v_fma_f32 v20, -v141, v37, v20
    v_fma_f32 v21, v141, v36, v21
    v_fma_f32 v10, -v145, v27, v10
    v_fma_f32 v11, v145, v26, v11
    v_fma_f32 v14, -v149, v31, v14
    v_fma_f32 v15, v149, v30, v15
    v_fma_f32 v18, -v153, v35, v18
    v_fma_f32 v19, v153, v34, v19
    v_fma_f32 v22, -v157, v39, v22
    v_fma_f32 v23, v157, v38, v23
    s_waitcnt lgkmcnt(0)
    v_fma_f32 v8, v130, v160, v8
    v_fma_f32 v9, v131, v160, v9
    v_fma_f32 v12, v134, v162, v12
    v_fma_f32 v13, v135, v162, v13
    v_fma_f32 v16, v138, v164, v16
    v_fma_f32 v17, v139, v164, v17
    v_fma_f32 v20, v142, v166, v20
    v_fma_f32 v21, v143, v166, v21
    v_fma_f32 v10, v146, v168, v10
    v_fma_f32 v11, v147, v168, v11
    v_fma_f32 v14, v150, v170, v14
    v_fma_f32 v15, v151, v170, v15
    v_fma_f32 v18, v154, v172, v18
    v_fma_f32 v19, v155, v172, v19
    v_fma_f32 v22, v158, v174, v22
    v_fma_f32 v23, v159, v174, v23
    v_fma_f32 v8, v131, v161, v8
    v_fma_f32 v9, -v130, v161, v9
    v_fma_f32 v12, v135, v163, v12
    v_fma_f32 v13, -v134, v163, v13
    v_fma_f32 v16, v139, v165, v16
    v_fma_f32 v17, -v138, v165, v17
    v_fma_f32 v20, v143, v167, v20
    v_fma_f32 v21, -v142, v167, v21
    v_fma_f32 v10, v147, v169, v10
    v_fma_f32 v11, -v146, v169, v11
    v_fma_f32 v14, v151, v171, v14
    v_fma_f32 v15, -v150, v171, v15
    v_fma_f32 v18, v155, v173, v18
    v_fma_f32 v19, -v154, v173, v19
    v_fma_f32 v22, v159, v175, v22
    v_fma_f32 v23, -v158, v175, v23
    s_nop 2
    s_branch L_k2_back
L_k2_spend:
L_k1_exit:
    s_endpgm
.p2align 8
.type TWTAB,@object
TWTAB:
.long 0x3f800000, 0x80000000, 0x3f800000, 0x80000000
.long 0x3f800000, 0x80000000, 0x3f7ffb11, 0xbc490e90
.long 0x3f800000, 0x80000000, 0x3f7fec43, 0xbcc90ab0
.long 0x3f800000, 0x80000000, 0x3f7fd397, 0xbd16c32c
.long 0x3f800000, 0x80000000, 0x3f7fb10f, 0xbd48fb30
.long 0x3f800000, 0x80000000, 0x3f7f84ab, 0xbd7b2b74
.long 0x3f800000, 0x80000000, 0x3f7f4e6d, 0xbd96a905
.long 0x3f800000, 0x80000000, 0x3f7f0e58, 0xbdafb680
.long 0x3f800000, 0x80000000, 0x3f7ec46d, 0xbdc8bd36
.long 0x3f800000, 0x80000000, 0x3f7e70b0, 0xbde1bc2e
.long 0x3f800000, 0x80000000, 0x3f7e1324, 0xbdfab273
.long 0x3f800000, 0x80000000, 0x3f7dabcc, 0xbe09cf86
.long 0x3f800000, 0x80000000, 0x3f7d3aac, 0xbe164083
.long 0x3f800000, 0x80000000, 0x3f7cbfc9, 0xbe22abb6
.long 0x3f800000, 0x80000000, 0x3f7c3b28, 0xbe2f10a2
.long 0x3f800000, 0x80000000, 0x3f7baccd, 0xbe3b6ecf
.long 0x3f800000, 0x80000000, 0x3f7b14be, 0xbe47c5c2
.long 0x3f800000, 0x80000000, 0x3f7a7302, 0xbe541501
.long 0x3f800000, 0x80000000, 0x3f79c79d, 0xbe605c13
.long 0x3f800000, 0x80000000, 0x3f791298, 0xbe6c9a7f
.long 0x3f800000, 0x80000000, 0x3f7853f8, 0xbe78cfcc
.long 0x3f800000, 0x80000000, 0x3f778bc5, 0xbe827dc0
.long 0x3f800000, 0x80000000, 0x3f76ba07, 0xbe888e93
.long 0x3f800000, 0x80000000, 0x3f75dec6, 0xbe8e9a22
.long 0x3f800000, 0x80000000, 0x3f74fa0b, 0xbe94a031
.long 0x3f800000, 0x80000000, 0x3f740bdd, 0xbe9aa086
.long 0x3f800000, 0x80000000, 0x3f731447, 0xbea09ae5
.long 0x3f800000, 0x80000000, 0x3f721352, 0xbea68f12
.long 0x3f800000, 0x80000000, 0x3f710908, 0xbeac7cd4
.long 0x3f800000, 0x80000000, 0x3f6ff573, 0xbeb263ef
.long 0x3f800000, 0x80000000, 0x3f6ed89e, 0xbeb8442a
.long 0x3f800000, 0x80000000, 0x3f6db293, 0xbebe1d4a
.long 0x3f800000, 0x80000000, 0x3f6c835e, 0xbec3ef15
.long 0x3f800000, 0x80000000, 0x3f6b4b0c, 0xbec9b953
.long 0x3f800000, 0x80000000, 0x3f6a09a7, 0xbecf7bca
.long 0x3f800000, 0x80000000, 0x3f68bf3c, 0xbed53641
.long 0x3f800000, 0x80000000, 0x3f676bd8, 0xbedae880
.long 0x3f800000, 0x80000000, 0x3f660f88, 0xbee0924f
.long 0x3f800000, 0x80000000, 0x3f64aa59, 0xbee63375
.long 0x3f800000, 0x80000000, 0x3f633c5a, 0xbeebcbbb
.long 0x3f800000, 0x80000000, 0x3f61c598, 0xbef15aea
.long 0x3f800000, 0x80000000, 0x3f604621, 0xbef6e0cb
.long 0x3f800000, 0x80000000, 0x3f5ebe05, 0xbefc5d27
.long 0x3f800000, 0x80000000, 0x3f5d2d53, 0xbf00e7e4
.long 0x3f800000, 0x80000000, 0x3f5b941a, 0xbf039c3d
.long 0x3f800000, 0x80000000, 0x3f59f26a, 0xbf064b82
.long 0x3f800000, 0x80000000, 0x3f584853, 0xbf08f59b
.long 0x3f800000, 0x80000000, 0x3f5695e5, 0xbf0b9a6b
.long 0x3f800000, 0x80000000, 0x3f54db31, 0xbf0e39da
.long 0x3f800000, 0x80000000, 0x3f531849, 0xbf10d3cd
.long 0x3f800000, 0x80000000, 0x3f514d3d, 0xbf13682a
.long 0x3f800000, 0x80000000, 0x3f4f7a1f, 0xbf15f6d9
.long 0x3f800000, 0x80000000, 0x3f4d9f02, 0xbf187fc0
.long 0x3f800000, 0x80000000, 0x3f4bbbf8, 0xbf1b02c6
.long 0x3f800000, 0x80000000, 0x3f49d112, 0xbf1d7fd1
.long 0x3f800000, 0x80000000, 0x3f47de65, 0xbf1ff6cb
.long 0x3f800000, 0x80000000, 0x3f45e403, 0xbf226799
.long 0x3f800000, 0x80000000, 0x3f43e200, 0xbf24d225
.long 0x3f800000, 0x80000000, 0x3f41d870, 0xbf273656
.long 0x3f800000, 0x80000000, 0x3f3fc767, 0xbf299415
.long 0x3f800000, 0x80000000, 0x3f3daef9, 0xbf2beb4a
.long 0x3f800000, 0x80000000, 0x3f3b8f3b, 0xbf2e3bde
.long 0x3f800000, 0x80000000, 0x3f396842, 0xbf3085bb
.long 0x3f800000, 0x80000000, 0x3f373a23, 0xbf32c8c9
.long 0x3f800000, 0x80000000, 0x3f800000, 0x80000000
.long 0x3f7fec43, 0xbcc90ab0, 0x3f7fd397, 0xbd16c32c
.long 0x3f7fb10f, 0xbd48fb30, 0x3f7f4e6d, 0xbd96a905
.long 0x3f7f4e6d, 0xbd96a905, 0x3f7e70b0, 0xbde1bc2e
.long 0x3f7ec46d, 0xbdc8bd36, 0x3f7d3aac, 0xbe164083
.long 0x3f7e1324, 0xbdfab273, 0x3f7baccd, 0xbe3b6ecf
.long 0x3f7d3aac, 0xbe164083, 0x3f79c79d, 0xbe605c13
.long 0x3f7c3b28, 0xbe2f10a2, 0x3f778bc5, 0xbe827dc0
.long 0x3f7b14be, 0xbe47c5c2, 0x3f74fa0b, 0xbe94a031
.long 0x3f79c79d, 0xbe605c13, 0x3f721352, 0xbea68f12
.long 0x3f7853f8, 0xbe78cfcc, 0x3f6ed89e, 0xbeb8442a
.long 0x3f76ba07, 0xbe888e93, 0x3f6b4b0c, 0xbec9b953
.long 0x3f74fa0b, 0xbe94a031, 0x3f676bd8, 0xbedae880
.long 0x3f731447, 0xbea09ae5, 0x3f633c5a, 0xbeebcbbb
.long 0x3f710908, 0xbeac7cd4, 0x3f5ebe05, 0xbefc5d27
.long 0x3f6ed89e, 0xbeb8442a, 0x3f59f26a, 0xbf064b82
.long 0x3f6c835e, 0xbec3ef15, 0x3f54db31, 0xbf0e39da
.long 0x3f6a09a7, 0xbecf7bca, 0x3f4f7a1f, 0xbf15f6d9
.long 0x3f676bd8, 0xbedae880, 0x3f49d112, 0xbf1d7fd1
.long 0x3f64aa59, 0xbee63375, 0x3f43e200, 0xbf24d225
.long 0x3f61c598, 0xbef15aea, 0x3f3daef9, 0xbf2beb4a
.long 0x3f5ebe05, 0xbefc5d27, 0x3f373a23, 0xbf32c8c9
.long 0x3f5b941a, 0xbf039c3d, 0x3f3085bb, 0xbf396842
.long 0x3f584853, 0xbf08f59b, 0x3f299415, 0xbf3fc767
.long 0x3f54db31, 0xbf0e39da, 0x3f226799, 0xbf45e403
.long 0x3f514d3d, 0xbf13682a, 0x3f1b02c6, 0xbf4bbbf8
.long 0x3f4d9f02, 0xbf187fc0, 0x3f13682a, 0xbf514d3d
.long 0x3f49d112, 0xbf1d7fd1, 0x3f0b9a6b, 0xbf5695e5
.long 0x3f45e403, 0xbf226799, 0x3f039c3d, 0xbf5b941a
.long 0x3f41d870, 0xbf273656, 0x3ef6e0cb, 0xbf604621
.long 0x3f3daef9, 0xbf2beb4a, 0x3ee63375, 0xbf64aa59
.long 0x3f396842, 0xbf3085bb, 0x3ed53641, 0xbf68bf3c
.long 0x3f3504f3, 0xbf3504f3, 0x3ec3ef15, 0xbf6c835e
.long 0x3f3085bb, 0xbf396842, 0x3eb263ef, 0xbf6ff573
.long 0x3f2beb4a, 0xbf3daef9, 0x3ea09ae5, 0xbf731447
.long 0x3f273656, 0xbf41d870, 0x3e8e9a22, 0xbf75dec6
.long 0x3f226799, 0xbf45e403, 0x3e78cfcc, 0xbf7853f8
.long 0x3f1d7fd1, 0xbf49d112, 0x3e541501, 0xbf7a7302
.long 0x3f187fc0, 0xbf4d9f02, 0x3e2f10a2, 0xbf7c3b28
.long 0x3f13682a, 0xbf514d3d, 0x3e09cf86, 0xbf7dabcc
.long 0x3f0e39da, 0xbf54db31, 0x3dc8bd36, 0xbf7ec46d
.long 0x3f08f59b, 0xbf584853, 0x3d7b2b74, 0xbf7f84ab
.long 0x3f039c3d, 0xbf5b941a, 0x3cc90ab0, 0xbf7fec43
.long 0x3efc5d27, 0xbf5ebe05, 0xbc490e90, 0xbf7ffb11
.long 0x3ef15aea, 0xbf61c598, 0xbd48fb30, 0xbf7fb10f
.long 0x3ee63375, 0xbf64aa59, 0xbdafb680, 0xbf7f0e58
.long 0x3edae880, 0xbf676bd8, 0xbdfab273, 0xbf7e1324
.long 0x3ecf7bca, 0xbf6a09a7, 0xbe22abb6, 0xbf7cbfc9
.long 0x3ec3ef15, 0xbf6c835e, 0xbe47c5c2, 0xbf7b14be
.long 0x3eb8442a, 0xbf6ed89e, 0xbe6c9a7f, 0xbf791298
.long 0x3eac7cd4, 0xbf710908, 0xbe888e93, 0xbf76ba07
.long 0x3ea09ae5, 0xbf731447, 0xbe9aa086, 0xbf740bdd
.long 0x3e94a031, 0xbf74fa0b, 0xbeac7cd4, 0xbf710908
.long 0x3e888e93, 0xbf76ba07, 0xbebe1d4a, 0xbf6db293
.long 0x3e78cfcc, 0xbf7853f8, 0xbecf7bca, 0xbf6a09a7
.long 0x3e605c13, 0xbf79c79d, 0xbee0924f, 0xbf660f88
.long 0x3e47c5c2, 0xbf7b14be, 0xbef15aea, 0xbf61c598
.long 0x3e2f10a2, 0xbf7c3b28, 0xbf00e7e4, 0xbf5d2d53
.long 0x3e164083, 0xbf7d3aac, 0xbf08f59b, 0xbf584853
.long 0x3dfab273, 0xbf7e1324, 0xbf10d3cd, 0xbf531849
.long 0x3dc8bd36, 0xbf7ec46d, 0xbf187fc0, 0xbf4d9f02
.long 0x3d96a905, 0xbf7f4e6d, 0xbf1ff6cb, 0xbf47de65
.long 0x3d48fb30, 0xbf7fb10f, 0xbf273656, 0xbf41d870
.long 0x3cc90ab0, 0xbf7fec43, 0xbf2e3bde, 0xbf3b8f3b
.long 0x3f800000, 0x80000000, 0x3f800000, 0x80000000
.long 0x3f7fb10f, 0xbd48fb30, 0x3f7f84ab, 0xbd7b2b74
.long 0x3f7ec46d, 0xbdc8bd36, 0x3f7e1324, 0xbdfab273
.long 0x3f7d3aac, 0xbe164083, 0x3f7baccd, 0xbe3b6ecf
.long 0x3f7b14be, 0xbe47c5c2, 0x3f7853f8, 0xbe78cfcc
.long 0x3f7853f8, 0xbe78cfcc, 0x3f740bdd, 0xbe9aa086
.long 0x3f74fa0b, 0xbe94a031, 0x3f6ed89e, 0xbeb8442a
.long 0x3f710908, 0xbeac7cd4, 0x3f68bf3c, 0xbed53641
.long 0x3f6c835e, 0xbec3ef15, 0x3f61c598, 0xbef15aea
.long 0x3f676bd8, 0xbedae880, 0x3f59f26a, 0xbf064b82
.long 0x3f61c598, 0xbef15aea, 0x3f514d3d, 0xbf13682a
.long 0x3f5b941a, 0xbf039c3d, 0x3f47de65, 0xbf1ff6cb
.long 0x3f54db31, 0xbf0e39da, 0x3f3daef9, 0xbf2beb4a
.long 0x3f4d9f02, 0xbf187fc0, 0x3f32c8c9, 0xbf373a23
.long 0x3f45e403, 0xbf226799, 0x3f273656, 0xbf41d870
.long 0x3f3daef9, 0xbf2beb4a, 0x3f1b02c6, 0xbf4bbbf8
.long 0x3f3504f3, 0xbf3504f3, 0x3f0e39da, 0xbf54db31
.long 0x3f2beb4a, 0xbf3daef9, 0x3f00e7e4, 0xbf5d2d53
.long 0x3f226799, 0xbf45e403, 0x3ee63375, 0xbf64aa59
.long 0x3f187fc0, 0xbf4d9f02, 0x3ec9b953, 0xbf6b4b0c
.long 0x3f0e39da, 0xbf54db31, 0x3eac7cd4, 0xbf710908
.long 0x3f039c3d, 0xbf5b941a, 0x3e8e9a22, 0xbf75dec6
.long 0x3ef15aea, 0xbf61c598, 0x3e605c13, 0xbf79c79d
.long 0x3edae880, 0xbf676bd8, 0x3e22abb6, 0xbf7cbfc9
.long 0x3ec3ef15, 0xbf6c835e, 0x3dc8bd36, 0xbf7ec46d
.long 0x3eac7cd4, 0xbf710908, 0x3d16c32c, 0xbf7fd397
.long 0x3e94a031, 0xbf74fa0b, 0xbcc90ab0, 0xbf7fec43
.long 0x3e78cfcc, 0xbf7853f8, 0xbdafb680, 0xbf7f0e58
.long 0x3e47c5c2, 0xbf7b14be, 0xbe164083, 0xbf7d3aac
.long 0x3e164083, 0xbf7d3aac, 0xbe541501, 0xbf7a7302
.long 0x3dc8bd36, 0xbf7ec46d, 0xbe888e93, 0xbf76ba07
.long 0x3d48fb30, 0xbf7fb10f, 0xbea68f12, 0xbf721352
.long 0x248d3132, 0xbf800000, 0xbec3ef15, 0xbf6c835e
.long 0xbd48fb30, 0xbf7fb10f, 0xbee0924f, 0xbf660f88
.long 0xbdc8bd36, 0xbf7ec46d, 0xbefc5d27, 0xbf5ebe05
.long 0xbe164083, 0xbf7d3aac, 0xbf0b9a6b, 0xbf5695e5
.long 0xbe47c5c2, 0xbf7b14be, 0xbf187fc0, 0xbf4d9f02
.long 0xbe78cfcc, 0xbf7853f8, 0xbf24d225, 0xbf43e200
.long 0xbe94a031, 0xbf74fa0b, 0xbf3085bb, 0xbf396842
.long 0xbeac7cd4, 0xbf710908, 0xbf3b8f3b, 0xbf2e3bde
.long 0xbec3ef15, 0xbf6c835e, 0xbf45e403, 0xbf226799
.long 0xbedae880, 0xbf676bd8, 0xbf4f7a1f, 0xbf15f6d9
.long 0xbef15aea, 0xbf61c598, 0xbf584853, 0xbf08f59b
.long 0xbf039c3d, 0xbf5b941a, 0xbf604621, 0xbef6e0cb
.long 0xbf0e39da, 0xbf54db31, 0xbf676bd8, 0xbedae880
.long 0xbf187fc0, 0xbf4d9f02, 0xbf6db293, 0xbebe1d4a
.long 0xbf226799, 0xbf45e403, 0xbf731447, 0xbea09ae5
.long 0xbf2beb4a, 0xbf3daef9, 0xbf778bc5, 0xbe827dc0
.long 0xbf3504f3, 0xbf3504f3, 0xbf7b14be, 0xbe47c5c2
.long 0xbf3daef9, 0xbf2beb4a, 0xbf7dabcc, 0xbe09cf86
.long 0xbf45e403, 0xbf226799, 0xbf7f4e6d, 0xbd96a905
.long 0xbf4d9f02, 0xbf187fc0, 0xbf7ffb11, 0xbc490e90
.long 0xbf54db31, 0xbf0e39da, 0xbf7fb10f, 0x3d48fb30
.long 0xbf5b941a, 0xbf039c3d, 0xbf7e70b0, 0x3de1bc2e
.long 0xbf61c598, 0xbef15aea, 0xbf7c3b28, 0x3e2f10a2
.long 0xbf676bd8, 0xbedae880, 0xbf791298, 0x3e6c9a7f
.long 0xbf6c835e, 0xbec3ef15, 0xbf74fa0b, 0x3e94a031
.long 0xbf710908, 0xbeac7cd4, 0xbf6ff573, 0x3eb263ef
.long 0xbf74fa0b, 0xbe94a031, 0xbf6a09a7, 0x3ecf7bca
.long 0xbf7853f8, 0xbe78cfcc, 0xbf633c5a, 0x3eebcbbb
.long 0xbf7b14be, 0xbe47c5c2, 0xbf5b941a, 0x3f039c3d
.long 0xbf7d3aac, 0xbe164083, 0xbf531849, 0x3f10d3cd
.long 0xbf7ec46d, 0xbdc8bd36, 0xbf49d112, 0x3f1d7fd1
.long 0xbf7fb10f, 0xbd48fb30, 0xbf3fc767, 0x3f299415
.long 0x3f800000, 0x80000000, 0x3f800000, 0x80000000
.long 0x3f7f4e6d, 0xbd96a905, 0x3f7f0e58, 0xbdafb680
.long 0x3f7d3aac, 0xbe164083, 0x3f7c3b28, 0xbe2f10a2
.long 0x3f79c79d, 0xbe605c13, 0x3f778bc5, 0xbe827dc0
.long 0x3f74fa0b, 0xbe94a031, 0x3f710908, 0xbeac7cd4
.long 0x3f6ed89e, 0xbeb8442a, 0x3f68bf3c, 0xbed53641
.long 0x3f676bd8, 0xbedae880, 0x3f5ebe05, 0xbefc5d27
.long 0x3f5ebe05, 0xbefc5d27, 0x3f531849, 0xbf10d3cd
.long 0x3f54db31, 0xbf0e39da, 0x3f45e403, 0xbf226799
.long 0x3f49d112, 0xbf1d7fd1, 0x3f373a23, 0xbf32c8c9
.long 0x3f3daef9, 0xbf2beb4a, 0x3f273656, 0xbf41d870
.long 0x3f3085bb, 0xbf396842, 0x3f15f6d9, 0xbf4f7a1f
.long 0x3f226799, 0xbf45e403, 0x3f039c3d, 0xbf5b941a
.long 0x3f13682a, 0xbf514d3d, 0x3ee0924f, 0xbf660f88
.long 0x3f039c3d, 0xbf5b941a, 0x3eb8442a, 0xbf6ed89e
.long 0x3ee63375, 0xbf64aa59, 0x3e8e9a22, 0xbf75dec6
.long 0x3ec3ef15, 0xbf6c835e, 0x3e47c5c2, 0xbf7b14be
.long 0x3ea09ae5, 0xbf731447, 0x3de1bc2e, 0xbf7e70b0
.long 0x3e78cfcc, 0xbf7853f8, 0x3cc90ab0, 0xbf7fec43
.long 0x3e2f10a2, 0xbf7c3b28, 0xbd7b2b74, 0xbf7f84ab
.long 0x3dc8bd36, 0xbf7ec46d, 0xbe164083, 0xbf7d3aac
.long 0x3cc90ab0, 0xbf7fec43, 0xbe6c9a7f, 0xbf791298
.long 0xbd48fb30, 0xbf7fb10f, 0xbea09ae5, 0xbf731447
.long 0xbdfab273, 0xbf7e1324, 0xbec9b953, 0xbf6b4b0c
.long 0xbe47c5c2, 0xbf7b14be, 0xbef15aea, 0xbf61c598
.long 0xbe888e93, 0xbf76ba07, 0xbf0b9a6b, 0xbf5695e5
.long 0xbeac7cd4, 0xbf710908, 0xbf1d7fd1, 0xbf49d112
.long 0xbecf7bca, 0xbf6a09a7, 0xbf2e3bde, 0xbf3b8f3b
.long 0xbef15aea, 0xbf61c598, 0xbf3daef9, 0xbf2beb4a
.long 0xbf08f59b, 0xbf584853, 0xbf4bbbf8, 0xbf1b02c6
.long 0xbf187fc0, 0xbf4d9f02, 0xbf584853, 0xbf08f59b
.long 0xbf273656, 0xbf41d870, 0xbf633c5a, 0xbeebcbbb
.long 0xbf3504f3, 0xbf3504f3, 0xbf6c835e, 0xbec3ef15
.long 0xbf41d870, 0xbf273656, 0xbf740bdd, 0xbe9aa086
.long 0xbf4d9f02, 0xbf187fc0, 0xbf79c79d, 0xbe605c13
.long 0xbf584853, 0xbf08f59b, 0xbf7dabcc, 0xbe09cf86
.long 0xbf61c598, 0xbef15aea, 0xbf7fb10f, 0xbd48fb30
.long 0xbf6a09a7, 0xbecf7bca, 0xbf7fd397, 0x3d16c32c
.long 0xbf710908, 0xbeac7cd4, 0xbf7e1324, 0x3dfab273
.long 0xbf76ba07, 0xbe888e93, 0xbf7a7302, 0x3e541501
.long 0xbf7b14be, 0xbe47c5c2, 0xbf74fa0b, 0x3e94a031
.long 0xbf7e1324, 0xbdfab273, 0xbf6db293, 0x3ebe1d4a
.long 0xbf7fb10f, 0xbd48fb30, 0xbf64aa59, 0x3ee63375
.long 0xbf7fec43, 0x3cc90ab0, 0xbf59f26a, 0x3f064b82
.long 0xbf7ec46d, 0x3dc8bd36, 0xbf4d9f02, 0x3f187fc0
.long 0xbf7c3b28, 0x3e2f10a2, 0xbf3fc767, 0x3f299415
.long 0xbf7853f8, 0x3e78cfcc, 0xbf3085bb, 0x3f396842
.long 0xbf731447, 0x3ea09ae5, 0xbf1ff6cb, 0x3f47de65
.long 0xbf6c835e, 0x3ec3ef15, 0xbf0e39da, 0x3f54db31
.long 0xbf64aa59, 0x3ee63375, 0xbef6e0cb, 0x3f604621
.long 0xbf5b941a, 0x3f039c3d, 0xbecf7bca, 0x3f6a09a7
.long 0xbf514d3d, 0x3f13682a, 0xbea68f12, 0x3f721352
.long 0xbf45e403, 0x3f226799, 0xbe78cfcc, 0x3f7853f8
.long 0xbf396842, 0x3f3085bb, 0xbe22abb6, 0x3f7cbfc9
.long 0xbf2beb4a, 0x3f3daef9, 0xbd96a905, 0x3f7f4e6d
.long 0xbf1d7fd1, 0x3f49d112, 0x3c490e90, 0x3f7ffb11
.long 0xbf0e39da, 0x3f54db31, 0x3dc8bd36, 0x3f7ec46d
.long 0xbefc5d27, 0x3f5ebe05, 0x3e3b6ecf, 0x3f7baccd
.long 0xbedae880, 0x3f676bd8, 0x3e888e93, 0x3f76ba07
.long 0xbeb8442a, 0x3f6ed89e, 0x3eb263ef, 0x3f6ff573
.long 0xbe94a031, 0x3f74fa0b, 0x3edae880, 0x3f676bd8
.long 0xbe605c13, 0x3f79c79d, 0x3f00e7e4, 0x3f5d2d53
.long 0xbe164083, 0x3f7d3aac, 0x3f13682a, 0x3f514d3d
.long 0xbd96a905, 0x3f7f4e6d, 0x3f24d225, 0x3f43e200
.long 0x3f800000, 0x80000000, 0x3f800000, 0x80000000
.long 0x3f800000, 0x80000000, 0x3f7ec46d, 0xbdc8bd36
.long 0x3f800000, 0x80000000, 0x3f7b14be, 0xbe47c5c2
.long 0x3f800000, 0x80000000, 0x3f74fa0b, 0xbe94a031
.long 0x3f800000, 0x80000000, 0x3f6c835e, 0xbec3ef15
.long 0x3f800000, 0x80000000, 0x3f61c598, 0xbef15aea
.long 0x3f800000, 0x80000000, 0x3f54db31, 0xbf0e39da
.long 0x3f800000, 0x80000000, 0x3f45e403, 0xbf226799
.long 0x3f800000, 0x80000000, 0x3f800000, 0x80000000
.long 0x3f7b14be, 0xbe47c5c2, 0x3f74fa0b, 0xbe94a031
.long 0x3f6c835e, 0xbec3ef15, 0x3f54db31, 0xbf0e39da
.long 0x3f54db31, 0xbf0e39da, 0x3f226799, 0xbf45e403
.long 0x3f3504f3, 0xbf3504f3, 0x3ec3ef15, 0xbf6c835e
.long 0x3f0e39da, 0xbf54db31, 0x3dc8bd36, 0xbf7ec46d
.long 0x3ec3ef15, 0xbf6c835e, 0xbe47c5c2, 0xbf7b14be
.long 0x3e47c5c2, 0xbf7b14be, 0xbef15aea, 0xbf61c598
.long 0x3f800000, 0x80000000, 0x3f800000, 0x80000000
.long 0x3f6c835e, 0xbec3ef15, 0x3f61c598, 0xbef15aea
.long 0x3f3504f3, 0xbf3504f3, 0x3f0e39da, 0xbf54db31
.long 0x3ec3ef15, 0xbf6c835e, 0x3dc8bd36, 0xbf7ec46d
.long 0x248d3132, 0xbf800000, 0xbec3ef15, 0xbf6c835e
.long 0xbec3ef15, 0xbf6c835e, 0xbf45e403, 0xbf226799
.long 0xbf3504f3, 0xbf3504f3, 0xbf7b14be, 0xbe47c5c2
.long 0xbf6c835e, 0xbec3ef15, 0xbf74fa0b, 0x3e94a031
.long 0x3f800000, 0x80000000, 0x3f800000, 0x80000000
.long 0x3f54db31, 0xbf0e39da, 0x3f45e403, 0xbf226799
.long 0x3ec3ef15, 0xbf6c835e, 0x3e47c5c2, 0xbf7b14be
.long 0xbe47c5c2, 0xbf7b14be, 0xbef15aea, 0xbf61c598
.long 0xbf3504f3, 0xbf3504f3, 0xbf6c835e, 0xbec3ef15
.long 0xbf7b14be, 0xbe47c5c2, 0xbf74fa0b, 0x3e94a031
.long 0xbf6c835e, 0x3ec3ef15, 0xbf0e39da, 0x3f54db31
.long 0xbf0e39da, 0x3f54db31, 0x3dc8bd36, 0x3f7ec46d
.long 0x3f800000, 0x80000000, 0x3f800000, 0x80000000
.long 0x3f800000, 0x80000000, 0x3f7fffb1, 0xbb490fc6
.long 0x3f800000, 0x80000000, 0x3f7ffec4, 0xbbc90f88
.long 0x3f800000, 0x80000000, 0x3f7ffd39, 0xbc16cb58
.long 0x3f800000, 0x80000000, 0x3f7ffb11, 0xbc490e90
.long 0x3f800000, 0x80000000, 0x3f7ff84a, 0xbc7b514b
.long 0x3f800000, 0x80000000, 0x3f7ff4e6, 0xbc96c9b6
.long 0x3f800000, 0x80000000, 0x3f7ff0e3, 0xbcafea69
.long 0x3f800000, 0x80000000, 0x3f7fec43, 0xbcc90ab0
.long 0x3f800000, 0x80000000, 0x3f7fe705, 0xbce22a7a
.long 0x3f800000, 0x80000000, 0x3f7fe129, 0xbcfb49ba
.long 0x3f800000, 0x80000000, 0x3f7fdaaf, 0xbd0a342f
.long 0x3f800000, 0x80000000, 0x3f7fd397, 0xbd16c32c
.long 0x3f800000, 0x80000000, 0x3f7fcbe2, 0xbd2351cb
.long 0x3f800000, 0x80000000, 0x3f7fc38f, 0xbd2fe007
.long 0x3f800000, 0x80000000, 0x3f7fba9e, 0xbd3c6dd5
.long 0x3f800000, 0x80000000, 0x3f7fb10f, 0xbd48fb30
.long 0x3f800000, 0x80000000, 0x3f7fa6e3, 0xbd55880e
.long 0x3f800000, 0x80000000, 0x3f7f9c18, 0xbd621469
.long 0x3f800000, 0x80000000, 0x3f7f90b1, 0xbd6ea038
.long 0x3f800000, 0x80000000, 0x3f7f84ab, 0xbd7b2b74
.long 0x3f800000, 0x80000000, 0x3f7f7808, 0xbd83db0a
.long 0x3f800000, 0x80000000, 0x3f7f6ac7, 0xbd8a200a
.long 0x3f800000, 0x80000000, 0x3f7f5ce9, 0xbd9064b4
.long 0x3f800000, 0x80000000, 0x3f7f4e6d, 0xbd96a905
.long 0x3f800000, 0x80000000, 0x3f7f3f54, 0xbd9cecf9
.long 0x3f800000, 0x80000000, 0x3f7f2f9d, 0xbda3308c
.long 0x3f800000, 0x80000000, 0x3f7f1f49, 0xbda973ba
.long 0x3f800000, 0x80000000, 0x3f7f0e58, 0xbdafb680
.long 0x3f800000, 0x80000000, 0x3f7efcc9, 0xbdb5f8da
.long 0x3f800000, 0x80000000, 0x3f7eea9d, 0xbdbc3ac3
.long 0x3f800000, 0x80000000, 0x3f7ed7d4, 0xbdc27c39
.long 0x3f800000, 0x80000000, 0x3f7ec46d, 0xbdc8bd36
.long 0x3f800000, 0x80000000, 0x3f7eb069, 0xbdcefdb7
.long 0x3f800000, 0x80000000, 0x3f7e9bc9, 0xbdd53db9
.long 0x3f800000, 0x80000000, 0x3f7e868b, 0xbddb7d37
.long 0x3f800000, 0x80000000, 0x3f7e70b0, 0xbde1bc2e
.long 0x3f800000, 0x80000000, 0x3f7e5a38, 0xbde7fa9a
.long 0x3f800000, 0x80000000, 0x3f7e4323, 0xbdee3876
.long 0x3f800000, 0x80000000, 0x3f7e2b72, 0xbdf475c0
.long 0x3f800000, 0x80000000, 0x3f7e1324, 0xbdfab273
.long 0x3f800000, 0x80000000, 0x3f7dfa38, 0xbe007745
.long 0x3f800000, 0x80000000, 0x3f7de0b1, 0xbe039502
.long 0x3f800000, 0x80000000, 0x3f7dc68c, 0xbe06b26e
.long 0x3f800000, 0x80000000, 0x3f7dabcc, 0xbe09cf86
.long 0x3f800000, 0x80000000, 0x3f7d906e, 0xbe0cec4a
.long 0x3f800000, 0x80000000, 0x3f7d7474, 0xbe1008b7
.long 0x3f800000, 0x80000000, 0x3f7d57de, 0xbe1324ca
.long 0x3f800000, 0x80000000, 0x3f7d3aac, 0xbe164083
.long 0x3f800000, 0x80000000, 0x3f7d1cdd, 0xbe195be0
.long 0x3f800000, 0x80000000, 0x3f7cfe73, 0xbe1c76de
.long 0x3f800000, 0x80000000, 0x3f7cdf6c, 0xbe1f917b
.long 0x3f800000, 0x80000000, 0x3f7cbfc9, 0xbe22abb6
.long 0x3f800000, 0x80000000, 0x3f7c9f8a, 0xbe25c58c
.long 0x3f800000, 0x80000000, 0x3f7c7eb0, 0xbe28defc
.long 0x3f800000, 0x80000000, 0x3f7c5d3a, 0xbe2bf804
.long 0x3f800000, 0x80000000, 0x3f7c3b28, 0xbe2f10a2
.long 0x3f800000, 0x80000000, 0x3f7c187a, 0xbe3228d4
.long 0x3f800000, 0x80000000, 0x3f7bf531, 0xbe354098
.long 0x3f800000, 0x80000000, 0x3f7bd14d, 0xbe3857ec
.long 0x3f800000, 0x80000000, 0x3f7baccd, 0xbe3b6ecf
.long 0x3f800000, 0x80000000, 0x3f7b87b2, 0xbe3e853e
.long 0x3f800000, 0x80000000, 0x3f7b61fc, 0xbe419b37
.long 0x3f800000, 0x80000000, 0x3f7b3bab, 0xbe44b0b9
.long 0x3f800000, 0x80000000, 0x3f7b14be, 0xbe47c5c2
.long 0x3f800000, 0x80000000, 0x3f7aed37, 0xbe4ada4f
.long 0x3f800000, 0x80000000, 0x3f7ac516, 0xbe4dee60
.long 0x3f800000, 0x80000000, 0x3f7a9c59, 0xbe5101f1
.long 0x3f800000, 0x80000000, 0x3f7a7302, 0xbe541501
.long 0x3f800000, 0x80000000, 0x3f7a4910, 0xbe57278f
.long 0x3f800000, 0x80000000, 0x3f7a1e84, 0xbe5a3997
.long 0x3f800000, 0x80000000, 0x3f79f35e, 0xbe5d4b1a
.long 0x3f800000, 0x80000000, 0x3f79c79d, 0xbe605c13
.long 0x3f800000, 0x80000000, 0x3f799b43, 0xbe636c83
.long 0x3f800000, 0x80000000, 0x3f796e4e, 0xbe667c66
.long 0x3f800000, 0x80000000, 0x3f7940c0, 0xbe698bba
.long 0x3f800000, 0x80000000, 0x3f791298, 0xbe6c9a7f
.long 0x3f800000, 0x80000000, 0x3f78e3d6, 0xbe6fa8b2
.long 0x3f800000, 0x80000000, 0x3f78b47b, 0xbe72b651
.long 0x3f800000, 0x80000000, 0x3f788486, 0xbe75c35a
.long 0x3f800000, 0x80000000, 0x3f7853f8, 0xbe78cfcc
.long 0x3f800000, 0x80000000, 0x3f7822d1, 0xbe7bdba4
.long 0x3f800000, 0x80000000, 0x3f77f110, 0xbe7ee6e1
.long 0x3f800000, 0x80000000, 0x3f77beb7, 0xbe80f8c0
.long 0x3f800000, 0x80000000, 0x3f778bc5, 0xbe827dc0
.long 0x3f800000, 0x80000000, 0x3f77583a, 0xbe840270
.long 0x3f800000, 0x80000000, 0x3f772417, 0xbe8586ce
.long 0x3f800000, 0x80000000, 0x3f76ef5b, 0xbe870ada
.long 0x3f800000, 0x80000000, 0x3f76ba07, 0xbe888e93
.long 0x3f800000, 0x80000000, 0x3f76841b, 0xbe8a11f7
.long 0x3f800000, 0x80000000, 0x3f764d97, 0xbe8b9507
.long 0x3f800000, 0x80000000, 0x3f76167a, 0xbe8d17c0
.long 0x3f800000, 0x80000000, 0x3f75dec6, 0xbe8e9a22
.long 0x3f800000, 0x80000000, 0x3f75a67b, 0xbe901c2c
.long 0x3f800000, 0x80000000, 0x3f756d97, 0xbe919ddd
.long 0x3f800000, 0x80000000, 0x3f75341d, 0xbe931f35
.long 0x3f800000, 0x80000000, 0x3f74fa0b, 0xbe94a031
.long 0x3f800000, 0x80000000, 0x3f74bf62, 0xbe9620d2
.long 0x3f800000, 0x80000000, 0x3f748422, 0xbe97a117
.long 0x3f800000, 0x80000000, 0x3f74484b, 0xbe9920fe
.long 0x3f800000, 0x80000000, 0x3f740bdd, 0xbe9aa086
.long 0x3f800000, 0x80000000, 0x3f73ced9, 0xbe9c1faf
.long 0x3f800000, 0x80000000, 0x3f73913f, 0xbe9d9e78
.long 0x3f800000, 0x80000000, 0x3f73530e, 0xbe9f1cdf
.long 0x3f800000, 0x80000000, 0x3f731447, 0xbea09ae5
.long 0x3f800000, 0x80000000, 0x3f72d4eb, 0xbea21887
.long 0x3f800000, 0x80000000, 0x3f7294f8, 0xbea395c5
.long 0x3f800000, 0x80000000, 0x3f725470, 0xbea5129f
.long 0x3f800000, 0x80000000, 0x3f721352, 0xbea68f12
.long 0x3f800000, 0x80000000, 0x3f71d19f, 0xbea80b1f
.long 0x3f800000, 0x80000000, 0x3f718f57, 0xbea986c4
.long 0x3f800000, 0x80000000, 0x3f714c7a, 0xbeab0201
.long 0x3f800000, 0x80000000, 0x3f710908, 0xbeac7cd4
.long 0x3f800000, 0x80000000, 0x3f70c501, 0xbeadf73c
.long 0x3f800000, 0x80000000, 0x3f708066, 0xbeaf713a
.long 0x3f800000, 0x80000000, 0x3f703b37, 0xbeb0eacb
.long 0x3f800000, 0x80000000, 0x3f6ff573, 0xbeb263ef
.long 0x3f800000, 0x80000000, 0x3f6faf1b, 0xbeb3dca5
.long 0x3f800000, 0x80000000, 0x3f6f6830, 0xbeb554ec
.long 0x3f800000, 0x80000000, 0x3f6f20b0, 0xbeb6ccc3
.long 0x3f800000, 0x80000000, 0x3f6ed89e, 0xbeb8442a
.long 0x3f800000, 0x80000000, 0x3f6e8ff8, 0xbeb9bb1e
.long 0x3f800000, 0x80000000, 0x3f6e46be, 0xbebb31a0
.long 0x3f800000, 0x80000000, 0x3f6dfcf2, 0xbebca7af
.long 0x3f800000, 0x80000000, 0x3f6db293, 0xbebe1d4a
.long 0x3f800000, 0x80000000, 0x3f6d67a1, 0xbebf926f
.long 0x3f800000, 0x80000000, 0x3f6d1c1d, 0xbec1071e
.long 0x3f800000, 0x80000000, 0x3f6cd007, 0xbec27b55
.long 0x3f800000, 0x80000000, 0x3f6c835e, 0xbec3ef15
.long 0x3f800000, 0x80000000, 0x3f6c3624, 0xbec5625c
.long 0x3f800000, 0x80000000, 0x3f6be858, 0xbec6d529
.long 0x3f800000, 0x80000000, 0x3f6b99fb, 0xbec8477c
.long 0x3f800000, 0x80000000, 0x3f6b4b0c, 0xbec9b953
.long 0x3f800000, 0x80000000, 0x3f6afb8c, 0xbecb2aae
.long 0x3f800000, 0x80000000, 0x3f6aab7b, 0xbecc9b8b
.long 0x3f800000, 0x80000000, 0x3f6a5ad9, 0xbece0bea
.long 0x3f800000, 0x80000000, 0x3f6a09a7, 0xbecf7bca
.long 0x3f800000, 0x80000000, 0x3f69b7e4, 0xbed0eb2a
.long 0x3f800000, 0x80000000, 0x3f696591, 0xbed25a09
.long 0x3f800000, 0x80000000, 0x3f6912ae, 0xbed3c867
.long 0x3f800000, 0x80000000, 0x3f68bf3c, 0xbed53641
.long 0x3f800000, 0x80000000, 0x3f686b39, 0xbed6a399
.long 0x3f800000, 0x80000000, 0x3f6816a8, 0xbed8106b
.long 0x3f800000, 0x80000000, 0x3f67c187, 0xbed97cb9
.long 0x3f800000, 0x80000000, 0x3f676bd8, 0xbedae880
.long 0x3f800000, 0x80000000, 0x3f671599, 0xbedc53c1
.long 0x3f800000, 0x80000000, 0x3f66becc, 0xbeddbe79
.long 0x3f800000, 0x80000000, 0x3f666771, 0xbedf28a9
.long 0x3f800000, 0x80000000, 0x3f660f88, 0xbee0924f
.long 0x3f800000, 0x80000000, 0x3f65b710, 0xbee1fb6a
.long 0x3f800000, 0x80000000, 0x3f655e0b, 0xbee363fa
.long 0x3f800000, 0x80000000, 0x3f650479, 0xbee4cbfe
.long 0x3f800000, 0x80000000, 0x3f64aa59, 0xbee63375
.long 0x3f800000, 0x80000000, 0x3f644fac, 0xbee79a5d
.long 0x3f800000, 0x80000000, 0x3f63f473, 0xbee900b7
.long 0x3f800000, 0x80000000, 0x3f6398ac, 0xbeea6681
.long 0x3f800000, 0x80000000, 0x3f633c5a, 0xbeebcbbb
.long 0x3f800000, 0x80000000, 0x3f62df7b, 0xbeed3063
.long 0x3f800000, 0x80000000, 0x3f628210, 0xbeee9479
.long 0x3f800000, 0x80000000, 0x3f62241a, 0xbeeff7fb
.long 0x3f800000, 0x80000000, 0x3f61c598, 0xbef15aea
.long 0x3f800000, 0x80000000, 0x3f61668a, 0xbef2bd43
.long 0x3f800000, 0x80000000, 0x3f6106f2, 0xbef41f07
.long 0x3f800000, 0x80000000, 0x3f60a6cf, 0xbef58035
.long 0x3f800000, 0x80000000, 0x3f604621, 0xbef6e0cb
.long 0x3f800000, 0x80000000, 0x3f5fe4e9, 0xbef840c8
.long 0x3f800000, 0x80000000, 0x3f5f8327, 0xbef9a02d
.long 0x3f800000, 0x80000000, 0x3f5f20db, 0xbefafef7
.long 0x3f800000, 0x80000000, 0x3f5ebe05, 0xbefc5d27
.long 0x3f800000, 0x80000000, 0x3f5e5aa6, 0xbefdbabb
.long 0x3f800000, 0x80000000, 0x3f5df6be, 0xbeff17b2
.long 0x3f800000, 0x80000000, 0x3f5d924d, 0xbf003a06
.long 0x3f800000, 0x80000000, 0x3f5d2d53, 0xbf00e7e4
.long 0x3f800000, 0x80000000, 0x3f5cc7d1, 0xbf019573
.long 0x3f800000, 0x80000000, 0x3f5c61c7, 0xbf0242b1
.long 0x3f800000, 0x80000000, 0x3f5bfb34, 0xbf02ef9f
.long 0x3f800000, 0x80000000, 0x3f5b941a, 0xbf039c3d
.long 0x3f800000, 0x80000000, 0x3f5b2c79, 0xbf044889
.long 0x3f800000, 0x80000000, 0x3f5ac450, 0xbf04f484
.long 0x3f800000, 0x80000000, 0x3f5a5ba0, 0xbf05a02c
.long 0x3f800000, 0x80000000, 0x3f59f26a, 0xbf064b82
.long 0x3f800000, 0x80000000, 0x3f5988ad, 0xbf06f686
.long 0x3f800000, 0x80000000, 0x3f591e6a, 0xbf07a136
.long 0x3f800000, 0x80000000, 0x3f58b3a1, 0xbf084b92
.long 0x3f800000, 0x80000000, 0x3f584853, 0xbf08f59b
.long 0x3f800000, 0x80000000, 0x3f57dc7f, 0xbf099f4e
.long 0x3f800000, 0x80000000, 0x3f577026, 0xbf0a48ad
.long 0x3f800000, 0x80000000, 0x3f570348, 0xbf0af1b7
.long 0x3f800000, 0x80000000, 0x3f5695e5, 0xbf0b9a6b
.long 0x3f800000, 0x80000000, 0x3f5627fe, 0xbf0c42c9
.long 0x3f800000, 0x80000000, 0x3f55b993, 0xbf0cead0
.long 0x3f800000, 0x80000000, 0x3f554aa4, 0xbf0d9281
.long 0x3f800000, 0x80000000, 0x3f54db31, 0xbf0e39da
.long 0x3f800000, 0x80000000, 0x3f546b3b, 0xbf0ee0db
.long 0x3f800000, 0x80000000, 0x3f53fac3, 0xbf0f8784
.long 0x3f800000, 0x80000000, 0x3f5389c7, 0xbf102dd5
.long 0x3f800000, 0x80000000, 0x3f531849, 0xbf10d3cd
.long 0x3f800000, 0x80000000, 0x3f52a649, 0xbf11796b
.long 0x3f800000, 0x80000000, 0x3f5233c6, 0xbf121eb0
.long 0x3f800000, 0x80000000, 0x3f51c0c2, 0xbf12c39a
.long 0x3f800000, 0x80000000, 0x3f514d3d, 0xbf13682a
.long 0x3f800000, 0x80000000, 0x3f50d937, 0xbf140c5f
.long 0x3f800000, 0x80000000, 0x3f5064af, 0xbf14b039
.long 0x3f800000, 0x80000000, 0x3f4fefa8, 0xbf1553b7
.long 0x3f800000, 0x80000000, 0x3f4f7a1f, 0xbf15f6d9
.long 0x3f800000, 0x80000000, 0x3f4f0417, 0xbf16999f
.long 0x3f800000, 0x80000000, 0x3f4e8d90, 0xbf173c07
.long 0x3f800000, 0x80000000, 0x3f4e1689, 0xbf17de12
.long 0x3f800000, 0x80000000, 0x3f4d9f02, 0xbf187fc0
.long 0x3f800000, 0x80000000, 0x3f4d26fd, 0xbf19210f
.long 0x3f800000, 0x80000000, 0x3f4cae79, 0xbf19c200
.long 0x3f800000, 0x80000000, 0x3f4c3578, 0xbf1a6293
.long 0x3f800000, 0x80000000, 0x3f4bbbf8, 0xbf1b02c6
.long 0x3f800000, 0x80000000, 0x3f4b41fa, 0xbf1ba299
.long 0x3f800000, 0x80000000, 0x3f4ac77f, 0xbf1c420c
.long 0x3f800000, 0x80000000, 0x3f4a4c87, 0xbf1ce11f
.long 0x3f800000, 0x80000000, 0x3f49d112, 0xbf1d7fd1
.long 0x3f800000, 0x80000000, 0x3f495521, 0xbf1e1e22
.long 0x3f800000, 0x80000000, 0x3f48d8b3, 0xbf1ebc12
.long 0x3f800000, 0x80000000, 0x3f485bca, 0xbf1f599f
.long 0x3f800000, 0x80000000, 0x3f47de65, 0xbf1ff6cb
.long 0x3f800000, 0x80000000, 0x3f476085, 0xbf209393
.long 0x3f800000, 0x80000000, 0x3f46e22a, 0xbf212ff9
.long 0x3f800000, 0x80000000, 0x3f466354, 0xbf21cbfb
.long 0x3f800000, 0x80000000, 0x3f45e403, 0xbf226799
.long 0x3f800000, 0x80000000, 0x3f456439, 0xbf2302d3
.long 0x3f800000, 0x80000000, 0x3f44e3f5, 0xbf239da9
.long 0x3f800000, 0x80000000, 0x3f446337, 0xbf24381a
.long 0x3f800000, 0x80000000, 0x3f43e200, 0xbf24d225
.long 0x3f800000, 0x80000000, 0x3f436051, 0xbf256bcb
.long 0x3f800000, 0x80000000, 0x3f42de29, 0xbf26050a
.long 0x3f800000, 0x80000000, 0x3f425b89, 0xbf269de3
.long 0x3f800000, 0x80000000, 0x3f41d870, 0xbf273656
.long 0x3f800000, 0x80000000, 0x3f4154e1, 0xbf27ce61
.long 0x3f800000, 0x80000000, 0x3f40d0da, 0xbf286605
.long 0x3f800000, 0x80000000, 0x3f404c5c, 0xbf28fd41
.long 0x3f800000, 0x80000000, 0x3f3fc767, 0xbf299415
.long 0x3f800000, 0x80000000, 0x3f3f41fc, 0xbf2a2a80
.long 0x3f800000, 0x80000000, 0x3f3ebc1b, 0xbf2ac082
.long 0x3f800000, 0x80000000, 0x3f3e35c5, 0xbf2b561b
.long 0x3f800000, 0x80000000, 0x3f3daef9, 0xbf2beb4a
.long 0x3f800000, 0x80000000, 0x3f3d27b8, 0xbf2c800f
.long 0x3f800000, 0x80000000, 0x3f3ca003, 0xbf2d1469
.long 0x3f800000, 0x80000000, 0x3f3c17d9, 0xbf2da859
.long 0x3f800000, 0x80000000, 0x3f3b8f3b, 0xbf2e3bde
.long 0x3f800000, 0x80000000, 0x3f3b0629, 0xbf2ecef7
.long 0x3f800000, 0x80000000, 0x3f3a7ca4, 0xbf2f61a5
.long 0x3f800000, 0x80000000, 0x3f39f2ac, 0xbf2ff3e6
.long 0x3f800000, 0x80000000, 0x3f396842, 0xbf3085bb
.long 0x3f800000, 0x80000000, 0x3f38dd65, 0xbf311722
.long 0x3f800000, 0x80000000, 0x3f385216, 0xbf31a81d
.long 0x3f800000, 0x80000000, 0x3f37c655, 0xbf3238aa
.long 0x3f800000, 0x80000000, 0x3f373a23, 0xbf32c8c9
.long 0x3f800000, 0x80000000, 0x3f36ad7f, 0xbf33587a
.long 0x3f800000, 0x80000000, 0x3f36206c, 0xbf33e7bc
.long 0x3f800000, 0x80000000, 0x3f3592e7, 0xbf34768f
.long 0x3f800000, 0x80000000, 0x3f800000, 0x80000000
.long 0x3f7ffec4, 0xbbc90f88, 0x3f7ffd39, 0xbc16cb58
.long 0x3f7ffb11, 0xbc490e90, 0x3f7ff4e6, 0xbc96c9b6
.long 0x3f7ff4e6, 0xbc96c9b6, 0x3f7fe705, 0xbce22a7a
.long 0x3f7fec43, 0xbcc90ab0, 0x3f7fd397, 0xbd16c32c
.long 0x3f7fe129, 0xbcfb49ba, 0x3f7fba9e, 0xbd3c6dd5
.long 0x3f7fd397, 0xbd16c32c, 0x3f7f9c18, 0xbd621469
.long 0x3f7fc38f, 0xbd2fe007, 0x3f7f7808, 0xbd83db0a
.long 0x3f7fb10f, 0xbd48fb30, 0x3f7f4e6d, 0xbd96a905
.long 0x3f7f9c18, 0xbd621469, 0x3f7f1f49, 0xbda973ba
.long 0x3f7f84ab, 0xbd7b2b74, 0x3f7eea9d, 0xbdbc3ac3
.long 0x3f7f6ac7, 0xbd8a200a, 0x3f7eb069, 0xbdcefdb7
.long 0x3f7f4e6d, 0xbd96a905, 0x3f7e70b0, 0xbde1bc2e
.long 0x3f7f2f9d, 0xbda3308c, 0x3f7e2b72, 0xbdf475c0
.long 0x3f7f0e58, 0xbdafb680, 0x3f7de0b1, 0xbe039502
.long 0x3f7eea9d, 0xbdbc3ac3, 0x3f7d906e, 0xbe0cec4a
.long 0x3f7ec46d, 0xbdc8bd36, 0x3f7d3aac, 0xbe164083
.long 0x3f7e9bc9, 0xbdd53db9, 0x3f7cdf6c, 0xbe1f917b
.long 0x3f7e70b0, 0xbde1bc2e, 0x3f7c7eb0, 0xbe28defc
.long 0x3f7e4323, 0xbdee3876, 0x3f7c187a, 0xbe3228d4
.long 0x3f7e1324, 0xbdfab273, 0x3f7baccd, 0xbe3b6ecf
.long 0x3f7de0b1, 0xbe039502, 0x3f7b3bab, 0xbe44b0b9
.long 0x3f7dabcc, 0xbe09cf86, 0x3f7ac516, 0xbe4dee60
.long 0x3f7d7474, 0xbe1008b7, 0x3f7a4910, 0xbe57278f
.long 0x3f7d3aac, 0xbe164083, 0x3f79c79d, 0xbe605c13
.long 0x3f7cfe73, 0xbe1c76de, 0x3f7940c0, 0xbe698bba
.long 0x3f7cbfc9, 0xbe22abb6, 0x3f78b47b, 0xbe72b651
.long 0x3f7c7eb0, 0xbe28defc, 0x3f7822d1, 0xbe7bdba4
.long 0x3f7c3b28, 0xbe2f10a2, 0x3f778bc5, 0xbe827dc0
.long 0x3f7bf531, 0xbe354098, 0x3f76ef5b, 0xbe870ada
.long 0x3f7baccd, 0xbe3b6ecf, 0x3f764d97, 0xbe8b9507
.long 0x3f7b61fc, 0xbe419b37, 0x3f75a67b, 0xbe901c2c
.long 0x3f7b14be, 0xbe47c5c2, 0x3f74fa0b, 0xbe94a031
.long 0x3f7ac516, 0xbe4dee60, 0x3f74484b, 0xbe9920fe
.long 0x3f7a7302, 0xbe541501, 0x3f73913f, 0xbe9d9e78
.long 0x3f7a1e84, 0xbe5a3997, 0x3f72d4eb, 0xbea21887
.long 0x3f79c79d, 0xbe605c13, 0x3f721352, 0xbea68f12
.long 0x3f796e4e, 0xbe667c66, 0x3f714c7a, 0xbeab0201
.long 0x3f791298, 0xbe6c9a7f, 0x3f708066, 0xbeaf713a
.long 0x3f78b47b, 0xbe72b651, 0x3f6faf1b, 0xbeb3dca5
.long 0x3f7853f8, 0xbe78cfcc, 0x3f6ed89e, 0xbeb8442a
.long 0x3f77f110, 0xbe7ee6e1, 0x3f6dfcf2, 0xbebca7af
.long 0x3f778bc5, 0xbe827dc0, 0x3f6d1c1d, 0xbec1071e
.long 0x3f772417, 0xbe8586ce, 0x3f6c3624, 0xbec5625c
.long 0x3f76ba07, 0xbe888e93, 0x3f6b4b0c, 0xbec9b953
.long 0x3f764d97, 0xbe8b9507, 0x3f6a5ad9, 0xbece0bea
.long 0x3f75dec6, 0xbe8e9a22, 0x3f696591, 0xbed25a09
.long 0x3f756d97, 0xbe919ddd, 0x3f686b39, 0xbed6a399
.long 0x3f74fa0b, 0xbe94a031, 0x3f676bd8, 0xbedae880
.long 0x3f748422, 0xbe97a117, 0x3f666771, 0xbedf28a9
.long 0x3f740bdd, 0xbe9aa086, 0x3f655e0b, 0xbee363fa
.long 0x3f73913f, 0xbe9d9e78, 0x3f644fac, 0xbee79a5d
.long 0x3f731447, 0xbea09ae5, 0x3f633c5a, 0xbeebcbbb
.long 0x3f7294f8, 0xbea395c5, 0x3f62241a, 0xbeeff7fb
.long 0x3f721352, 0xbea68f12, 0x3f6106f2, 0xbef41f07
.long 0x3f718f57, 0xbea986c4, 0x3f5fe4e9, 0xbef840c8
.long 0x3f710908, 0xbeac7cd4, 0x3f5ebe05, 0xbefc5d27
.long 0x3f708066, 0xbeaf713a, 0x3f5d924d, 0xbf003a06
.long 0x3f6ff573, 0xbeb263ef, 0x3f5c61c7, 0xbf0242b1
.long 0x3f6f6830, 0xbeb554ec, 0x3f5b2c79, 0xbf044889
.long 0x3f6ed89e, 0xbeb8442a, 0x3f59f26a, 0xbf064b82
.long 0x3f6e46be, 0xbebb31a0, 0x3f58b3a1, 0xbf084b92
.long 0x3f6db293, 0xbebe1d4a, 0x3f577026, 0xbf0a48ad
.long 0x3f6d1c1d, 0xbec1071e, 0x3f5627fe, 0xbf0c42c9
.long 0x3f6c835e, 0xbec3ef15, 0x3f54db31, 0xbf0e39da
.long 0x3f6be858, 0xbec6d529, 0x3f5389c7, 0xbf102dd5
.long 0x3f6b4b0c, 0xbec9b953, 0x3f5233c6, 0xbf121eb0
.long 0x3f6aab7b, 0xbecc9b8b, 0x3f50d937, 0xbf140c5f
.long 0x3f6a09a7, 0xbecf7bca, 0x3f4f7a1f, 0xbf15f6d9
.long 0x3f696591, 0xbed25a09, 0x3f4e1689, 0xbf17de12
.long 0x3f68bf3c, 0xbed53641, 0x3f4cae79, 0xbf19c200
.long 0x3f6816a8, 0xbed8106b, 0x3f4b41fa, 0xbf1ba299
.long 0x3f676bd8, 0xbedae880, 0x3f49d112, 0xbf1d7fd1
.long 0x3f66becc, 0xbeddbe79, 0x3f485bca, 0xbf1f599f
.long 0x3f660f88, 0xbee0924f, 0x3f46e22a, 0xbf212ff9
.long 0x3f655e0b, 0xbee363fa, 0x3f456439, 0xbf2302d3
.long 0x3f64aa59, 0xbee63375, 0x3f43e200, 0xbf24d225
.long 0x3f63f473, 0xbee900b7, 0x3f425b89, 0xbf269de3
.long 0x3f633c5a, 0xbeebcbbb, 0x3f40d0da, 0xbf286605
.long 0x3f628210, 0xbeee9479, 0x3f3f41fc, 0xbf2a2a80
.long 0x3f61c598, 0xbef15aea, 0x3f3daef9, 0xbf2beb4a
.long 0x3f6106f2, 0xbef41f07, 0x3f3c17d9, 0xbf2da859
.long 0x3f604621, 0xbef6e0cb, 0x3f3a7ca4, 0xbf2f61a5
.long 0x3f5f8327, 0xbef9a02d, 0x3f38dd65, 0xbf311722
.long 0x3f5ebe05, 0xbefc5d27, 0x3f373a23, 0xbf32c8c9
.long 0x3f5df6be, 0xbeff17b2, 0x3f3592e7, 0xbf34768f
.long 0x3f5d2d53, 0xbf00e7e4, 0x3f33e7bc, 0xbf36206c
.long 0x3f5c61c7, 0xbf0242b1, 0x3f3238aa, 0xbf37c655
.long 0x3f5b941a, 0xbf039c3d, 0x3f3085bb, 0xbf396842
.long 0x3f5ac450, 0xbf04f484, 0x3f2ecef7, 0xbf3b0629
.long 0x3f59f26a, 0xbf064b82, 0x3f2d1469, 0xbf3ca003
.long 0x3f591e6a, 0xbf07a136, 0x3f2b561b, 0xbf3e35c5
.long 0x3f584853, 0xbf08f59b, 0x3f299415, 0xbf3fc767
.long 0x3f577026, 0xbf0a48ad, 0x3f27ce61, 0xbf4154e1
.long 0x3f5695e5, 0xbf0b9a6b, 0x3f26050a, 0xbf42de29
.long 0x3f55b993, 0xbf0cead0, 0x3f24381a, 0xbf446337
.long 0x3f54db31, 0xbf0e39da, 0x3f226799, 0xbf45e403
.long 0x3f53fac3, 0xbf0f8784, 0x3f209393, 0xbf476085
.long 0x3f531849, 0xbf10d3cd, 0x3f1ebc12, 0xbf48d8b3
.long 0x3f5233c6, 0xbf121eb0, 0x3f1ce11f, 0xbf4a4c87
.long 0x3f514d3d, 0xbf13682a, 0x3f1b02c6, 0xbf4bbbf8
.long 0x3f5064af, 0xbf14b039, 0x3f19210f, 0xbf4d26fd
.long 0x3f4f7a1f, 0xbf15f6d9, 0x3f173c07, 0xbf4e8d90
.long 0x3f4e8d90, 0xbf173c07, 0x3f1553b7, 0xbf4fefa8
.long 0x3f4d9f02, 0xbf187fc0, 0x3f13682a, 0xbf514d3d
.long 0x3f4cae79, 0xbf19c200, 0x3f11796b, 0xbf52a649
.long 0x3f4bbbf8, 0xbf1b02c6, 0x3f0f8784, 0xbf53fac3
.long 0x3f4ac77f, 0xbf1c420c, 0x3f0d9281, 0xbf554aa4
.long 0x3f49d112, 0xbf1d7fd1, 0x3f0b9a6b, 0xbf5695e5
.long 0x3f48d8b3, 0xbf1ebc12, 0x3f099f4e, 0xbf57dc7f
.long 0x3f47de65, 0xbf1ff6cb, 0x3f07a136, 0xbf591e6a
.long 0x3f46e22a, 0xbf212ff9, 0x3f05a02c, 0xbf5a5ba0
.long 0x3f45e403, 0xbf226799, 0x3f039c3d, 0xbf5b941a
.long 0x3f44e3f5, 0xbf239da9, 0x3f019573, 0xbf5cc7d1
.long 0x3f43e200, 0xbf24d225, 0x3eff17b2, 0xbf5df6be
.long 0x3f42de29, 0xbf26050a, 0x3efafef7, 0xbf5f20db
.long 0x3f41d870, 0xbf273656, 0x3ef6e0cb, 0xbf604621
.long 0x3f40d0da, 0xbf286605, 0x3ef2bd43, 0xbf61668a
.long 0x3f3fc767, 0xbf299415, 0x3eee9479, 0xbf628210
.long 0x3f3ebc1b, 0xbf2ac082, 0x3eea6681, 0xbf6398ac
.long 0x3f3daef9, 0xbf2beb4a, 0x3ee63375, 0xbf64aa59
.long 0x3f3ca003, 0xbf2d1469, 0x3ee1fb6a, 0xbf65b710
.long 0x3f3b8f3b, 0xbf2e3bde, 0x3eddbe79, 0xbf66becc
.long 0x3f3a7ca4, 0xbf2f61a5, 0x3ed97cb9, 0xbf67c187
.long 0x3f396842, 0xbf3085bb, 0x3ed53641, 0xbf68bf3c
.long 0x3f385216, 0xbf31a81d, 0x3ed0eb2a, 0xbf69b7e4
.long 0x3f373a23, 0xbf32c8c9, 0x3ecc9b8b, 0xbf6aab7b
.long 0x3f36206c, 0xbf33e7bc, 0x3ec8477c, 0xbf6b99fb
.long 0x3f3504f3, 0xbf3504f3, 0x3ec3ef15, 0xbf6c835e
.long 0x3f33e7bc, 0xbf36206c, 0x3ebf926f, 0xbf6d67a1
.long 0x3f32c8c9, 0xbf373a23, 0x3ebb31a0, 0xbf6e46be
.long 0x3f31a81d, 0xbf385216, 0x3eb6ccc3, 0xbf6f20b0
.long 0x3f3085bb, 0xbf396842, 0x3eb263ef, 0xbf6ff573
.long 0x3f2f61a5, 0xbf3a7ca4, 0x3eadf73c, 0xbf70c501
.long 0x3f2e3bde, 0xbf3b8f3b, 0x3ea986c4, 0xbf718f57
.long 0x3f2d1469, 0xbf3ca003, 0x3ea5129f, 0xbf725470
.long 0x3f2beb4a, 0xbf3daef9, 0x3ea09ae5, 0xbf731447
.long 0x3f2ac082, 0xbf3ebc1b, 0x3e9c1faf, 0xbf73ced9
.long 0x3f299415, 0xbf3fc767, 0x3e97a117, 0xbf748422
.long 0x3f286605, 0xbf40d0da, 0x3e931f35, 0xbf75341d
.long 0x3f273656, 0xbf41d870, 0x3e8e9a22, 0xbf75dec6
.long 0x3f26050a, 0xbf42de29, 0x3e8a11f7, 0xbf76841b
.long 0x3f24d225, 0xbf43e200, 0x3e8586ce, 0xbf772417
.long 0x3f239da9, 0xbf44e3f5, 0x3e80f8c0, 0xbf77beb7
.long 0x3f226799, 0xbf45e403, 0x3e78cfcc, 0xbf7853f8
.long 0x3f212ff9, 0xbf46e22a, 0x3e6fa8b2, 0xbf78e3d6
.long 0x3f1ff6cb, 0xbf47de65, 0x3e667c66, 0xbf796e4e
.long 0x3f1ebc12, 0xbf48d8b3, 0x3e5d4b1a, 0xbf79f35e
.long 0x3f1d7fd1, 0xbf49d112, 0x3e541501, 0xbf7a7302
.long 0x3f1c420c, 0xbf4ac77f, 0x3e4ada4f, 0xbf7aed37
.long 0x3f1b02c6, 0xbf4bbbf8, 0x3e419b37, 0xbf7b61fc
.long 0x3f19c200, 0xbf4cae79, 0x3e3857ec, 0xbf7bd14d
.long 0x3f187fc0, 0xbf4d9f02, 0x3e2f10a2, 0xbf7c3b28
.long 0x3f173c07, 0xbf4e8d90, 0x3e25c58c, 0xbf7c9f8a
.long 0x3f15f6d9, 0xbf4f7a1f, 0x3e1c76de, 0xbf7cfe73
.long 0x3f14b039, 0xbf5064af, 0x3e1324ca, 0xbf7d57de
.long 0x3f13682a, 0xbf514d3d, 0x3e09cf86, 0xbf7dabcc
.long 0x3f121eb0, 0xbf5233c6, 0x3e007745, 0xbf7dfa38
.long 0x3f10d3cd, 0xbf531849, 0x3dee3876, 0xbf7e4323
.long 0x3f0f8784, 0xbf53fac3, 0x3ddb7d37, 0xbf7e868b
.long 0x3f0e39da, 0xbf54db31, 0x3dc8bd36, 0xbf7ec46d
.long 0x3f0cead0, 0xbf55b993, 0x3db5f8da, 0xbf7efcc9
.long 0x3f0b9a6b, 0xbf5695e5, 0x3da3308c, 0xbf7f2f9d
.long 0x3f0a48ad, 0xbf577026, 0x3d9064b4, 0xbf7f5ce9
.long 0x3f08f59b, 0xbf584853, 0x3d7b2b74, 0xbf7f84ab
.long 0x3f07a136, 0xbf591e6a, 0x3d55880e, 0xbf7fa6e3
.long 0x3f064b82, 0xbf59f26a, 0x3d2fe007, 0xbf7fc38f
.long 0x3f04f484, 0xbf5ac450, 0x3d0a342f, 0xbf7fdaaf
.long 0x3f039c3d, 0xbf5b941a, 0x3cc90ab0, 0xbf7fec43
.long 0x3f0242b1, 0xbf5c61c7, 0x3c7b514b, 0xbf7ff84a
.long 0x3f00e7e4, 0xbf5d2d53, 0x3bc90f88, 0xbf7ffec4
.long 0x3eff17b2, 0xbf5df6be, 0xbb490fc6, 0xbf7fffb1
.long 0x3efc5d27, 0xbf5ebe05, 0xbc490e90, 0xbf7ffb11
.long 0x3ef9a02d, 0xbf5f8327, 0xbcafea69, 0xbf7ff0e3
.long 0x3ef6e0cb, 0xbf604621, 0xbcfb49ba, 0xbf7fe129
.long 0x3ef41f07, 0xbf6106f2, 0xbd2351cb, 0xbf7fcbe2
.long 0x3ef15aea, 0xbf61c598, 0xbd48fb30, 0xbf7fb10f
.long 0x3eee9479, 0xbf628210, 0xbd6ea038, 0xbf7f90b1
.long 0x3eebcbbb, 0xbf633c5a, 0xbd8a200a, 0xbf7f6ac7
.long 0x3ee900b7, 0xbf63f473, 0xbd9cecf9, 0xbf7f3f54
.long 0x3ee63375, 0xbf64aa59, 0xbdafb680, 0xbf7f0e58
.long 0x3ee363fa, 0xbf655e0b, 0xbdc27c39, 0xbf7ed7d4
.long 0x3ee0924f, 0xbf660f88, 0xbdd53db9, 0xbf7e9bc9
.long 0x3eddbe79, 0xbf66becc, 0xbde7fa9a, 0xbf7e5a38
.long 0x3edae880, 0xbf676bd8, 0xbdfab273, 0xbf7e1324
.long 0x3ed8106b, 0xbf6816a8, 0xbe06b26e, 0xbf7dc68c
.long 0x3ed53641, 0xbf68bf3c, 0xbe1008b7, 0xbf7d7474
.long 0x3ed25a09, 0xbf696591, 0xbe195be0, 0xbf7d1cdd
.long 0x3ecf7bca, 0xbf6a09a7, 0xbe22abb6, 0xbf7cbfc9
.long 0x3ecc9b8b, 0xbf6aab7b, 0xbe2bf804, 0xbf7c5d3a
.long 0x3ec9b953, 0xbf6b4b0c, 0xbe354098, 0xbf7bf531
.long 0x3ec6d529, 0xbf6be858, 0xbe3e853e, 0xbf7b87b2
.long 0x3ec3ef15, 0xbf6c835e, 0xbe47c5c2, 0xbf7b14be
.long 0x3ec1071e, 0xbf6d1c1d, 0xbe5101f1, 0xbf7a9c59
.long 0x3ebe1d4a, 0xbf6db293, 0xbe5a3997, 0xbf7a1e84
.long 0x3ebb31a0, 0xbf6e46be, 0xbe636c83, 0xbf799b43
.long 0x3eb8442a, 0xbf6ed89e, 0xbe6c9a7f, 0xbf791298
.long 0x3eb554ec, 0xbf6f6830, 0xbe75c35a, 0xbf788486
.long 0x3eb263ef, 0xbf6ff573, 0xbe7ee6e1, 0xbf77f110
.long 0x3eaf713a, 0xbf708066, 0xbe840270, 0xbf77583a
.long 0x3eac7cd4, 0xbf710908, 0xbe888e93, 0xbf76ba07
.long 0x3ea986c4, 0xbf718f57, 0xbe8d17c0, 0xbf76167a
.long 0x3ea68f12, 0xbf721352, 0xbe919ddd, 0xbf756d97
.long 0x3ea395c5, 0xbf7294f8, 0xbe9620d2, 0xbf74bf62
.long 0x3ea09ae5, 0xbf731447, 0xbe9aa086, 0xbf740bdd
.long 0x3e9d9e78, 0xbf73913f, 0xbe9f1cdf, 0xbf73530e
.long 0x3e9aa086, 0xbf740bdd, 0xbea395c5, 0xbf7294f8
.long 0x3e97a117, 0xbf748422, 0xbea80b1f, 0xbf71d19f
.long 0x3e94a031, 0xbf74fa0b, 0xbeac7cd4, 0xbf710908
.long 0x3e919ddd, 0xbf756d97, 0xbeb0eacb, 0xbf703b37
.long 0x3e8e9a22, 0xbf75dec6, 0xbeb554ec, 0xbf6f6830
.long 0x3e8b9507, 0xbf764d97, 0xbeb9bb1e, 0xbf6e8ff8
.long 0x3e888e93, 0xbf76ba07, 0xbebe1d4a, 0xbf6db293
.long 0x3e8586ce, 0xbf772417, 0xbec27b55, 0xbf6cd007
.long 0x3e827dc0, 0xbf778bc5, 0xbec6d529, 0xbf6be858
.long 0x3e7ee6e1, 0xbf77f110, 0xbecb2aae, 0xbf6afb8c
.long 0x3e78cfcc, 0xbf7853f8, 0xbecf7bca, 0xbf6a09a7
.long 0x3e72b651, 0xbf78b47b, 0xbed3c867, 0xbf6912ae
.long 0x3e6c9a7f, 0xbf791298, 0xbed8106b, 0xbf6816a8
.long 0x3e667c66, 0xbf796e4e, 0xbedc53c1, 0xbf671599
.long 0x3e605c13, 0xbf79c79d, 0xbee0924f, 0xbf660f88
.long 0x3e5a3997, 0xbf7a1e84, 0xbee4cbfe, 0xbf650479
.long 0x3e541501, 0xbf7a7302, 0xbee900b7, 0xbf63f473
.long 0x3e4dee60, 0xbf7ac516, 0xbeed3063, 0xbf62df7b
.long 0x3e47c5c2, 0xbf7b14be, 0xbef15aea, 0xbf61c598
.long 0x3e419b37, 0xbf7b61fc, 0xbef58035, 0xbf60a6cf
.long 0x3e3b6ecf, 0xbf7baccd, 0xbef9a02d, 0xbf5f8327
.long 0x3e354098, 0xbf7bf531, 0xbefdbabb, 0xbf5e5aa6
.long 0x3e2f10a2, 0xbf7c3b28, 0xbf00e7e4, 0xbf5d2d53
.long 0x3e28defc, 0xbf7c7eb0, 0xbf02ef9f, 0xbf5bfb34
.long 0x3e22abb6, 0xbf7cbfc9, 0xbf04f484, 0xbf5ac450
.long 0x3e1c76de, 0xbf7cfe73, 0xbf06f686, 0xbf5988ad
.long 0x3e164083, 0xbf7d3aac, 0xbf08f59b, 0xbf584853
.long 0x3e1008b7, 0xbf7d7474, 0xbf0af1b7, 0xbf570348
.long 0x3e09cf86, 0xbf7dabcc, 0xbf0cead0, 0xbf55b993
.long 0x3e039502, 0xbf7de0b1, 0xbf0ee0db, 0xbf546b3b
.long 0x3dfab273, 0xbf7e1324, 0xbf10d3cd, 0xbf531849
.long 0x3dee3876, 0xbf7e4323, 0xbf12c39a, 0xbf51c0c2
.long 0x3de1bc2e, 0xbf7e70b0, 0xbf14b039, 0xbf5064af
.long 0x3dd53db9, 0xbf7e9bc9, 0xbf16999f, 0xbf4f0417
.long 0x3dc8bd36, 0xbf7ec46d, 0xbf187fc0, 0xbf4d9f02
.long 0x3dbc3ac3, 0xbf7eea9d, 0xbf1a6293, 0xbf4c3578
.long 0x3dafb680, 0xbf7f0e58, 0xbf1c420c, 0xbf4ac77f
.long 0x3da3308c, 0xbf7f2f9d, 0xbf1e1e22, 0xbf495521
.long 0x3d96a905, 0xbf7f4e6d, 0xbf1ff6cb, 0xbf47de65
.long 0x3d8a200a, 0xbf7f6ac7, 0xbf21cbfb, 0xbf466354
.long 0x3d7b2b74, 0xbf7f84ab, 0xbf239da9, 0xbf44e3f5
.long 0x3d621469, 0xbf7f9c18, 0xbf256bcb, 0xbf436051
.long 0x3d48fb30, 0xbf7fb10f, 0xbf273656, 0xbf41d870
.long 0x3d2fe007, 0xbf7fc38f, 0xbf28fd41, 0xbf404c5c
.long 0x3d16c32c, 0xbf7fd397, 0xbf2ac082, 0xbf3ebc1b
.long 0x3cfb49ba, 0xbf7fe129, 0xbf2c800f, 0xbf3d27b8
.long 0x3cc90ab0, 0xbf7fec43, 0xbf2e3bde, 0xbf3b8f3b
.long 0x3c96c9b6, 0xbf7ff4e6, 0xbf2ff3e6, 0xbf39f2ac
.long 0x3c490e90, 0xbf7ffb11, 0xbf31a81d, 0xbf385216
.long 0x3bc90f88, 0xbf7ffec4, 0xbf33587a, 0xbf36ad7f
.long 0x3f800000, 0x80000000, 0x3f800000, 0x80000000
.long 0x3f7ffb11, 0xbc490e90, 0x3f7ff84a, 0xbc7b514b
.long 0x3f7fec43, 0xbcc90ab0, 0x3f7fe129, 0xbcfb49ba
.long 0x3f7fd397, 0xbd16c32c, 0x3f7fba9e, 0xbd3c6dd5
.long 0x3f7fb10f, 0xbd48fb30, 0x3f7f84ab, 0xbd7b2b74
.long 0x3f7f84ab, 0xbd7b2b74, 0x3f7f3f54, 0xbd9cecf9
.long 0x3f7f4e6d, 0xbd96a905, 0x3f7eea9d, 0xbdbc3ac3
.long 0x3f7f0e58, 0xbdafb680, 0x3f7e868b, 0xbddb7d37
.long 0x3f7ec46d, 0xbdc8bd36, 0x3f7e1324, 0xbdfab273
.long 0x3f7e70b0, 0xbde1bc2e, 0x3f7d906e, 0xbe0cec4a
.long 0x3f7e1324, 0xbdfab273, 0x3f7cfe73, 0xbe1c76de
.long 0x3f7dabcc, 0xbe09cf86, 0x3f7c5d3a, 0xbe2bf804
.long 0x3f7d3aac, 0xbe164083, 0x3f7baccd, 0xbe3b6ecf
.long 0x3f7cbfc9, 0xbe22abb6, 0x3f7aed37, 0xbe4ada4f
.long 0x3f7c3b28, 0xbe2f10a2, 0x3f7a1e84, 0xbe5a3997
.long 0x3f7baccd, 0xbe3b6ecf, 0x3f7940c0, 0xbe698bba
.long 0x3f7b14be, 0xbe47c5c2, 0x3f7853f8, 0xbe78cfcc
.long 0x3f7a7302, 0xbe541501, 0x3f77583a, 0xbe840270
.long 0x3f79c79d, 0xbe605c13, 0x3f764d97, 0xbe8b9507
.long 0x3f791298, 0xbe6c9a7f, 0x3f75341d, 0xbe931f35
.long 0x3f7853f8, 0xbe78cfcc, 0x3f740bdd, 0xbe9aa086
.long 0x3f778bc5, 0xbe827dc0, 0x3f72d4eb, 0xbea21887
.long 0x3f76ba07, 0xbe888e93, 0x3f718f57, 0xbea986c4
.long 0x3f75dec6, 0xbe8e9a22, 0x3f703b37, 0xbeb0eacb
.long 0x3f74fa0b, 0xbe94a031, 0x3f6ed89e, 0xbeb8442a
.long 0x3f740bdd, 0xbe9aa086, 0x3f6d67a1, 0xbebf926f
.long 0x3f731447, 0xbea09ae5, 0x3f6be858, 0xbec6d529
.long 0x3f721352, 0xbea68f12, 0x3f6a5ad9, 0xbece0bea
.long 0x3f710908, 0xbeac7cd4, 0x3f68bf3c, 0xbed53641
.long 0x3f6ff573, 0xbeb263ef, 0x3f671599, 0xbedc53c1
.long 0x3f6ed89e, 0xbeb8442a, 0x3f655e0b, 0xbee363fa
.long 0x3f6db293, 0xbebe1d4a, 0x3f6398ac, 0xbeea6681
.long 0x3f6c835e, 0xbec3ef15, 0x3f61c598, 0xbef15aea
.long 0x3f6b4b0c, 0xbec9b953, 0x3f5fe4e9, 0xbef840c8
.long 0x3f6a09a7, 0xbecf7bca, 0x3f5df6be, 0xbeff17b2
.long 0x3f68bf3c, 0xbed53641, 0x3f5bfb34, 0xbf02ef9f
.long 0x3f676bd8, 0xbedae880, 0x3f59f26a, 0xbf064b82
.long 0x3f660f88, 0xbee0924f, 0x3f57dc7f, 0xbf099f4e
.long 0x3f64aa59, 0xbee63375, 0x3f55b993, 0xbf0cead0
.long 0x3f633c5a, 0xbeebcbbb, 0x3f5389c7, 0xbf102dd5
.long 0x3f61c598, 0xbef15aea, 0x3f514d3d, 0xbf13682a
.long 0x3f604621, 0xbef6e0cb, 0x3f4f0417, 0xbf16999f
.long 0x3f5ebe05, 0xbefc5d27, 0x3f4cae79, 0xbf19c200
.long 0x3f5d2d53, 0xbf00e7e4, 0x3f4a4c87, 0xbf1ce11f
.long 0x3f5b941a, 0xbf039c3d, 0x3f47de65, 0xbf1ff6cb
.long 0x3f59f26a, 0xbf064b82, 0x3f456439, 0xbf2302d3
.long 0x3f584853, 0xbf08f59b, 0x3f42de29, 0xbf26050a
.long 0x3f5695e5, 0xbf0b9a6b, 0x3f404c5c, 0xbf28fd41
.long 0x3f54db31, 0xbf0e39da, 0x3f3daef9, 0xbf2beb4a
.long 0x3f531849, 0xbf10d3cd, 0x3f3b0629, 0xbf2ecef7
.long 0x3f514d3d, 0xbf13682a, 0x3f385216, 0xbf31a81d
.long 0x3f4f7a1f, 0xbf15f6d9, 0x3f3592e7, 0xbf34768f
.long 0x3f4d9f02, 0xbf187fc0, 0x3f32c8c9, 0xbf373a23
.long 0x3f4bbbf8, 0xbf1b02c6, 0x3f2ff3e6, 0xbf39f2ac
.long 0x3f49d112, 0xbf1d7fd1, 0x3f2d1469, 0xbf3ca003
.long 0x3f47de65, 0xbf1ff6cb, 0x3f2a2a80, 0xbf3f41fc
.long 0x3f45e403, 0xbf226799, 0x3f273656, 0xbf41d870
.long 0x3f43e200, 0xbf24d225, 0x3f24381a, 0xbf446337
.long 0x3f41d870, 0xbf273656, 0x3f212ff9, 0xbf46e22a
.long 0x3f3fc767, 0xbf299415, 0x3f1e1e22, 0xbf495521
.long 0x3f3daef9, 0xbf2beb4a, 0x3f1b02c6, 0xbf4bbbf8
.long 0x3f3b8f3b, 0xbf2e3bde, 0x3f17de12, 0xbf4e1689
.long 0x3f396842, 0xbf3085bb, 0x3f14b039, 0xbf5064af
.long 0x3f373a23, 0xbf32c8c9, 0x3f11796b, 0xbf52a649
.long 0x3f3504f3, 0xbf3504f3, 0x3f0e39da, 0xbf54db31
.long 0x3f32c8c9, 0xbf373a23, 0x3f0af1b7, 0xbf570348
.long 0x3f3085bb, 0xbf396842, 0x3f07a136, 0xbf591e6a
.long 0x3f2e3bde, 0xbf3b8f3b, 0x3f044889, 0xbf5b2c79
.long 0x3f2beb4a, 0xbf3daef9, 0x3f00e7e4, 0xbf5d2d53
.long 0x3f299415, 0xbf3fc767, 0x3efafef7, 0xbf5f20db
.long 0x3f273656, 0xbf41d870, 0x3ef41f07, 0xbf6106f2
.long 0x3f24d225, 0xbf43e200, 0x3eed3063, 0xbf62df7b
.long 0x3f226799, 0xbf45e403, 0x3ee63375, 0xbf64aa59
.long 0x3f1ff6cb, 0xbf47de65, 0x3edf28a9, 0xbf666771
.long 0x3f1d7fd1, 0xbf49d112, 0x3ed8106b, 0xbf6816a8
.long 0x3f1b02c6, 0xbf4bbbf8, 0x3ed0eb2a, 0xbf69b7e4
.long 0x3f187fc0, 0xbf4d9f02, 0x3ec9b953, 0xbf6b4b0c
.long 0x3f15f6d9, 0xbf4f7a1f, 0x3ec27b55, 0xbf6cd007
.long 0x3f13682a, 0xbf514d3d, 0x3ebb31a0, 0xbf6e46be
.long 0x3f10d3cd, 0xbf531849, 0x3eb3dca5, 0xbf6faf1b
.long 0x3f0e39da, 0xbf54db31, 0x3eac7cd4, 0xbf710908
.long 0x3f0b9a6b, 0xbf5695e5, 0x3ea5129f, 0xbf725470
.long 0x3f08f59b, 0xbf584853, 0x3e9d9e78, 0xbf73913f
.long 0x3f064b82, 0xbf59f26a, 0x3e9620d2, 0xbf74bf62
.long 0x3f039c3d, 0xbf5b941a, 0x3e8e9a22, 0xbf75dec6
.long 0x3f00e7e4, 0xbf5d2d53, 0x3e870ada, 0xbf76ef5b
.long 0x3efc5d27, 0xbf5ebe05, 0x3e7ee6e1, 0xbf77f110
.long 0x3ef6e0cb, 0xbf604621, 0x3e6fa8b2, 0xbf78e3d6
.long 0x3ef15aea, 0xbf61c598, 0x3e605c13, 0xbf79c79d
.long 0x3eebcbbb, 0xbf633c5a, 0x3e5101f1, 0xbf7a9c59
.long 0x3ee63375, 0xbf64aa59, 0x3e419b37, 0xbf7b61fc
.long 0x3ee0924f, 0xbf660f88, 0x3e3228d4, 0xbf7c187a
.long 0x3edae880, 0xbf676bd8, 0x3e22abb6, 0xbf7cbfc9
.long 0x3ed53641, 0xbf68bf3c, 0x3e1324ca, 0xbf7d57de
.long 0x3ecf7bca, 0xbf6a09a7, 0x3e039502, 0xbf7de0b1
.long 0x3ec9b953, 0xbf6b4b0c, 0x3de7fa9a, 0xbf7e5a38
.long 0x3ec3ef15, 0xbf6c835e, 0x3dc8bd36, 0xbf7ec46d
.long 0x3ebe1d4a, 0xbf6db293, 0x3da973ba, 0xbf7f1f49
.long 0x3eb8442a, 0xbf6ed89e, 0x3d8a200a, 0xbf7f6ac7
.long 0x3eb263ef, 0xbf6ff573, 0x3d55880e, 0xbf7fa6e3
.long 0x3eac7cd4, 0xbf710908, 0x3d16c32c, 0xbf7fd397
.long 0x3ea68f12, 0xbf721352, 0x3cafea69, 0xbf7ff0e3
.long 0x3ea09ae5, 0xbf731447, 0x3bc90f88, 0xbf7ffec4
.long 0x3e9aa086, 0xbf740bdd, 0xbc16cb58, 0xbf7ffd39
.long 0x3e94a031, 0xbf74fa0b, 0xbcc90ab0, 0xbf7fec43
.long 0x3e8e9a22, 0xbf75dec6, 0xbd2351cb, 0xbf7fcbe2
.long 0x3e888e93, 0xbf76ba07, 0xbd621469, 0xbf7f9c18
.long 0x3e827dc0, 0xbf778bc5, 0xbd9064b4, 0xbf7f5ce9
.long 0x3e78cfcc, 0xbf7853f8, 0xbdafb680, 0xbf7f0e58
.long 0x3e6c9a7f, 0xbf791298, 0xbdcefdb7, 0xbf7eb069
.long 0x3e605c13, 0xbf79c79d, 0xbdee3876, 0xbf7e4323
.long 0x3e541501, 0xbf7a7302, 0xbe06b26e, 0xbf7dc68c
.long 0x3e47c5c2, 0xbf7b14be, 0xbe164083, 0xbf7d3aac
.long 0x3e3b6ecf, 0xbf7baccd, 0xbe25c58c, 0xbf7c9f8a
.long 0x3e2f10a2, 0xbf7c3b28, 0xbe354098, 0xbf7bf531
.long 0x3e22abb6, 0xbf7cbfc9, 0xbe44b0b9, 0xbf7b3bab
.long 0x3e164083, 0xbf7d3aac, 0xbe541501, 0xbf7a7302
.long 0x3e09cf86, 0xbf7dabcc, 0xbe636c83, 0xbf799b43
.long 0x3dfab273, 0xbf7e1324, 0xbe72b651, 0xbf78b47b
.long 0x3de1bc2e, 0xbf7e70b0, 0xbe80f8c0, 0xbf77beb7
.long 0x3dc8bd36, 0xbf7ec46d, 0xbe888e93, 0xbf76ba07
.long 0x3dafb680, 0xbf7f0e58, 0xbe901c2c, 0xbf75a67b
.long 0x3d96a905, 0xbf7f4e6d, 0xbe97a117, 0xbf748422
.long 0x3d7b2b74, 0xbf7f84ab, 0xbe9f1cdf, 0xbf73530e
.long 0x3d48fb30, 0xbf7fb10f, 0xbea68f12, 0xbf721352
.long 0x3d16c32c, 0xbf7fd397, 0xbeadf73c, 0xbf70c501
.long 0x3cc90ab0, 0xbf7fec43, 0xbeb554ec, 0xbf6f6830
.long 0x3c490e90, 0xbf7ffb11, 0xbebca7af, 0xbf6dfcf2
.long 0x248d3132, 0xbf800000, 0xbec3ef15, 0xbf6c835e
.long 0xbc490e90, 0xbf7ffb11, 0xbecb2aae, 0xbf6afb8c
.long 0xbcc90ab0, 0xbf7fec43, 0xbed25a09, 0xbf696591
.long 0xbd16c32c, 0xbf7fd397, 0xbed97cb9, 0xbf67c187
.long 0xbd48fb30, 0xbf7fb10f, 0xbee0924f, 0xbf660f88
.long 0xbd7b2b74, 0xbf7f84ab, 0xbee79a5d, 0xbf644fac
.long 0xbd96a905, 0xbf7f4e6d, 0xbeee9479, 0xbf628210
.long 0xbdafb680, 0xbf7f0e58, 0xbef58035, 0xbf60a6cf
.long 0xbdc8bd36, 0xbf7ec46d, 0xbefc5d27, 0xbf5ebe05
.long 0xbde1bc2e, 0xbf7e70b0, 0xbf019573, 0xbf5cc7d1
.long 0xbdfab273, 0xbf7e1324, 0xbf04f484, 0xbf5ac450
.long 0xbe09cf86, 0xbf7dabcc, 0xbf084b92, 0xbf58b3a1
.long 0xbe164083, 0xbf7d3aac, 0xbf0b9a6b, 0xbf5695e5
.long 0xbe22abb6, 0xbf7cbfc9, 0xbf0ee0db, 0xbf546b3b
.long 0xbe2f10a2, 0xbf7c3b28, 0xbf121eb0, 0xbf5233c6
.long 0xbe3b6ecf, 0xbf7baccd, 0xbf1553b7, 0xbf4fefa8
.long 0xbe47c5c2, 0xbf7b14be, 0xbf187fc0, 0xbf4d9f02
.long 0xbe541501, 0xbf7a7302, 0xbf1ba299, 0xbf4b41fa
.long 0xbe605c13, 0xbf79c79d, 0xbf1ebc12, 0xbf48d8b3
.long 0xbe6c9a7f, 0xbf791298, 0xbf21cbfb, 0xbf466354
.long 0xbe78cfcc, 0xbf7853f8, 0xbf24d225, 0xbf43e200
.long 0xbe827dc0, 0xbf778bc5, 0xbf27ce61, 0xbf4154e1
.long 0xbe888e93, 0xbf76ba07, 0xbf2ac082, 0xbf3ebc1b
.long 0xbe8e9a22, 0xbf75dec6, 0xbf2da859, 0xbf3c17d9
.long 0xbe94a031, 0xbf74fa0b, 0xbf3085bb, 0xbf396842
.long 0xbe9aa086, 0xbf740bdd, 0xbf33587a, 0xbf36ad7f
.long 0xbea09ae5, 0xbf731447, 0xbf36206c, 0xbf33e7bc
.long 0xbea68f12, 0xbf721352, 0xbf38dd65, 0xbf311722
.long 0xbeac7cd4, 0xbf710908, 0xbf3b8f3b, 0xbf2e3bde
.long 0xbeb263ef, 0xbf6ff573, 0xbf3e35c5, 0xbf2b561b
.long 0xbeb8442a, 0xbf6ed89e, 0xbf40d0da, 0xbf286605
.long 0xbebe1d4a, 0xbf6db293, 0xbf436051, 0xbf256bcb
.long 0xbec3ef15, 0xbf6c835e, 0xbf45e403, 0xbf226799
.long 0xbec9b953, 0xbf6b4b0c, 0xbf485bca, 0xbf1f599f
.long 0xbecf7bca, 0xbf6a09a7, 0xbf4ac77f, 0xbf1c420c
.long 0xbed53641, 0xbf68bf3c, 0xbf4d26fd, 0xbf19210f
.long 0xbedae880, 0xbf676bd8, 0xbf4f7a1f, 0xbf15f6d9
.long 0xbee0924f, 0xbf660f88, 0xbf51c0c2, 0xbf12c39a
.long 0xbee63375, 0xbf64aa59, 0xbf53fac3, 0xbf0f8784
.long 0xbeebcbbb, 0xbf633c5a, 0xbf5627fe, 0xbf0c42c9
.long 0xbef15aea, 0xbf61c598, 0xbf584853, 0xbf08f59b
.long 0xbef6e0cb, 0xbf604621, 0xbf5a5ba0, 0xbf05a02c
.long 0xbefc5d27, 0xbf5ebe05, 0xbf5c61c7, 0xbf0242b1
.long 0xbf00e7e4, 0xbf5d2d53, 0xbf5e5aa6, 0xbefdbabb
.long 0xbf039c3d, 0xbf5b941a, 0xbf604621, 0xbef6e0cb
.long 0xbf064b82, 0xbf59f26a, 0xbf62241a, 0xbeeff7fb
.long 0xbf08f59b, 0xbf584853, 0xbf63f473, 0xbee900b7
.long 0xbf0b9a6b, 0xbf5695e5, 0xbf65b710, 0xbee1fb6a
.long 0xbf0e39da, 0xbf54db31, 0xbf676bd8, 0xbedae880
.long 0xbf10d3cd, 0xbf531849, 0xbf6912ae, 0xbed3c867
.long 0xbf13682a, 0xbf514d3d, 0xbf6aab7b, 0xbecc9b8b
.long 0xbf15f6d9, 0xbf4f7a1f, 0xbf6c3624, 0xbec5625c
.long 0xbf187fc0, 0xbf4d9f02, 0xbf6db293, 0xbebe1d4a
.long 0xbf1b02c6, 0xbf4bbbf8, 0xbf6f20b0, 0xbeb6ccc3
.long 0xbf1d7fd1, 0xbf49d112, 0xbf708066, 0xbeaf713a
.long 0xbf1ff6cb, 0xbf47de65, 0xbf71d19f, 0xbea80b1f
.long 0xbf226799, 0xbf45e403, 0xbf731447, 0xbea09ae5
.long 0xbf24d225, 0xbf43e200, 0xbf74484b, 0xbe9920fe
.long 0xbf273656, 0xbf41d870, 0xbf756d97, 0xbe919ddd
.long 0xbf299415, 0xbf3fc767, 0xbf76841b, 0xbe8a11f7
.long 0xbf2beb4a, 0xbf3daef9, 0xbf778bc5, 0xbe827dc0
.long 0xbf2e3bde, 0xbf3b8f3b, 0xbf788486, 0xbe75c35a
.long 0xbf3085bb, 0xbf396842, 0xbf796e4e, 0xbe667c66
.long 0xbf32c8c9, 0xbf373a23, 0xbf7a4910, 0xbe57278f
.long 0xbf3504f3, 0xbf3504f3, 0xbf7b14be, 0xbe47c5c2
.long 0xbf373a23, 0xbf32c8c9, 0xbf7bd14d, 0xbe3857ec
.long 0xbf396842, 0xbf3085bb, 0xbf7c7eb0, 0xbe28defc
.long 0xbf3b8f3b, 0xbf2e3bde, 0xbf7d1cdd, 0xbe195be0
.long 0xbf3daef9, 0xbf2beb4a, 0xbf7dabcc, 0xbe09cf86
.long 0xbf3fc767, 0xbf299415, 0xbf7e2b72, 0xbdf475c0
.long 0xbf41d870, 0xbf273656, 0xbf7e9bc9, 0xbdd53db9
.long 0xbf43e200, 0xbf24d225, 0xbf7efcc9, 0xbdb5f8da
.long 0xbf45e403, 0xbf226799, 0xbf7f4e6d, 0xbd96a905
.long 0xbf47de65, 0xbf1ff6cb, 0xbf7f90b1, 0xbd6ea038
.long 0xbf49d112, 0xbf1d7fd1, 0xbf7fc38f, 0xbd2fe007
.long 0xbf4bbbf8, 0xbf1b02c6, 0xbf7fe705, 0xbce22a7a
.long 0xbf4d9f02, 0xbf187fc0, 0xbf7ffb11, 0xbc490e90
.long 0xbf4f7a1f, 0xbf15f6d9, 0xbf7fffb1, 0x3b490fc6
.long 0xbf514d3d, 0xbf13682a, 0xbf7ff4e6, 0x3c96c9b6
.long 0xbf531849, 0xbf10d3cd, 0xbf7fdaaf, 0x3d0a342f
.long 0xbf54db31, 0xbf0e39da, 0xbf7fb10f, 0x3d48fb30
.long 0xbf5695e5, 0xbf0b9a6b, 0xbf7f7808, 0x3d83db0a
.long 0xbf584853, 0xbf08f59b, 0xbf7f2f9d, 0x3da3308c
.long 0xbf59f26a, 0xbf064b82, 0xbf7ed7d4, 0x3dc27c39
.long 0xbf5b941a, 0xbf039c3d, 0xbf7e70b0, 0x3de1bc2e
.long 0xbf5d2d53, 0xbf00e7e4, 0xbf7dfa38, 0x3e007745
.long 0xbf5ebe05, 0xbefc5d27, 0xbf7d7474, 0x3e1008b7
.long 0xbf604621, 0xbef6e0cb, 0xbf7cdf6c, 0x3e1f917b
.long 0xbf61c598, 0xbef15aea, 0xbf7c3b28, 0x3e2f10a2
.long 0xbf633c5a, 0xbeebcbbb, 0xbf7b87b2, 0x3e3e853e
.long 0xbf64aa59, 0xbee63375, 0xbf7ac516, 0x3e4dee60
.long 0xbf660f88, 0xbee0924f, 0xbf79f35e, 0x3e5d4b1a
.long 0xbf676bd8, 0xbedae880, 0xbf791298, 0x3e6c9a7f
.long 0xbf68bf3c, 0xbed53641, 0xbf7822d1, 0x3e7bdba4
.long 0xbf6a09a7, 0xbecf7bca, 0xbf772417, 0x3e8586ce
.long 0xbf6b4b0c, 0xbec9b953, 0xbf76167a, 0x3e8d17c0
.long 0xbf6c835e, 0xbec3ef15, 0xbf74fa0b, 0x3e94a031
.long 0xbf6db293, 0xbebe1d4a, 0xbf73ced9, 0x3e9c1faf
.long 0xbf6ed89e, 0xbeb8442a, 0xbf7294f8, 0x3ea395c5
.long 0xbf6ff573, 0xbeb263ef, 0xbf714c7a, 0x3eab0201
.long 0xbf710908, 0xbeac7cd4, 0xbf6ff573, 0x3eb263ef
.long 0xbf721352, 0xbea68f12, 0xbf6e8ff8, 0x3eb9bb1e
.long 0xbf731447, 0xbea09ae5, 0xbf6d1c1d, 0x3ec1071e
.long 0xbf740bdd, 0xbe9aa086, 0xbf6b99fb, 0x3ec8477c
.long 0xbf74fa0b, 0xbe94a031, 0xbf6a09a7, 0x3ecf7bca
.long 0xbf75dec6, 0xbe8e9a22, 0xbf686b39, 0x3ed6a399
.long 0xbf76ba07, 0xbe888e93, 0xbf66becc, 0x3eddbe79
.long 0xbf778bc5, 0xbe827dc0, 0xbf650479, 0x3ee4cbfe
.long 0xbf7853f8, 0xbe78cfcc, 0xbf633c5a, 0x3eebcbbb
.long 0xbf791298, 0xbe6c9a7f, 0xbf61668a, 0x3ef2bd43
.long 0xbf79c79d, 0xbe605c13, 0xbf5f8327, 0x3ef9a02d
.long 0xbf7a7302, 0xbe541501, 0xbf5d924d, 0x3f003a06
.long 0xbf7b14be, 0xbe47c5c2, 0xbf5b941a, 0x3f039c3d
.long 0xbf7baccd, 0xbe3b6ecf, 0xbf5988ad, 0x3f06f686
.long 0xbf7c3b28, 0xbe2f10a2, 0xbf577026, 0x3f0a48ad
.long 0xbf7cbfc9, 0xbe22abb6, 0xbf554aa4, 0x3f0d9281
.long 0xbf7d3aac, 0xbe164083, 0xbf531849, 0x3f10d3cd
.long 0xbf7dabcc, 0xbe09cf86, 0xbf50d937, 0x3f140c5f
.long 0xbf7e1324, 0xbdfab273, 0xbf4e8d90, 0x3f173c07
.long 0xbf7e70b0, 0xbde1bc2e, 0xbf4c3578, 0x3f1a6293
.long 0xbf7ec46d, 0xbdc8bd36, 0xbf49d112, 0x3f1d7fd1
.long 0xbf7f0e58, 0xbdafb680, 0xbf476085, 0x3f209393
.long 0xbf7f4e6d, 0xbd96a905, 0xbf44e3f5, 0x3f239da9
.long 0xbf7f84ab, 0xbd7b2b74, 0xbf425b89, 0x3f269de3
.long 0xbf7fb10f, 0xbd48fb30, 0xbf3fc767, 0x3f299415
.long 0xbf7fd397, 0xbd16c32c, 0xbf3d27b8, 0x3f2c800f
.long 0xbf7fec43, 0xbcc90ab0, 0xbf3a7ca4, 0x3f2f61a5
.long 0xbf7ffb11, 0xbc490e90, 0xbf37c655, 0x3f3238aa
.long 0x3f800000, 0x80000000, 0x3f800000, 0x80000000
.long 0x3f7ff4e6, 0xbc96c9b6, 0x3f7ff0e3, 0xbcafea69
.long 0x3f7fd397, 0xbd16c32c, 0x3f7fc38f, 0xbd2fe007
.long 0x3f7f9c18, 0xbd621469, 0x3f7f7808, 0xbd83db0a
.long 0x3f7f4e6d, 0xbd96a905, 0x3f7f0e58, 0xbdafb680
.long 0x3f7eea9d, 0xbdbc3ac3, 0x3f7e868b, 0xbddb7d37
.long 0x3f7e70b0, 0xbde1bc2e, 0x3f7de0b1, 0xbe039502
.long 0x3f7de0b1, 0xbe039502, 0x3f7d1cdd, 0xbe195be0
.long 0x3f7d3aac, 0xbe164083, 0x3f7c3b28, 0xbe2f10a2
.long 0x3f7c7eb0, 0xbe28defc, 0x3f7b3bab, 0xbe44b0b9
.long 0x3f7baccd, 0xbe3b6ecf, 0x3f7a1e84, 0xbe5a3997
.long 0x3f7ac516, 0xbe4dee60, 0x3f78e3d6, 0xbe6fa8b2
.long 0x3f79c79d, 0xbe605c13, 0x3f778bc5, 0xbe827dc0
.long 0x3f78b47b, 0xbe72b651, 0x3f76167a, 0xbe8d17c0
.long 0x3f778bc5, 0xbe827dc0, 0x3f748422, 0xbe97a117
.long 0x3f764d97, 0xbe8b9507, 0x3f72d4eb, 0xbea21887
.long 0x3f74fa0b, 0xbe94a031, 0x3f710908, 0xbeac7cd4
.long 0x3f73913f, 0xbe9d9e78, 0x3f6f20b0, 0xbeb6ccc3
.long 0x3f721352, 0xbea68f12, 0x3f6d1c1d, 0xbec1071e
.long 0x3f708066, 0xbeaf713a, 0x3f6afb8c, 0xbecb2aae
.long 0x3f6ed89e, 0xbeb8442a, 0x3f68bf3c, 0xbed53641
.long 0x3f6d1c1d, 0xbec1071e, 0x3f666771, 0xbedf28a9
.long 0x3f6b4b0c, 0xbec9b953, 0x3f63f473, 0xbee900b7
.long 0x3f696591, 0xbed25a09, 0x3f61668a, 0xbef2bd43
.long 0x3f676bd8, 0xbedae880, 0x3f5ebe05, 0xbefc5d27
.long 0x3f655e0b, 0xbee363fa, 0x3f5bfb34, 0xbf02ef9f
.long 0x3f633c5a, 0xbeebcbbb, 0x3f591e6a, 0xbf07a136
.long 0x3f6106f2, 0xbef41f07, 0x3f5627fe, 0xbf0c42c9
.long 0x3f5ebe05, 0xbefc5d27, 0x3f531849, 0xbf10d3cd
.long 0x3f5c61c7, 0xbf0242b1, 0x3f4fefa8, 0xbf1553b7
.long 0x3f59f26a, 0xbf064b82, 0x3f4cae79, 0xbf19c200
.long 0x3f577026, 0xbf0a48ad, 0x3f495521, 0xbf1e1e22
.long 0x3f54db31, 0xbf0e39da, 0x3f45e403, 0xbf226799
.long 0x3f5233c6, 0xbf121eb0, 0x3f425b89, 0xbf269de3
.long 0x3f4f7a1f, 0xbf15f6d9, 0x3f3ebc1b, 0xbf2ac082
.long 0x3f4cae79, 0xbf19c200, 0x3f3b0629, 0xbf2ecef7
.long 0x3f49d112, 0xbf1d7fd1, 0x3f373a23, 0xbf32c8c9
.long 0x3f46e22a, 0xbf212ff9, 0x3f33587a, 0xbf36ad7f
.long 0x3f43e200, 0xbf24d225, 0x3f2f61a5, 0xbf3a7ca4
.long 0x3f40d0da, 0xbf286605, 0x3f2b561b, 0xbf3e35c5
.long 0x3f3daef9, 0xbf2beb4a, 0x3f273656, 0xbf41d870
.long 0x3f3a7ca4, 0xbf2f61a5, 0x3f2302d3, 0xbf456439
.long 0x3f373a23, 0xbf32c8c9, 0x3f1ebc12, 0xbf48d8b3
.long 0x3f33e7bc, 0xbf36206c, 0x3f1a6293, 0xbf4c3578
.long 0x3f3085bb, 0xbf396842, 0x3f15f6d9, 0xbf4f7a1f
.long 0x3f2d1469, 0xbf3ca003, 0x3f11796b, 0xbf52a649
.long 0x3f299415, 0xbf3fc767, 0x3f0cead0, 0xbf55b993
.long 0x3f26050a, 0xbf42de29, 0x3f084b92, 0xbf58b3a1
.long 0x3f226799, 0xbf45e403, 0x3f039c3d, 0xbf5b941a
.long 0x3f1ebc12, 0xbf48d8b3, 0x3efdbabb, 0xbf5e5aa6
.long 0x3f1b02c6, 0xbf4bbbf8, 0x3ef41f07, 0xbf6106f2
.long 0x3f173c07, 0xbf4e8d90, 0x3eea6681, 0xbf6398ac
.long 0x3f13682a, 0xbf514d3d, 0x3ee0924f, 0xbf660f88
.long 0x3f0f8784, 0xbf53fac3, 0x3ed6a399, 0xbf686b39
.long 0x3f0b9a6b, 0xbf5695e5, 0x3ecc9b8b, 0xbf6aab7b
.long 0x3f07a136, 0xbf591e6a, 0x3ec27b55, 0xbf6cd007
.long 0x3f039c3d, 0xbf5b941a, 0x3eb8442a, 0xbf6ed89e
.long 0x3eff17b2, 0xbf5df6be, 0x3eadf73c, 0xbf70c501
.long 0x3ef6e0cb, 0xbf604621, 0x3ea395c5, 0xbf7294f8
.long 0x3eee9479, 0xbf628210, 0x3e9920fe, 0xbf74484b
.long 0x3ee63375, 0xbf64aa59, 0x3e8e9a22, 0xbf75dec6
.long 0x3eddbe79, 0xbf66becc, 0x3e840270, 0xbf77583a
.long 0x3ed53641, 0xbf68bf3c, 0x3e72b651, 0xbf78b47b
.long 0x3ecc9b8b, 0xbf6aab7b, 0x3e5d4b1a, 0xbf79f35e
.long 0x3ec3ef15, 0xbf6c835e, 0x3e47c5c2, 0xbf7b14be
.long 0x3ebb31a0, 0xbf6e46be, 0x3e3228d4, 0xbf7c187a
.long 0x3eb263ef, 0xbf6ff573, 0x3e1c76de, 0xbf7cfe73
.long 0x3ea986c4, 0xbf718f57, 0x3e06b26e, 0xbf7dc68c
.long 0x3ea09ae5, 0xbf731447, 0x3de1bc2e, 0xbf7e70b0
.long 0x3e97a117, 0xbf748422, 0x3db5f8da, 0xbf7efcc9
.long 0x3e8e9a22, 0xbf75dec6, 0x3d8a200a, 0xbf7f6ac7
.long 0x3e8586ce, 0xbf772417, 0x3d3c6dd5, 0xbf7fba9e
.long 0x3e78cfcc, 0xbf7853f8, 0x3cc90ab0, 0xbf7fec43
.long 0x3e667c66, 0xbf796e4e, 0x3b490fc6, 0xbf7fffb1
.long 0x3e541501, 0xbf7a7302, 0xbc96c9b6, 0xbf7ff4e6
.long 0x3e419b37, 0xbf7b61fc, 0xbd2351cb, 0xbf7fcbe2
.long 0x3e2f10a2, 0xbf7c3b28, 0xbd7b2b74, 0xbf7f84ab
.long 0x3e1c76de, 0xbf7cfe73, 0xbda973ba, 0xbf7f1f49
.long 0x3e09cf86, 0xbf7dabcc, 0xbdd53db9, 0xbf7e9bc9
.long 0x3dee3876, 0xbf7e4323, 0xbe007745, 0xbf7dfa38
.long 0x3dc8bd36, 0xbf7ec46d, 0xbe164083, 0xbf7d3aac
.long 0x3da3308c, 0xbf7f2f9d, 0xbe2bf804, 0xbf7c5d3a
.long 0x3d7b2b74, 0xbf7f84ab, 0xbe419b37, 0xbf7b61fc
.long 0x3d2fe007, 0xbf7fc38f, 0xbe57278f, 0xbf7a4910
.long 0x3cc90ab0, 0xbf7fec43, 0xbe6c9a7f, 0xbf791298
.long 0x3bc90f88, 0xbf7ffec4, 0xbe80f8c0, 0xbf77beb7
.long 0xbc490e90, 0xbf7ffb11, 0xbe8b9507, 0xbf764d97
.long 0xbcfb49ba, 0xbf7fe129, 0xbe9620d2, 0xbf74bf62
.long 0xbd48fb30, 0xbf7fb10f, 0xbea09ae5, 0xbf731447
.long 0xbd8a200a, 0xbf7f6ac7, 0xbeab0201, 0xbf714c7a
.long 0xbdafb680, 0xbf7f0e58, 0xbeb554ec, 0xbf6f6830
.long 0xbdd53db9, 0xbf7e9bc9, 0xbebf926f, 0xbf6d67a1
.long 0xbdfab273, 0xbf7e1324, 0xbec9b953, 0xbf6b4b0c
.long 0xbe1008b7, 0xbf7d7474, 0xbed3c867, 0xbf6912ae
.long 0xbe22abb6, 0xbf7cbfc9, 0xbeddbe79, 0xbf66becc
.long 0xbe354098, 0xbf7bf531, 0xbee79a5d, 0xbf644fac
.long 0xbe47c5c2, 0xbf7b14be, 0xbef15aea, 0xbf61c598
.long 0xbe5a3997, 0xbf7a1e84, 0xbefafef7, 0xbf5f20db
.long 0xbe6c9a7f, 0xbf791298, 0xbf0242b1, 0xbf5c61c7
.long 0xbe7ee6e1, 0xbf77f110, 0xbf06f686, 0xbf5988ad
.long 0xbe888e93, 0xbf76ba07, 0xbf0b9a6b, 0xbf5695e5
.long 0xbe919ddd, 0xbf756d97, 0xbf102dd5, 0xbf5389c7
.long 0xbe9aa086, 0xbf740bdd, 0xbf14b039, 0xbf5064af
.long 0xbea395c5, 0xbf7294f8, 0xbf19210f, 0xbf4d26fd
.long 0xbeac7cd4, 0xbf710908, 0xbf1d7fd1, 0xbf49d112
.long 0xbeb554ec, 0xbf6f6830, 0xbf21cbfb, 0xbf466354
.long 0xbebe1d4a, 0xbf6db293, 0xbf26050a, 0xbf42de29
.long 0xbec6d529, 0xbf6be858, 0xbf2a2a80, 0xbf3f41fc
.long 0xbecf7bca, 0xbf6a09a7, 0xbf2e3bde, 0xbf3b8f3b
.long 0xbed8106b, 0xbf6816a8, 0xbf3238aa, 0xbf37c655
.long 0xbee0924f, 0xbf660f88, 0xbf36206c, 0xbf33e7bc
.long 0xbee900b7, 0xbf63f473, 0xbf39f2ac, 0xbf2ff3e6
.long 0xbef15aea, 0xbf61c598, 0xbf3daef9, 0xbf2beb4a
.long 0xbef9a02d, 0xbf5f8327, 0xbf4154e1, 0xbf27ce61
.long 0xbf00e7e4, 0xbf5d2d53, 0xbf44e3f5, 0xbf239da9
.long 0xbf04f484, 0xbf5ac450, 0xbf485bca, 0xbf1f599f
.long 0xbf08f59b, 0xbf584853, 0xbf4bbbf8, 0xbf1b02c6
.long 0xbf0cead0, 0xbf55b993, 0xbf4f0417, 0xbf16999f
.long 0xbf10d3cd, 0xbf531849, 0xbf5233c6, 0xbf121eb0
.long 0xbf14b039, 0xbf5064af, 0xbf554aa4, 0xbf0d9281
.long 0xbf187fc0, 0xbf4d9f02, 0xbf584853, 0xbf08f59b
.long 0xbf1c420c, 0xbf4ac77f, 0xbf5b2c79, 0xbf044889
.long 0xbf1ff6cb, 0xbf47de65, 0xbf5df6be, 0xbeff17b2
.long 0xbf239da9, 0xbf44e3f5, 0xbf60a6cf, 0xbef58035
.long 0xbf273656, 0xbf41d870, 0xbf633c5a, 0xbeebcbbb
.long 0xbf2ac082, 0xbf3ebc1b, 0xbf65b710, 0xbee1fb6a
.long 0xbf2e3bde, 0xbf3b8f3b, 0xbf6816a8, 0xbed8106b
.long 0xbf31a81d, 0xbf385216, 0xbf6a5ad9, 0xbece0bea
.long 0xbf3504f3, 0xbf3504f3, 0xbf6c835e, 0xbec3ef15
.long 0xbf385216, 0xbf31a81d, 0xbf6e8ff8, 0xbeb9bb1e
.long 0xbf3b8f3b, 0xbf2e3bde, 0xbf708066, 0xbeaf713a
.long 0xbf3ebc1b, 0xbf2ac082, 0xbf725470, 0xbea5129f
.long 0xbf41d870, 0xbf273656, 0xbf740bdd, 0xbe9aa086
.long 0xbf44e3f5, 0xbf239da9, 0xbf75a67b, 0xbe901c2c
.long 0xbf47de65, 0xbf1ff6cb, 0xbf772417, 0xbe8586ce
.long 0xbf4ac77f, 0xbf1c420c, 0xbf788486, 0xbe75c35a
.long 0xbf4d9f02, 0xbf187fc0, 0xbf79c79d, 0xbe605c13
.long 0xbf5064af, 0xbf14b039, 0xbf7aed37, 0xbe4ada4f
.long 0xbf531849, 0xbf10d3cd, 0xbf7bf531, 0xbe354098
.long 0xbf55b993, 0xbf0cead0, 0xbf7cdf6c, 0xbe1f917b
.long 0xbf584853, 0xbf08f59b, 0xbf7dabcc, 0xbe09cf86
.long 0xbf5ac450, 0xbf04f484, 0xbf7e5a38, 0xbde7fa9a
.long 0xbf5d2d53, 0xbf00e7e4, 0xbf7eea9d, 0xbdbc3ac3
.long 0xbf5f8327, 0xbef9a02d, 0xbf7f5ce9, 0xbd9064b4
.long 0xbf61c598, 0xbef15aea, 0xbf7fb10f, 0xbd48fb30
.long 0xbf63f473, 0xbee900b7, 0xbf7fe705, 0xbce22a7a
.long 0xbf660f88, 0xbee0924f, 0xbf7ffec4, 0xbbc90f88
.long 0xbf6816a8, 0xbed8106b, 0xbf7ff84a, 0x3c7b514b
.long 0xbf6a09a7, 0xbecf7bca, 0xbf7fd397, 0x3d16c32c
.long 0xbf6be858, 0xbec6d529, 0xbf7f90b1, 0x3d6ea038
.long 0xbf6db293, 0xbebe1d4a, 0xbf7f2f9d, 0x3da3308c
.long 0xbf6f6830, 0xbeb554ec, 0xbf7eb069, 0x3dcefdb7
.long 0xbf710908, 0xbeac7cd4, 0xbf7e1324, 0x3dfab273
.long 0xbf7294f8, 0xbea395c5, 0xbf7d57de, 0x3e1324ca
.long 0xbf740bdd, 0xbe9aa086, 0xbf7c7eb0, 0x3e28defc
.long 0xbf756d97, 0xbe919ddd, 0xbf7b87b2, 0x3e3e853e
.long 0xbf76ba07, 0xbe888e93, 0xbf7a7302, 0x3e541501
.long 0xbf77f110, 0xbe7ee6e1, 0xbf7940c0, 0x3e698bba
.long 0xbf791298, 0xbe6c9a7f, 0xbf77f110, 0x3e7ee6e1
.long 0xbf7a1e84, 0xbe5a3997, 0xbf76841b, 0x3e8a11f7
.long 0xbf7b14be, 0xbe47c5c2, 0xbf74fa0b, 0x3e94a031
.long 0xbf7bf531, 0xbe354098, 0xbf73530e, 0x3e9f1cdf
.long 0xbf7cbfc9, 0xbe22abb6, 0xbf718f57, 0x3ea986c4
.long 0xbf7d7474, 0xbe1008b7, 0xbf6faf1b, 0x3eb3dca5
.long 0xbf7e1324, 0xbdfab273, 0xbf6db293, 0x3ebe1d4a
.long 0xbf7e9bc9, 0xbdd53db9, 0xbf6b99fb, 0x3ec8477c
.long 0xbf7f0e58, 0xbdafb680, 0xbf696591, 0x3ed25a09
.long 0xbf7f6ac7, 0xbd8a200a, 0xbf671599, 0x3edc53c1
.long 0xbf7fb10f, 0xbd48fb30, 0xbf64aa59, 0x3ee63375
.long 0xbf7fe129, 0xbcfb49ba, 0xbf62241a, 0x3eeff7fb
.long 0xbf7ffb11, 0xbc490e90, 0xbf5f8327, 0x3ef9a02d
.long 0xbf7ffec4, 0x3bc90f88, 0xbf5cc7d1, 0x3f019573
.long 0xbf7fec43, 0x3cc90ab0, 0xbf59f26a, 0x3f064b82
.long 0xbf7fc38f, 0x3d2fe007, 0xbf570348, 0x3f0af1b7
.long 0xbf7f84ab, 0x3d7b2b74, 0xbf53fac3, 0x3f0f8784
.long 0xbf7f2f9d, 0x3da3308c, 0xbf50d937, 0x3f140c5f
.long 0xbf7ec46d, 0x3dc8bd36, 0xbf4d9f02, 0x3f187fc0
.long 0xbf7e4323, 0x3dee3876, 0xbf4a4c87, 0x3f1ce11f
.long 0xbf7dabcc, 0x3e09cf86, 0xbf46e22a, 0x3f212ff9
.long 0xbf7cfe73, 0x3e1c76de, 0xbf436051, 0x3f256bcb
.long 0xbf7c3b28, 0x3e2f10a2, 0xbf3fc767, 0x3f299415
.long 0xbf7b61fc, 0x3e419b37, 0xbf3c17d9, 0x3f2da859
.long 0xbf7a7302, 0x3e541501, 0xbf385216, 0x3f31a81d
.long 0xbf796e4e, 0x3e667c66, 0xbf34768f, 0x3f3592e7
.long 0xbf7853f8, 0x3e78cfcc, 0xbf3085bb, 0x3f396842
.long 0xbf772417, 0x3e8586ce, 0xbf2c800f, 0x3f3d27b8
.long 0xbf75dec6, 0x3e8e9a22, 0xbf286605, 0x3f40d0da
.long 0xbf748422, 0x3e97a117, 0xbf24381a, 0x3f446337
.long 0xbf731447, 0x3ea09ae5, 0xbf1ff6cb, 0x3f47de65
.long 0xbf718f57, 0x3ea986c4, 0xbf1ba299, 0x3f4b41fa
.long 0xbf6ff573, 0x3eb263ef, 0xbf173c07, 0x3f4e8d90
.long 0xbf6e46be, 0x3ebb31a0, 0xbf12c39a, 0x3f51c0c2
.long 0xbf6c835e, 0x3ec3ef15, 0xbf0e39da, 0x3f54db31
.long 0xbf6aab7b, 0x3ecc9b8b, 0xbf099f4e, 0x3f57dc7f
.long 0xbf68bf3c, 0x3ed53641, 0xbf04f484, 0x3f5ac450
.long 0xbf66becc, 0x3eddbe79, 0xbf003a06, 0x3f5d924d
.long 0xbf64aa59, 0x3ee63375, 0xbef6e0cb, 0x3f604621
.long 0xbf628210, 0x3eee9479, 0xbeed3063, 0x3f62df7b
.long 0xbf604621, 0x3ef6e0cb, 0xbee363fa, 0x3f655e0b
.long 0xbf5df6be, 0x3eff17b2, 0xbed97cb9, 0x3f67c187
.long 0xbf5b941a, 0x3f039c3d, 0xbecf7bca, 0x3f6a09a7
.long 0xbf591e6a, 0x3f07a136, 0xbec5625c, 0x3f6c3624
.long 0xbf5695e5, 0x3f0b9a6b, 0xbebb31a0, 0x3f6e46be
.long 0xbf53fac3, 0x3f0f8784, 0xbeb0eacb, 0x3f703b37
.long 0xbf514d3d, 0x3f13682a, 0xbea68f12, 0x3f721352
.long 0xbf4e8d90, 0x3f173c07, 0xbe9c1faf, 0x3f73ced9
.long 0xbf4bbbf8, 0x3f1b02c6, 0xbe919ddd, 0x3f756d97
.long 0xbf48d8b3, 0x3f1ebc12, 0xbe870ada, 0x3f76ef5b
.long 0xbf45e403, 0x3f226799, 0xbe78cfcc, 0x3f7853f8
.long 0xbf42de29, 0x3f26050a, 0xbe636c83, 0x3f799b43
.long 0xbf3fc767, 0x3f299415, 0xbe4dee60, 0x3f7ac516
.long 0xbf3ca003, 0x3f2d1469, 0xbe3857ec, 0x3f7bd14d
.long 0xbf396842, 0x3f3085bb, 0xbe22abb6, 0x3f7cbfc9
.long 0xbf36206c, 0x3f33e7bc, 0xbe0cec4a, 0x3f7d906e
.long 0xbf32c8c9, 0x3f373a23, 0xbdee3876, 0x3f7e4323
.long 0xbf2f61a5, 0x3f3a7ca4, 0xbdc27c39, 0x3f7ed7d4
.long 0xbf2beb4a, 0x3f3daef9, 0xbd96a905, 0x3f7f4e6d
.long 0xbf286605, 0x3f40d0da, 0xbd55880e, 0x3f7fa6e3
.long 0xbf24d225, 0x3f43e200, 0xbcfb49ba, 0x3f7fe129
.long 0xbf212ff9, 0x3f46e22a, 0xbc16cb58, 0x3f7ffd39
.long 0xbf1d7fd1, 0x3f49d112, 0x3c490e90, 0x3f7ffb11
.long 0xbf19c200, 0x3f4cae79, 0x3d0a342f, 0x3f7fdaaf
.long 0xbf15f6d9, 0x3f4f7a1f, 0x3d621469, 0x3f7f9c18
.long 0xbf121eb0, 0x3f5233c6, 0x3d9cecf9, 0x3f7f3f54
.long 0xbf0e39da, 0x3f54db31, 0x3dc8bd36, 0x3f7ec46d
.long 0xbf0a48ad, 0x3f577026, 0x3df475c0, 0x3f7e2b72
.long 0xbf064b82, 0x3f59f26a, 0x3e1008b7, 0x3f7d7474
.long 0xbf0242b1, 0x3f5c61c7, 0x3e25c58c, 0x3f7c9f8a
.long 0xbefc5d27, 0x3f5ebe05, 0x3e3b6ecf, 0x3f7baccd
.long 0xbef41f07, 0x3f6106f2, 0x3e5101f1, 0x3f7a9c59
.long 0xbeebcbbb, 0x3f633c5a, 0x3e667c66, 0x3f796e4e
.long 0xbee363fa, 0x3f655e0b, 0x3e7bdba4, 0x3f7822d1
.long 0xbedae880, 0x3f676bd8, 0x3e888e93, 0x3f76ba07
.long 0xbed25a09, 0x3f696591, 0x3e931f35, 0x3f75341d
.long 0xbec9b953, 0x3f6b4b0c, 0x3e9d9e78, 0x3f73913f
.long 0xbec1071e, 0x3f6d1c1d, 0x3ea80b1f, 0x3f71d19f
.long 0xbeb8442a, 0x3f6ed89e, 0x3eb263ef, 0x3f6ff573
.long 0xbeaf713a, 0x3f708066, 0x3ebca7af, 0x3f6dfcf2
.long 0xbea68f12, 0x3f721352, 0x3ec6d529, 0x3f6be858
.long 0xbe9d9e78, 0x3f73913f, 0x3ed0eb2a, 0x3f69b7e4
.long 0xbe94a031, 0x3f74fa0b, 0x3edae880, 0x3f676bd8
.long 0xbe8b9507, 0x3f764d97, 0x3ee4cbfe, 0x3f650479
.long 0xbe827dc0, 0x3f778bc5, 0x3eee9479, 0x3f628210
.long 0xbe72b651, 0x3f78b47b, 0x3ef840c8, 0x3f5fe4e9
.long 0xbe605c13, 0x3f79c79d, 0x3f00e7e4, 0x3f5d2d53
.long 0xbe4dee60, 0x3f7ac516, 0x3f05a02c, 0x3f5a5ba0
.long 0xbe3b6ecf, 0x3f7baccd, 0x3f0a48ad, 0x3f577026
.long 0xbe28defc, 0x3f7c7eb0, 0x3f0ee0db, 0x3f546b3b
.long 0xbe164083, 0x3f7d3aac, 0x3f13682a, 0x3f514d3d
.long 0xbe039502, 0x3f7de0b1, 0x3f17de12, 0x3f4e1689
.long 0xbde1bc2e, 0x3f7e70b0, 0x3f1c420c, 0x3f4ac77f
.long 0xbdbc3ac3, 0x3f7eea9d, 0x3f209393, 0x3f476085
.long 0xbd96a905, 0x3f7f4e6d, 0x3f24d225, 0x3f43e200
.long 0xbd621469, 0x3f7f9c18, 0x3f28fd41, 0x3f404c5c
.long 0xbd16c32c, 0x3f7fd397, 0x3f2d1469, 0x3f3ca003
.long 0xbc96c9b6, 0x3f7ff4e6, 0x3f311722, 0x3f38dd65
.long 0x3f800000, 0x80000000, 0x3f800000, 0x80000000
.long 0x3f800000, 0x80000000, 0x3f7fec43, 0xbcc90ab0
.long 0x3f800000, 0x80000000, 0x3f7fb10f, 0xbd48fb30
.long 0x3f800000, 0x80000000, 0x3f7f4e6d, 0xbd96a905
.long 0x3f800000, 0x80000000, 0x3f7ec46d, 0xbdc8bd36
.long 0x3f800000, 0x80000000, 0x3f7e1324, 0xbdfab273
.long 0x3f800000, 0x80000000, 0x3f7d3aac, 0xbe164083
.long 0x3f800000, 0x80000000, 0x3f7c3b28, 0xbe2f10a2
.long 0x3f800000, 0x80000000, 0x3f7b14be, 0xbe47c5c2
.long 0x3f800000, 0x80000000, 0x3f79c79d, 0xbe605c13
.long 0x3f800000, 0x80000000, 0x3f7853f8, 0xbe78cfcc
.long 0x3f800000, 0x80000000, 0x3f76ba07, 0xbe888e93
.long 0x3f800000, 0x80000000, 0x3f74fa0b, 0xbe94a031
.long 0x3f800000, 0x80000000, 0x3f731447, 0xbea09ae5
.long 0x3f800000, 0x80000000, 0x3f710908, 0xbeac7cd4
.long 0x3f800000, 0x80000000, 0x3f6ed89e, 0xbeb8442a
.long 0x3f800000, 0x80000000, 0x3f6c835e, 0xbec3ef15
.long 0x3f800000, 0x80000000, 0x3f6a09a7, 0xbecf7bca
.long 0x3f800000, 0x80000000, 0x3f676bd8, 0xbedae880
.long 0x3f800000, 0x80000000, 0x3f64aa59, 0xbee63375
.long 0x3f800000, 0x80000000, 0x3f61c598, 0xbef15aea
.long 0x3f800000, 0x80000000, 0x3f5ebe05, 0xbefc5d27
.long 0x3f800000, 0x80000000, 0x3f5b941a, 0xbf039c3d
.long 0x3f800000, 0x80000000, 0x3f584853, 0xbf08f59b
.long 0x3f800000, 0x80000000, 0x3f54db31, 0xbf0e39da
.long 0x3f800000, 0x80000000, 0x3f514d3d, 0xbf13682a
.long 0x3f800000, 0x80000000, 0x3f4d9f02, 0xbf187fc0
.long 0x3f800000, 0x80000000, 0x3f49d112, 0xbf1d7fd1
.long 0x3f800000, 0x80000000, 0x3f45e403, 0xbf226799
.long 0x3f800000, 0x80000000, 0x3f41d870, 0xbf273656
.long 0x3f800000, 0x80000000, 0x3f3daef9, 0xbf2beb4a
.long 0x3f800000, 0x80000000, 0x3f396842, 0xbf3085bb
.long 0x3f800000, 0x80000000, 0x3f800000, 0x80000000
.long 0x3f7fb10f, 0xbd48fb30, 0x3f7f4e6d, 0xbd96a905
.long 0x3f7ec46d, 0xbdc8bd36, 0x3f7d3aac, 0xbe164083
.long 0x3f7d3aac, 0xbe164083, 0x3f79c79d, 0xbe605c13
.long 0x3f7b14be, 0xbe47c5c2, 0x3f74fa0b, 0xbe94a031
.long 0x3f7853f8, 0xbe78cfcc, 0x3f6ed89e, 0xbeb8442a
.long 0x3f74fa0b, 0xbe94a031, 0x3f676bd8, 0xbedae880
.long 0x3f710908, 0xbeac7cd4, 0x3f5ebe05, 0xbefc5d27
.long 0x3f6c835e, 0xbec3ef15, 0x3f54db31, 0xbf0e39da
.long 0x3f676bd8, 0xbedae880, 0x3f49d112, 0xbf1d7fd1
.long 0x3f61c598, 0xbef15aea, 0x3f3daef9, 0xbf2beb4a
.long 0x3f5b941a, 0xbf039c3d, 0x3f3085bb, 0xbf396842
.long 0x3f54db31, 0xbf0e39da, 0x3f226799, 0xbf45e403
.long 0x3f4d9f02, 0xbf187fc0, 0x3f13682a, 0xbf514d3d
.long 0x3f45e403, 0xbf226799, 0x3f039c3d, 0xbf5b941a
.long 0x3f3daef9, 0xbf2beb4a, 0x3ee63375, 0xbf64aa59
.long 0x3f3504f3, 0xbf3504f3, 0x3ec3ef15, 0xbf6c835e
.long 0x3f2beb4a, 0xbf3daef9, 0x3ea09ae5, 0xbf731447
.long 0x3f226799, 0xbf45e403, 0x3e78cfcc, 0xbf7853f8
.long 0x3f187fc0, 0xbf4d9f02, 0x3e2f10a2, 0xbf7c3b28
.long 0x3f0e39da, 0xbf54db31, 0x3dc8bd36, 0xbf7ec46d
.long 0x3f039c3d, 0xbf5b941a, 0x3cc90ab0, 0xbf7fec43
.long 0x3ef15aea, 0xbf61c598, 0xbd48fb30, 0xbf7fb10f
.long 0x3edae880, 0xbf676bd8, 0xbdfab273, 0xbf7e1324
.long 0x3ec3ef15, 0xbf6c835e, 0xbe47c5c2, 0xbf7b14be
.long 0x3eac7cd4, 0xbf710908, 0xbe888e93, 0xbf76ba07
.long 0x3e94a031, 0xbf74fa0b, 0xbeac7cd4, 0xbf710908
.long 0x3e78cfcc, 0xbf7853f8, 0xbecf7bca, 0xbf6a09a7
.long 0x3e47c5c2, 0xbf7b14be, 0xbef15aea, 0xbf61c598
.long 0x3e164083, 0xbf7d3aac, 0xbf08f59b, 0xbf584853
.long 0x3dc8bd36, 0xbf7ec46d, 0xbf187fc0, 0xbf4d9f02
.long 0x3d48fb30, 0xbf7fb10f, 0xbf273656, 0xbf41d870
.long 0x3f800000, 0x80000000, 0x3f800000, 0x80000000
.long 0x3f7ec46d, 0xbdc8bd36, 0x3f7e1324, 0xbdfab273
.long 0x3f7b14be, 0xbe47c5c2, 0x3f7853f8, 0xbe78cfcc
.long 0x3f74fa0b, 0xbe94a031, 0x3f6ed89e, 0xbeb8442a
.long 0x3f6c835e, 0xbec3ef15, 0x3f61c598, 0xbef15aea
.long 0x3f61c598, 0xbef15aea, 0x3f514d3d, 0xbf13682a
.long 0x3f54db31, 0xbf0e39da, 0x3f3daef9, 0xbf2beb4a
.long 0x3f45e403, 0xbf226799, 0x3f273656, 0xbf41d870
.long 0x3f3504f3, 0xbf3504f3, 0x3f0e39da, 0xbf54db31
.long 0x3f226799, 0xbf45e403, 0x3ee63375, 0xbf64aa59
.long 0x3f0e39da, 0xbf54db31, 0x3eac7cd4, 0xbf710908
.long 0x3ef15aea, 0xbf61c598, 0x3e605c13, 0xbf79c79d
.long 0x3ec3ef15, 0xbf6c835e, 0x3dc8bd36, 0xbf7ec46d
.long 0x3e94a031, 0xbf74fa0b, 0xbcc90ab0, 0xbf7fec43
.long 0x3e47c5c2, 0xbf7b14be, 0xbe164083, 0xbf7d3aac
.long 0x3dc8bd36, 0xbf7ec46d, 0xbe888e93, 0xbf76ba07
.long 0x248d3132, 0xbf800000, 0xbec3ef15, 0xbf6c835e
.long 0xbdc8bd36, 0xbf7ec46d, 0xbefc5d27, 0xbf5ebe05
.long 0xbe47c5c2, 0xbf7b14be, 0xbf187fc0, 0xbf4d9f02
.long 0xbe94a031, 0xbf74fa0b, 0xbf3085bb, 0xbf396842
.long 0xbec3ef15, 0xbf6c835e, 0xbf45e403, 0xbf226799
.long 0xbef15aea, 0xbf61c598, 0xbf584853, 0xbf08f59b
.long 0xbf0e39da, 0xbf54db31, 0xbf676bd8, 0xbedae880
.long 0xbf226799, 0xbf45e403, 0xbf731447, 0xbea09ae5
.long 0xbf3504f3, 0xbf3504f3, 0xbf7b14be, 0xbe47c5c2
.long 0xbf45e403, 0xbf226799, 0xbf7f4e6d, 0xbd96a905
.long 0xbf54db31, 0xbf0e39da, 0xbf7fb10f, 0x3d48fb30
.long 0xbf61c598, 0xbef15aea, 0xbf7c3b28, 0x3e2f10a2
.long 0xbf6c835e, 0xbec3ef15, 0xbf74fa0b, 0x3e94a031
.long 0xbf74fa0b, 0xbe94a031, 0xbf6a09a7, 0x3ecf7bca
.long 0xbf7b14be, 0xbe47c5c2, 0xbf5b941a, 0x3f039c3d
.long 0xbf7ec46d, 0xbdc8bd36, 0xbf49d112, 0x3f1d7fd1
.long 0x3f800000, 0x80000000, 0x3f800000, 0x80000000
.long 0x3f7d3aac, 0xbe164083, 0x3f7c3b28, 0xbe2f10a2
.long 0x3f74fa0b, 0xbe94a031, 0x3f710908, 0xbeac7cd4
.long 0x3f676bd8, 0xbedae880, 0x3f5ebe05, 0xbefc5d27
.long 0x3f54db31, 0xbf0e39da, 0x3f45e403, 0xbf226799
.long 0x3f3daef9, 0xbf2beb4a, 0x3f273656, 0xbf41d870
.long 0x3f226799, 0xbf45e403, 0x3f039c3d, 0xbf5b941a
.long 0x3f039c3d, 0xbf5b941a, 0x3eb8442a, 0xbf6ed89e
.long 0x3ec3ef15, 0xbf6c835e, 0x3e47c5c2, 0xbf7b14be
.long 0x3e78cfcc, 0xbf7853f8, 0x3cc90ab0, 0xbf7fec43
.long 0x3dc8bd36, 0xbf7ec46d, 0xbe164083, 0xbf7d3aac
.long 0xbd48fb30, 0xbf7fb10f, 0xbea09ae5, 0xbf731447
.long 0xbe47c5c2, 0xbf7b14be, 0xbef15aea, 0xbf61c598
.long 0xbeac7cd4, 0xbf710908, 0xbf1d7fd1, 0xbf49d112
.long 0xbef15aea, 0xbf61c598, 0xbf3daef9, 0xbf2beb4a
.long 0xbf187fc0, 0xbf4d9f02, 0xbf584853, 0xbf08f59b
.long 0xbf3504f3, 0xbf3504f3, 0xbf6c835e, 0xbec3ef15
.long 0xbf4d9f02, 0xbf187fc0, 0xbf79c79d, 0xbe605c13
.long 0xbf61c598, 0xbef15aea, 0xbf7fb10f, 0xbd48fb30
.long 0xbf710908, 0xbeac7cd4, 0xbf7e1324, 0x3dfab273
.long 0xbf7b14be, 0xbe47c5c2, 0xbf74fa0b, 0x3e94a031
.long 0xbf7fb10f, 0xbd48fb30, 0xbf64aa59, 0x3ee63375
.long 0xbf7ec46d, 0x3dc8bd36, 0xbf4d9f02, 0x3f187fc0
.long 0xbf7853f8, 0x3e78cfcc, 0xbf3085bb, 0x3f396842
.long 0xbf6c835e, 0x3ec3ef15, 0xbf0e39da, 0x3f54db31
.long 0xbf5b941a, 0x3f039c3d, 0xbecf7bca, 0x3f6a09a7
.long 0xbf45e403, 0x3f226799, 0xbe78cfcc, 0x3f7853f8
.long 0xbf2beb4a, 0x3f3daef9, 0xbd96a905, 0x3f7f4e6d
.long 0xbf0e39da, 0x3f54db31, 0x3dc8bd36, 0x3f7ec46d
.long 0xbedae880, 0x3f676bd8, 0x3e888e93, 0x3f76ba07
.long 0xbe94a031, 0x3f74fa0b, 0x3edae880, 0x3f676bd8
.long 0xbe164083, 0x3f7d3aac, 0x3f13682a, 0x3f514d3d
.long 0x3f800000, 0x80000000, 0x3f800000, 0x80000000
.long 0x3f800000, 0x80000000, 0x3f7b14be, 0xbe47c5c2
.long 0x3f800000, 0x80000000, 0x3f6c835e, 0xbec3ef15
.long 0x3f800000, 0x80000000, 0x3f54db31, 0xbf0e39da
.long 0x3f800000, 0x80000000, 0x3f800000, 0x80000000
.long 0x3f6c835e, 0xbec3ef15, 0x3f54db31, 0xbf0e39da
.long 0x3f3504f3, 0xbf3504f3, 0x3ec3ef15, 0xbf6c835e
.long 0x3ec3ef15, 0xbf6c835e, 0xbe47c5c2, 0xbf7b14be
.long 0x3f800000, 0x80000000, 0x3f800000, 0x80000000
.long 0x3f3504f3, 0xbf3504f3, 0x3f0e39da, 0xbf54db31
.long 0x248d3132, 0xbf800000, 0xbec3ef15, 0xbf6c835e
.long 0xbf3504f3, 0xbf3504f3, 0xbf7b14be, 0xbe47c5c2
.long 0x3f800000, 0x80000000, 0x3f800000, 0x80000000
.long 0x3ec3ef15, 0xbf6c835e, 0x3e47c5c2, 0xbf7b14be
.long 0xbf3504f3, 0xbf3504f3, 0xbf6c835e, 0xbec3ef15
.long 0xbf6c835e, 0x3ec3ef15, 0xbf0e39da, 0x3f54db31
.size TWTAB, 23296
.section .rodata,"a"
.p2align 6
.amdhsa_kernel k0_kernel
  .amdhsa_next_free_vgpr 96
  .amdhsa_next_free_sgpr 102
  .amdhsa_accum_offset 96
  .amdhsa_group_segment_fixed_size 0
  .amdhsa_kernarg_size 80
  .amdhsa_user_sgpr_count 2
  .amdhsa_user_sgpr_kernarg_segment_ptr 1
  .amdhsa_system_sgpr_workgroup_id_x 1
.end_amdhsa_kernel
.p2align 6
.amdhsa_kernel k1_kernel
  .amdhsa_next_free_vgpr 208
  .amdhsa_next_free_sgpr 102
  .amdhsa_accum_offset 208
  .amdhsa_group_segment_fixed_size 0
  .amdhsa_kernarg_size 80
  .amdhsa_user_sgpr_count 2
  .amdhsa_user_sgpr_kernarg_segment_ptr 1
  .amdhsa_system_sgpr_workgroup_id_x 1
.end_amdhsa_kernel
```
